```python
import torch

def _softmax(x, axis=-1):
    return torch.softmax(x, dim=axis)
def _gelu(x):
    return torch.nn.functional.gelu(x, approximate="tanh")
def _silu(x):
    return torch.nn.functional.silu(x)
def _sigmoid(x):
    return torch.sigmoid(x)
def _layernorm(x, axis=-1, eps=1e-5):
    m = x.mean(dim=axis, keepdim=True)
    v = x.var(dim=axis, keepdim=True, unbiased=False)
    return (x - m) / torch.sqrt(v + eps)
def _scatter_add(tgt, idx, src, axis=0):
    return tgt.clone().index_add_(axis, idx, src)
def _segment_sum(src, seg, n):
    out = torch.zeros((n,) + src.shape[1:], dtype=src.dtype)
    return out.index_add_(0, seg, src)
def _pad(x, pw):
    flat = tuple(v for pair in reversed(pw) for v in pair)
    return torch.nn.functional.pad(x, flat)

kernel_name = 'sequential_preLN__linear_attn_block__mixer_token_mlp__prompt'

def setup_inputs():

    _w = (lambda a: (lambda t: t.to(torch.bfloat16) if t.is_floating_point() else t)(torch.as_tensor(a)))
    def _A_setup():
        B, S, D = 1, 2048, 640
        return {
            "x": _w((lambda *s: torch.randn(*s, dtype=torch.bfloat16) * 0.05)(B, S, D)),
            "wqkv": _w((lambda *s: torch.randn(*s, dtype=torch.bfloat16) * 0.05)(D, 3 * D)),
            "wo": _w((lambda *s: torch.randn(*s, dtype=torch.bfloat16) * 0.05)(D, D)),
        }
    _A_in = _A_setup()

    def _B_setup():
        B, S, D, F = 1, 2048, 640, 1536
        return {
            "x": _w((lambda *s: torch.randn(*s, dtype=torch.bfloat16) * 0.05)(B, S, D)),
            "w1": _w((lambda *s: torch.randn(*s, dtype=torch.bfloat16) * 0.2)(S, F) * (S ** -0.5)),
            "b1": _w((lambda *s: torch.randn(*s, dtype=torch.bfloat16) * 3.2)(F) * 0.02),
            "w2": _w((lambda *s: torch.randn(*s, dtype=torch.bfloat16) * 0.4)(F, S) * (F ** -0.5)),
            "b2": _w((lambda *s: torch.randn(*s, dtype=torch.bfloat16) * 0.8)(S) * 0.02),
        }
    _B_in = _B_setup()

    return {
        "A_x": _A_in["x"],
        "A_wqkv": _A_in["wqkv"],
        "A_wo": _A_in["wo"],
        "B_x": _B_in["x"],
        "B_w1": _B_in["w1"],
        "B_b1": _B_in["b1"],
        "B_w2": _B_in["w2"],
        "B_b2": _B_in["b2"],
    }

def reference(A_x, A_wqkv, A_wo, B_x, B_w1, B_b1, B_w2, B_b2):
    def _A_ref(x, wqkv, wo):
        B, S, D = x.shape
        H = 32; Dh = D // H
        qkv = (lambda x, *d: x.permute(*d))((x @ wqkv).reshape(B, S, 3, H, Dh), 2, 0, 3, 1, 4)
        q, k, v = qkv[0], qkv[1], qkv[2]
        phi = lambda t: torch.where(t > 0, t + 1, torch.exp(t)) + 1e-6
        pq, pk = phi(q), phi(k)
        kv = torch.einsum("bhsd,bhse->bhde", pk, v)
        z = torch.einsum("bhsd->bhd", pk)
        num = torch.einsum("bhqd,bhde->bhqe", pq, kv)
        den = torch.einsum("bhqd,bhd->bhq", pq, z)[..., None] + 1e-6
        o = num / den
        return (lambda x, *d: x.permute(*d))(o, 0, 2, 1, 3).reshape(B, S, D) @ wo

    def _B_ref(x, w1, b1, w2, b2):
        B, S, D = x.shape
        h = _layernorm(x, axis=-1)
        u = torch.einsum("bsd,sf->bdf", h, w1) + b1
        u = _gelu(u)
        y = torch.einsum("bdf,fs->bds", u, w2) + b2
        return (lambda x, *d: x.permute(*d))(y, 0, 2, 1)

    x = A_x
    h = x + _A_ref(_layernorm(x, axis=-1), A_wqkv, A_wo)
    h2 = h + _B_ref(_layernorm(h, axis=-1), B_w1, B_b1, B_w2, B_b2)
    return h2
```

```asm
; @launch grid=(256,1,1) block=(256,1,1) lds=163840
.amdgcn_target "amdgcn-amd-amdhsa--gfx950"
.text
.globl sequential_preLN__linear_attn_block__mixer_token_mlp__prompt_kernel
.p2align 12
.p2align 8
.type sequential_preLN__linear_attn_block__mixer_token_mlp__prompt_kernel,@function
sequential_preLN__linear_attn_block__mixer_token_mlp__prompt_kernel:
    s_cmp_ge_u32 s2, 256
    s_cbranch_scc1 L_end
    s_load_dwordx2 s[4:5], s[0:1], 0
    s_load_dwordx2 s[8:9], s[0:1], 8
    s_getpc_b64 s[60:61]
    v_lshrrev_b32 v1, 6, v0
    s_and_b32 s60, s60, 0xffffff00
    v_readfirstlane_b32 s38, v1
    v_and_b32 v0, 63, v0
    s_and_b32 s39, s2, 7
    s_lshr_b32 s40, s2, 3
    s_lshl_b32 s3, s40, 2
    s_add_u32 s3, s3, s38
    s_lshl_b32 s3, s3, 2
    v_and_b32 v5, 3, v0
    v_add_u32 v1, s3, v5
    v_min_u32 v1, 409, v1
    v_lshlrev_b32_e64 v251, 7, v1
    global_load_dword v255, v251, s[60:61]
    s_mov_b32 s6, 2621440
    s_mov_b32 s7, 0x20000
    s_mov_b32 s10, 2457600
    s_mov_b32 s11, 0x20000
    v_and_b32 v1, 15, v0
    v_lshrrev_b32 v2, 4, v0
    s_cmp_ge_u32 s40, 26
    s_cbranch_scc1 L_helper
    s_cmp_ge_u32 s40, 16
    s_cbranch_scc1 L_roleq
    v_mul_u32_u24 v11, 6554, v0
    v_lshrrev_b32 v9, 16, v11
    v_mul_u32_u24 v10, 10, v9
    v_sub_u32 v8, v0, v10
    v_add_u32 v10, 5, v8
    v_cmp_gt_u32 vcc, 5, v8
    s_lshl_b32 s45, s40, 2
    s_add_u32 s45, s45, s38
    s_mul_i32 s3, s45, 6
    v_cndmask_b32 v8, v10, v8, vcc
    s_and_b32 s54, s39, 1
    s_add_u32 s3, s3, s54
    s_mul_i32 s3, s3, 640
    s_add_u32 s3, s3, 1280
    v_lshl_add_u32 v8, v8, 7, s3
    s_mov_b32 s3, 245760
    v_min_u32 v10, 4, v9
    v_mad_u32_u24 v12, v10, s3, v8
    s_lshr_b32 s3, s39, 1
    s_lshl_b32 s3, s3, 6
    s_add_u32 s3, s3, s45
    s_mul_i32 s3, s3, 10240
    v_lshrrev_b32 v8, 3, v0
    v_mul_u32_u24 v8, 1280, v8
    v_and_b32 v9, 7, v0
    v_min_u32_e64 v9, 2, v9
    v_lshl_add_u32 v13, v9, 7, v8
    s_waitcnt lgkmcnt(0)
    buffer_load_dword v255, v13, s[4:7], s3 offen
    buffer_load_dword v255, v12, s[8:11], 0 offen
    s_branch L_kv2
L_ret:
    s_setpc_b64 s[62:63]
L_roleq:
    s_sub_u32 s45, s40, 16
    s_lshl_b32 s45, s45, 2
    s_add_u32 s45, s45, s38
    s_and_b32 s54, s39, 1
    s_mul_i32 s3, s45, 30720
    s_lshl_b32 s44, s54, 9
    s_add_u32 s3, s3, s44
    v_lshrrev_b32 v8, 3, v0
    v_mul_u32_u24 v8, 3840, v8
    v_and_b32 v9, 7, v0
    v_min_u32 v9, 5, v9
    v_lshl_add_u32 v12, v9, 7, v8
    s_waitcnt lgkmcnt(0)
    buffer_load_dword v255, v12, s[8:11], s3 offen
    s_branch L_roleq2
L_helper:
    s_sub_u32 s53, s40, 26
    s_cmp_ge_u32 s53, 4
    s_cbranch_scc1 L_hcol
    s_lshl_b32 s3, s39, 2
    s_add_u32 s3, s3, s53
    s_lshl_b32 s3, s3, 2
    s_add_u32 s47, s3, s38
    s_lshl_b32 s3, s47, 4
    v_lshrrev_b32 v13, 3, v0
    v_add_u32 v14, s3, v13
    v_mul_u32_u24 v14, 1280, v14
    v_and_b32 v12, 7, v0
    v_lshl_add_u32 v14, v12, 4, v14
    s_movk_i32 s48, 10240
    s_waitcnt lgkmcnt(0)
    buffer_load_dwordx4 v[16:19], v14, s[4:7], 0 offen offset:0
    buffer_load_dwordx4 v[20:23], v14, s[4:7], s48 offen offset:0
    buffer_load_dwordx4 v[24:27], v14, s[4:7], 0 offen offset:128
    buffer_load_dwordx4 v[28:31], v14, s[4:7], s48 offen offset:128
    buffer_load_dwordx4 v[32:35], v14, s[4:7], 0 offen offset:256
    buffer_load_dwordx4 v[36:39], v14, s[4:7], s48 offen offset:256
    buffer_load_dwordx4 v[40:43], v14, s[4:7], 0 offen offset:384
    buffer_load_dwordx4 v[44:47], v14, s[4:7], s48 offen offset:384
    s_branch L_helper2
L_hcol:
    s_and_b32 s3, s39, 6
    s_add_u32 s3, s3, s53
    s_lshl_b32 s3, s3, 2
    s_sub_u32 s3, s3, 16
    s_mov_b32 s47, 0x27ba6510
    s_bitcmp1_b32 s39, 0
    s_cselect_b32 s47, 0xfced9843, s47
    s_lshr_b32 s47, s47, s3
    s_and_b32 s47, s47, 15
    s_lshl_b32 s3, s38, 2
    v_add_u32 v13, s3, v2
    v_mul_u32_u24 v14, 3840, v13
    v_lshl_add_u32 v14, v1, 4, v14
    s_lshl_b32 s48, s47, 8
    s_waitcnt lgkmcnt(0)
    buffer_load_dwordx4 v[16:19], v14, s[8:11], s48 offen
    s_add_u32 s48, s48, 61440
    buffer_load_dwordx4 v[20:23], v14, s[8:11], s48 offen
    s_add_u32 s48, s48, 61440
    buffer_load_dwordx4 v[24:27], v14, s[8:11], s48 offen
    s_add_u32 s48, s48, 61440
    buffer_load_dwordx4 v[28:31], v14, s[8:11], s48 offen
    s_add_u32 s48, s48, 61440
    buffer_load_dwordx4 v[32:35], v14, s[8:11], s48 offen
    s_add_u32 s48, s48, 61440
    buffer_load_dwordx4 v[36:39], v14, s[8:11], s48 offen
    s_add_u32 s48, s48, 61440
    buffer_load_dwordx4 v[40:43], v14, s[8:11], s48 offen
    s_add_u32 s48, s48, 61440
    buffer_load_dwordx4 v[44:47], v14, s[8:11], s48 offen
    s_add_u32 s48, s48, 61440
    s_branch L_hcol2
L_kv2:
    s_and_b32 s54, s39, 1
    s_sub_u32 s53, s40, 16
    s_lshl_b32 s3, s54, 1
    s_add_u32 s3, s3, s53
    s_sub_u32 s3, s3, 8
    s_lshr_b32 s52, s53, 1
    s_cmp_lt_u32 s53, 8
    s_cselect_b32 s52, s52, s3
    s_lshr_b32 s3, s40, 2
    s_cmp_lt_u32 s40, 16
    s_cselect_b32 s52, s3, s52
    s_and_b32 s3, s39, 6
    s_lshl_b32 s3, s3, 1
    s_add_u32 s52, s52, s3
    s_lshl_b32 s3, s52, 2
    s_add_u32 s3, s3, s38
    s_lshl_b32 s3, s3, 5
    s_lshl_b32 s49, s38, 12
    v_lshrrev_b32 v8, 3, v0
    v_add_u32 v8, s3, v8
    v_mul_u32_u24 v8, 1280, v8
    v_and_b32 v9, 7, v0
    v_xor_b32 v9, v9, v2
    v_lshl_add_u32 v148, v9, 4, v8
    v_xor_b32 v8, 64, v148
    v_add_u32 v149, 9216, v8
    v_add_u32 v150, 18432, v148
    v_add_u32 v151, 27648, v8
    s_lshl_b32 s51, s54, 2
    s_and_b32 s3, s40, 3
    s_add_u32 s51, s51, s3
    s_mul_i32 s45, s51, 160
    s_mul_i32 s50, s38, 5120
    s_add_u32 s50, s50, 16384
    s_mul_i32 s3, s38, 61440
    s_add_u32 s3, s3, s45
    s_add_u32 s3, s3, 1280
    s_movk_i32 s44, 160
    v_lshl_add_u32 v8, v0, 4, s3
    v_add_u32 v9, 0, v11
    v_lshrrev_b32 v9, 16, v9
    v_mul_u32_u24 v10, 3, v9
    v_and_b32 v10, -2, v10
    v_lshlrev_b32 v10, 2, v10
    v_sub_u32_e64 v9, v10, v9
    v_mad_u32_u24 v152, v9, s44, v8
    v_add_u32 v9, 419456, v11
    v_lshrrev_b32 v9, 16, v9
    v_mul_u32_u24 v10, 3, v9
    v_and_b32 v10, -2, v10
    v_lshlrev_b32 v10, 2, v10
    v_sub_u32_e64 v9, v10, v9
    v_mad_u32_u24 v153, v9, s44, v8
    v_add_u32 v9, 838912, v11
    v_lshrrev_b32 v9, 16, v9
    v_lshrrev_b32 v10, 4, v9
    v_xor_b32 v10, v10, v9
    v_mul_u32_u24 v10, 3, v10
    v_and_b32 v10, -2, v10
    v_lshlrev_b32 v10, 2, v10
    v_sub_u32 v9, v10, v9
    v_mad_u32_u24 v154, v9, s44, v8
    v_add_u32 v9, 1258368, v11
    v_lshrrev_b32 v9, 16, v9
    v_xor_b32 v10, 1, v9
    v_mul_u32_u24 v10, 3, v10
    v_and_b32 v10, -2, v10
    v_lshlrev_b32 v10, 2, v10
    v_sub_u32_e64 v9, v10, v9
    v_mad_u32_u24 v155, v9, s44, v8
    v_add_u32 v8, 4096, v8
    v_add_u32 v9, 1677824, v11
    v_lshrrev_b32 v9, 16, v9
    v_xor_b32 v10, 1, v9
    v_mul_u32_u24 v10, 3, v10
    v_and_b32 v10, -2, v10
    v_lshlrev_b32 v10, 2, v10
    v_sub_u32 v9, v10, v9
    v_mad_u32_u24 v156, v9, s44, v8
    s_load_dwordx2 s[28:29], s[0:1], 80
    s_load_dwordx2 s[12:13], s[0:1], 16
    s_load_dwordx2 s[16:17], s[0:1], 32
    s_load_dwordx2 s[32:33], s[0:1], 40
    s_load_dwordx2 s[20:21], s[0:1], 48
    s_load_dwordx2 s[34:35], s[0:1], 56
    s_load_dwordx2 s[24:25], s[0:1], 64
    s_lshr_b32 s41, s38, 1
    s_and_b32 s42, s38, 1
    s_mov_b32 s14, 819200
    s_mov_b32 s15, 0x20000
    s_mov_b32 s18, 6291456
    s_mov_b32 s19, 0x20000
    s_mov_b32 s22, 6291456
    s_mov_b32 s23, 0x20000
    s_mov_b32 s26, 2621440
    s_mov_b32 s27, 0x20000
    s_mov_b32 s30, 16777216
    s_mov_b32 s31, 0x20000
    s_load_dwordx2 s[36:37], s[0:1], 72
    v_lshrrev_b32 v3, 5, v0
    v_bfe_u32 v4, v0, 2, 2
    v_and_b32 v6, 1, v2
    v_lshlrev_b32_e64 v7, 4, v0
    s_mov_b32 s56, 0xaaaaaaaa
    s_mov_b32 s57, 0xaaaaaaaa
    s_mov_b32 s58, 0xcccccccc
    s_mov_b32 s59, 0xcccccccc
    s_cmp_eq_u32 s38, 0
    s_cselect_b64 vcc, 1, 0
    v_mov_b32 v253, 1073741824
    v_cndmask_b32 v252, v253, 0, vcc
    v_mov_b32 v253, 1
    v_lshrrev_b32 v8, 1, v1
    v_xor_b32 v8, v8, v2
    v_lshlrev_b32 v8, 4, v8
    v_lshl_add_u32 v8, v1, 7, v8
    s_lshl_b32 s3, s41, 13
    v_add_u32 v158, s3, v8
    v_xor_b32 v159, 64, v158
    s_lshl_b32 s44, s42, 1
    s_add_u32 s45, s44, s41
    s_xor_b32 s44, s45, 1
    v_lshl_add_u32 v8, v2, 3, v4
    v_mul_u32_u24 v8, 320, v8
    v_mul_u32_u24 v9, 160, v6
    v_sub_u32 v10, 160, v9
    v_lshl_add_u32 v11, v5, 3, v8
    s_mul_i32 s3, s45, 40
    s_add_u32 s3, s3, 16384
    v_add3_u32 v162, v11, v9, s3
    v_add3_u32 v163, v11, v10, s3
    v_mov_b32 v12, s3
    s_mul_i32 s3, s44, 40
    s_add_u32 s3, s3, 16384
    v_add3_u32 v164, v11, v9, s3
    v_add3_u32 v165, v11, v10, s3
    v_mov_b32_e64 v13, s3
    v_cndmask_b32 v9, v9, v10, s[56:57]
    v_cndmask_b32 v12, v12, v13, s[58:59]
    v_add3_u32 v8, v8, v9, v12
    v_add_u32_e64 v166, 32, v8
    v_add_u32 v160, 73728, v158
    v_add_u32 v161, 73728, v159
    v_add_u32 v167, 73728, v162
    v_add_u32 v168, 73728, v163
    v_add_u32 v169, 73728, v164
    v_add_u32 v170, 73728, v165
    v_add_u32 v171, 73728, v166
    s_mov_b64 exec, 0
    s_cmp_lg_u32 s38, 0
    s_cbranch_scc1 L_wn_2
    s_call_b64 s[62:63], L_pg0
    s_call_b64 s[62:63], L_pg9
    s_call_b64 s[62:63], L_pg13
    s_branch L_wd_1
L_wn_2:
    s_cmp_lg_u32 s38, 1
    s_cbranch_scc1 L_wn_3
    s_call_b64 s[62:63], L_pg1
    s_call_b64 s[62:63], L_pg10
    s_call_b64 s[62:63], L_pg14
    s_branch L_wd_1
L_wn_3:
    s_cmp_lg_u32 s38, 2
    s_cbranch_scc1 L_wn_4
    s_call_b64 s[62:63], L_pg2
    s_call_b64 s[62:63], L_pg11
    s_nop 0
    s_branch L_wd_1
L_wn_4:
    s_call_b64 s[62:63], L_pg8
    s_call_b64 s[62:63], L_pg12
    s_nop 0
L_wd_1:
    s_mov_b64 exec, -1
    v_mov_b32 v196, 0
    s_mov_b32 s62, 0x3fb8aa3b
    s_mov_b32 s63, 0x3fb8aa3b
    v_mov_b32 v138, 0x358637bd
    v_mov_b32 v139, 0x358637bd
    v_mov_b32 v140, 0xb5c1a2a0
    v_mov_b32 v141, 0xb5c1a2a0
    s_lshl_b32 s3, s52, 1
    s_add_u32 s3, s3, s41
    s_lshl_b32 s3, s3, 9
    s_add_u32 s3, s3, 524288
    v_lshl_add_u32 v186, v0, 3, s3
    s_lshl_b32 s3, s38, 9
    s_add_u32 s3, s3, 36864
    v_lshl_add_u32 v172, v0, 3, s3
    v_lshl_add_u32 v173, v2, 4, s3
    s_lshl_b32 s46, s51, 4
    s_add_u32 s46, s46, s52
    s_lshl_b32 s46, s46, 7
    s_lshl_b32 s3, s51, 2
    s_add_u32 s45, s45, s3
    s_add_u32 s44, s44, s3
    s_lshl_b32 s64, s45, 11
    s_add_u32 s64, s64, 131072
    s_mul_i32 s3, s45, 80
    s_add_u32 s3, s3, 543232
    v_lshl_add_u32 v187, v1, 2, s3
    v_mov_b32 v12, s3
    s_mul_i32 s3, s44, 80
    s_add_u32 s3, s3, 543232
    v_lshl_add_u32 v188, v1, 2, s3
    v_mov_b32 v13, s3
    v_cmp_gt_u32 vcc, 2, v4
    v_and_b32 v11, 1, v4
    v_mul_u32_u24 v9, 2560, v11
    v_cndmask_b32 v12, v13, v12, vcc
    v_lshl_add_u32 v9, v5, 2, v9
    v_add3_u32 v189, v12, v9, 64
    v_cmp_eq_u32 s[66:67], 0, v11
    v_mov_b32 v8, 0xff800000
    s_add_u32 m0, s49, 0
    s_mov_b32 s47, 0
    buffer_load_dwordx4 v148, s[4:7], s47 offen offset:0 lds
    buffer_load_dwordx4 v149, s[4:7], s47 offen offset:1024 lds
    buffer_load_dwordx4 v150, s[4:7], s47 offen offset:2048 lds
    buffer_load_dwordx4 v151, s[4:7], s47 offen offset:3072 lds
    s_add_u32 m0, s50, 0
    s_mov_b32 s48, 0
    buffer_load_dwordx4 v152, s[8:11], s48 offen offset:0 lds
    buffer_load_dwordx4 v153, s[8:11], s48 offen offset:1024 lds
    buffer_load_dwordx4 v154, s[8:11], s48 offen offset:2048 lds
    buffer_load_dwordx4 v155, s[8:11], s48 offen offset:3072 lds
    s_add_u32 m0, s50, 4096
    s_nop 0
    s_nop 0
    buffer_load_dwordx4 v156, s[8:11], s48 offen offset:0 lds
    s_add_u32 m0, s49, 73728
    s_mov_b32 s47, 128
    buffer_load_dwordx4 v148, s[4:7], s47 offen offset:0 lds
    buffer_load_dwordx4 v149, s[4:7], s47 offen offset:1024 lds
    buffer_load_dwordx4 v150, s[4:7], s47 offen offset:2048 lds
    buffer_load_dwordx4 v151, s[4:7], s47 offen offset:3072 lds
    s_add_u32 m0, s50, 73728
    s_mov_b32 s48, 245760
    buffer_load_dwordx4 v152, s[8:11], s48 offen offset:0 lds
    buffer_load_dwordx4 v153, s[8:11], s48 offen offset:1024 lds
    buffer_load_dwordx4 v154, s[8:11], s48 offen offset:2048 lds
    buffer_load_dwordx4 v155, s[8:11], s48 offen offset:3072 lds
    s_add_u32 m0, s50, 77824
    s_nop 0
    buffer_load_dwordx4 v156, s[8:11], s48 offen offset:0 lds
    s_waitcnt lgkmcnt(0)
    s_waitcnt vmcnt(9)
    s_barrier
    ds_read_b64_tr_b16 a[200:201], v162 offset:0
    ds_read_b64_tr_b16 a[202:203], v162 offset:1280
    ds_read_b128 a[184:187], v158 offset:0
    ds_read_b64_tr_b16 a[204:205], v163 offset:0
    ds_read_b64_tr_b16 a[206:207], v163 offset:1280
    ds_read_b128 a[188:191], v158 offset:2048
    ds_read_b64_tr_b16 a[208:209], v164 offset:0
    ds_read_b64_tr_b16 a[210:211], v164 offset:1280
    ds_read_b128 a[192:195], v158 offset:4096
    ds_read_b64_tr_b16 a[212:213], v165 offset:0
    ds_read_b64_tr_b16 a[214:215], v165 offset:1280
    ds_read_b128 a[196:199], v158 offset:6144
    ds_read_b64_tr_b16 a[216:217], v166 offset:0
    ds_read_b64_tr_b16 a[218:219], v166 offset:1280
    s_waitcnt lgkmcnt(11)
    s_nop 0
    v_mfma_f32_16x16x32_bf16 v[16:19], a[184:187], a[200:203], 0
    ds_read_b64_tr_b16 a[236:237], v162 offset:10240
    s_add_u32 m0, s49, 36864
    s_mov_b32 s47, 256
    buffer_load_dwordx4 v148, s[4:7], s47 offen offset:0 lds
    s_waitcnt lgkmcnt(10)
    v_mfma_f32_16x16x32_bf16 v[20:23], a[184:187], a[204:207], 0
    ds_read_b64_tr_b16 a[238:239], v162 offset:11520
    s_waitcnt lgkmcnt(10)
    v_mfma_f32_16x16x32_bf16 v[40:43], a[188:191], a[204:207], 0
    ds_read_b128 a[220:223], v159 offset:0
    buffer_load_dwordx4 v149, s[4:7], s47 offen offset:1024 lds
    v_mfma_f32_16x16x32_bf16 v[36:39], a[188:191], a[200:203], 0
    ds_read_b64_tr_b16 a[240:241], v163 offset:10240
    s_waitcnt lgkmcnt(9)
    v_mfma_f32_16x16x32_bf16 v[56:59], a[192:195], a[200:203], 0
    ds_read_b64_tr_b16 a[242:243], v163 offset:11520
    s_nop 0
    buffer_load_dwordx4 v150, s[4:7], s47 offen offset:2048 lds
    v_mfma_f32_16x16x32_bf16 v[60:63], a[192:195], a[204:207], 0
    ds_read_b128 a[224:227], v159 offset:2048
    v_mfma_f32_16x16x32_bf16 v[64:67], a[192:195], a[208:211], 0
    ds_read_b64_tr_b16 a[244:245], v164 offset:10240
    buffer_load_dwordx4 v151, s[4:7], s47 offen offset:3072 lds
    v_mfma_f32_16x16x32_bf16 v[44:47], a[188:191], a[208:211], 0
    ds_read_b64_tr_b16 a[246:247], v164 offset:11520
    v_mfma_f32_16x16x32_bf16 v[24:27], a[184:187], a[208:211], 0
    ds_read_b128 a[228:231], v159 offset:4096
    s_add_u32 m0, s50, 36864
    s_mov_b32 s48, 491520
    buffer_load_dwordx4 v152, s[8:11], s48 offen offset:0 lds
    s_waitcnt lgkmcnt(12)
    v_mfma_f32_16x16x32_bf16 v[28:31], a[184:187], a[212:215], 0
    ds_read_b64_tr_b16 a[248:249], v165 offset:10240
    s_nop 0
    v_mfma_f32_16x16x32_bf16 v[48:51], a[188:191], a[212:215], 0
    ds_read_b64_tr_b16 a[250:251], v165 offset:11520
    v_mfma_f32_16x16x32_bf16 v[68:71], a[192:195], a[212:215], 0
    ds_read_b128 a[232:235], v159 offset:6144
    buffer_load_dwordx4 v153, s[8:11], s48 offen offset:1024 lds
    s_waitcnt lgkmcnt(14)
    v_mfma_f32_16x16x32_bf16 v[88:91], a[196:199], a[212:215], 0
    ds_read_b64_tr_b16 a[252:253], v166 offset:10240
    s_nop 0
    v_mfma_f32_16x16x32_bf16 v[84:87], a[196:199], a[208:211], 0
    ds_read_b64_tr_b16 a[254:255], v166 offset:11520
    buffer_load_dwordx4 v154, s[8:11], s48 offen offset:2048 lds
    v_mfma_f32_16x16x32_bf16 v[80:83], a[196:199], a[204:207], 0
    v_mfma_f32_16x16x32_bf16 v[76:79], a[196:199], a[200:203], 0
    buffer_load_dwordx4 v155, s[8:11], s48 offen offset:3072 lds
    s_waitcnt lgkmcnt(14)
    v_mfma_f32_16x16x32_bf16 v[92:95], a[196:199], a[216:219], 0
    v_mfma_f32_16x16x32_bf16 v[72:75], a[192:195], a[216:219], 0
    s_add_u32 m0, s50, 40960
    s_nop 0
    buffer_load_dwordx4 v156, s[8:11], s48 offen offset:0 lds
    v_mfma_f32_16x16x32_bf16 v[52:55], a[188:191], a[216:219], 0
    v_mfma_f32_16x16x32_bf16 v[32:35], a[184:187], a[216:219], 0
    s_waitcnt vmcnt(9) lgkmcnt(0)
    s_barrier
    v_mfma_f32_16x16x32_bf16 v[16:19], a[220:223], a[236:239], v[16:19]
    ds_read_b64_tr_b16 a[200:201], v167 offset:0
    v_mov_b32 v147, 0x3f803f80
    v_mfma_f32_16x16x32_bf16 v[20:23], a[220:223], a[240:243], v[20:23]
    ds_read_b64_tr_b16 a[202:203], v167 offset:1280
    v_cndmask_b32 v142, 0, v138, s[66:67]
    v_mfma_f32_16x16x32_bf16 v[40:43], a[224:227], a[240:243], v[40:43]
    ds_read_b128 a[184:187], v160 offset:0
    s_add_u32 m0, s49, 0
    s_mov_b32 s47, 384
    s_nop 0
    v_cndmask_b32 v143, 0, v138, s[66:67]
    v_mfma_f32_16x16x32_bf16 v[36:39], a[224:227], a[236:239], v[36:39]
    buffer_load_dwordx4 v148, s[4:7], s47 offen offset:0 lds
    v_mfma_f32_16x16x32_bf16 v[56:59], a[228:231], a[236:239], v[56:59]
    ds_read_b64_tr_b16 a[204:205], v168 offset:0
    v_cndmask_b32 v144, 0, 1.0, s[66:67]
    v_mfma_f32_16x16x32_bf16 v[60:63], a[228:231], a[240:243], v[60:63]
    ds_read_b64_tr_b16 a[206:207], v168 offset:1280
    v_cndmask_b32 v145, 0, 1.0, s[66:67]
    v_mfma_f32_16x16x32_bf16 v[64:67], a[228:231], a[244:247], v[64:67]
    buffer_load_dwordx4 v149, s[4:7], s47 offen offset:1024 lds
    v_mfma_f32_16x16x32_bf16 v[44:47], a[224:227], a[244:247], v[44:47]
    ds_read_b128 a[188:191], v160 offset:2048
    v_cndmask_b32 v146, v8, v138, s[66:67]
    v_mfma_f32_16x16x32_bf16 v[24:27], a[220:223], a[244:247], v[24:27]
    ds_read_b64_tr_b16 a[208:209], v169 offset:0
    v_lshlrev_b32_e64 v9, 4, v2
    v_mfma_f32_16x16x32_bf16 v[28:31], a[220:223], a[248:251], v[28:31]
    buffer_load_dwordx4 v150, s[4:7], s47 offen offset:2048 lds
    v_mfma_f32_16x16x32_bf16 v[48:51], a[224:227], a[248:251], v[48:51]
    ds_read_b64_tr_b16 a[210:211], v169 offset:1280
    v_lshl_add_u32 v9, v5, 2, v9
    v_mfma_f32_16x16x32_bf16 v[68:71], a[228:231], a[248:251], v[68:71]
    ds_read_b128 a[192:195], v160 offset:4096
    v_lshl_add_u32 v180, v4, 8, v9
    v_mfma_f32_16x16x32_bf16 v[88:91], a[232:235], a[248:251], v[88:91]
    buffer_load_dwordx4 v151, s[4:7], s47 offen offset:3072 lds
    v_mfma_f32_16x16x32_bf16 v[84:87], a[232:235], a[244:247], v[84:87]
    ds_read_b64_tr_b16 a[212:213], v170 offset:0
    s_mul_i32 s3, s38, 6144
    v_mfma_f32_16x16x32_bf16 v[80:83], a[232:235], a[240:243], v[80:83]
    ds_read_b64_tr_b16 a[214:215], v170 offset:1280
    s_add_u32 m0, s50, 0
    s_mov_b32 s48, 737280
    v_add_u32 v190, s3, v7
    v_mfma_f32_16x16x32_bf16 v[76:79], a[232:235], a[236:239], v[76:79]
    buffer_load_dwordx4 v152, s[8:11], s48 offen offset:0 lds
    v_mfma_f32_16x16x32_bf16 v[92:95], a[232:235], a[252:255], v[92:95]
    ds_read_b128 a[196:199], v160 offset:6144
    s_xor_b32 s60, s38, 2
    v_mfma_f32_16x16x32_bf16 v[72:75], a[228:231], a[252:255], v[72:75]
    ds_read_b64_tr_b16 a[216:217], v171 offset:0
    s_mul_i32 s60, s60, 6144
    v_mfma_f32_16x16x32_bf16 v[52:55], a[224:227], a[252:255], v[52:55]
    ds_read_b64_tr_b16 a[218:219], v171 offset:1280
    v_add_u32 v191, s60, v7
    v_mfma_f32_16x16x32_bf16 v[32:35], a[220:223], a[252:255], v[32:35]
    s_waitcnt lgkmcnt(11)
    v_mfma_f32_16x16x32_bf16 v[16:19], a[184:187], a[200:203], v[16:19]
    ds_read_b64_tr_b16 a[236:237], v167 offset:10240
    v_lshl_add_u32 v8, v4, 4, v5
    s_waitcnt lgkmcnt(10)
    v_mfma_f32_16x16x32_bf16 v[20:23], a[184:187], a[204:207], v[20:23]
    ds_read_b64_tr_b16 a[238:239], v167 offset:11520
    v_add_u32 v8, 64, v8
    s_waitcnt lgkmcnt(10)
    v_mfma_f32_16x16x32_bf16 v[40:43], a[188:191], a[204:207], v[40:43]
    ds_read_b128 a[220:223], v161 offset:0
    v_lshlrev_b32_e64 v9, 2, v1
    v_mfma_f32_16x16x32_bf16 v[36:39], a[188:191], a[200:203], v[36:39]
    ds_read_b64_tr_b16 a[240:241], v168 offset:10240
    v_add_u32 v10, 1024, v9
    s_waitcnt lgkmcnt(9)
    v_mfma_f32_16x16x32_bf16 v[56:59], a[192:195], a[200:203], v[56:59]
    s_nop 0
    ds_read_b64_tr_b16 a[242:243], v168 offset:11520
L_pg0:
    s_cbranch_execz L_ret
    v_mov_b32 v11, 328
    v_mfma_f32_16x16x32_bf16 v[60:63], a[192:195], a[204:207], v[60:63]
    buffer_load_dwordx4 v153, s[8:11], s48 offen offset:1024 lds
    v_mfma_f32_16x16x32_bf16 v[64:67], a[192:195], a[208:211], v[64:67]
    ds_read_b128 a[224:227], v161 offset:2048
    v_cmp_eq_u32 vcc, 1, v2
    v_mfma_f32_16x16x32_bf16 v[44:47], a[188:191], a[208:211], v[44:47]
    ds_read_b64_tr_b16 a[244:245], v169 offset:10240
    v_add_u32 v12, 144, v1
    v_mfma_f32_16x16x32_bf16 v[24:27], a[184:187], a[208:211], v[24:27]
    ds_read_b64_tr_b16 a[246:247], v169 offset:11520
    s_waitcnt lgkmcnt(11)
    v_mfma_f32_16x16x32_bf16 v[28:31], a[184:187], a[212:215], v[28:31]
    ds_read_b128 a[228:231], v161 offset:4096
    v_add_u32 v13, 1280, v9
    s_nop 0
    v_mfma_f32_16x16x32_bf16 v[48:51], a[188:191], a[212:215], v[48:51]
    buffer_load_dwordx4 v154, s[8:11], s48 offen offset:2048 lds
    v_mfma_f32_16x16x32_bf16 v[68:71], a[192:195], a[212:215], v[68:71]
    ds_read_b64_tr_b16 a[248:249], v170 offset:10240
    v_mov_b32 v14, 480
    s_waitcnt lgkmcnt(12)
    v_mfma_f32_16x16x32_bf16 v[88:91], a[196:199], a[212:215], v[88:91]
    ds_read_b64_tr_b16 a[250:251], v170 offset:11520
    v_cndmask_b32 v8, v8, v12, vcc
    v_mfma_f32_16x16x32_bf16 v[84:87], a[196:199], a[208:211], v[84:87]
    ds_read_b128 a[232:235], v161 offset:6144
    v_cndmask_b32 v10, v10, v13, vcc
    v_mfma_f32_16x16x32_bf16 v[80:83], a[196:199], a[204:207], v[80:83]
    ds_read_b64_tr_b16 a[252:253], v171 offset:10240
    v_cndmask_b32 v11, v11, v14, vcc
    v_mfma_f32_16x16x32_bf16 v[76:79], a[196:199], a[200:203], v[76:79]
    ds_read_b64_tr_b16 a[254:255], v171 offset:11520
    v_cmp_eq_u32 vcc, 2, v2
    s_waitcnt lgkmcnt(14)
    v_mfma_f32_16x16x32_bf16 v[92:95], a[196:199], a[216:219], v[92:95]
    buffer_load_dwordx4 v155, s[8:11], s48 offen offset:3072 lds
    v_mfma_f32_16x16x32_bf16 v[72:75], a[192:195], a[216:219], v[72:75]
    v_add_u32 v12, 128, v1
    v_mfma_f32_16x16x32_bf16 v[52:55], a[188:191], a[216:219], v[52:55]
    s_add_u32 m0, s50, 4096
    v_mfma_f32_16x16x32_bf16 v[32:35], a[184:187], a[216:219], v[32:35]
    buffer_load_dwordx4 v156, s[8:11], s48 offen offset:0 lds
    s_waitcnt vmcnt(9) lgkmcnt(0)
    s_barrier
    v_mfma_f32_16x16x32_bf16 v[16:19], a[220:223], a[236:239], v[16:19]
    ds_read_b64_tr_b16 a[200:201], v162 offset:36864
    v_add_u32 v13, 1792, v9
    v_mfma_f32_16x16x32_bf16 v[20:23], a[220:223], a[240:243], v[20:23]
    ds_read_b64_tr_b16 a[202:203], v162 offset:38144
    v_cndmask_b32 v11, v11, v14, vcc
    v_mfma_f32_16x16x32_bf16 v[40:43], a[224:227], a[240:243], v[40:43]
    ds_read_b128 a[184:187], v158 offset:36864
    s_add_u32 m0, s49, 73728
    s_mov_b32 s47, 512
    v_cndmask_b32 v8, v8, v12, vcc
    v_mfma_f32_16x16x32_bf16 v[36:39], a[224:227], a[236:239], v[36:39]
    buffer_load_dwordx4 v148, s[4:7], s47 offen offset:0 lds
    v_mfma_f32_16x16x32_bf16 v[56:59], a[228:231], a[236:239], v[56:59]
    ds_read_b64_tr_b16 a[204:205], v163 offset:36864
    v_cndmask_b32 v10, v10, v13, vcc
    v_mfma_f32_16x16x32_bf16 v[60:63], a[228:231], a[240:243], v[60:63]
    ds_read_b64_tr_b16 a[206:207], v163 offset:38144
    v_cmp_eq_u32 vcc, 3, v2
    v_mfma_f32_16x16x32_bf16 v[64:67], a[228:231], a[244:247], v[64:67]
    buffer_load_dwordx4 v149, s[4:7], s47 offen offset:1024 lds
    v_mfma_f32_16x16x32_bf16 v[44:47], a[224:227], a[244:247], v[44:47]
    ds_read_b128 a[188:191], v158 offset:38912
    v_and_b32_e64 v14, 1, v4
    v_mfma_f32_16x16x32_bf16 v[24:27], a[220:223], a[244:247], v[24:27]
    ds_read_b64_tr_b16 a[208:209], v164 offset:36864
    v_lshlrev_b32_e64 v12, 4, v14
    v_mfma_f32_16x16x32_bf16 v[28:31], a[220:223], a[248:251], v[28:31]
    buffer_load_dwordx4 v150, s[4:7], s47 offen offset:2048 lds
    v_mfma_f32_16x16x32_bf16 v[48:51], a[224:227], a[248:251], v[48:51]
    ds_read_b64_tr_b16 a[210:211], v164 offset:38144
    v_sub_u32 v12, 208, v12
    v_mfma_f32_16x16x32_bf16 v[68:71], a[228:231], a[248:251], v[68:71]
    ds_read_b128 a[192:195], v158 offset:40960
    v_add_u32_e64 v12, v12, v5
    v_mfma_f32_16x16x32_bf16 v[88:91], a[232:235], a[248:251], v[88:91]
    buffer_load_dwordx4 v151, s[4:7], s47 offen offset:3072 lds
    v_mfma_f32_16x16x32_bf16 v[84:87], a[232:235], a[244:247], v[84:87]
    ds_read_b64_tr_b16 a[212:213], v165 offset:36864
    v_lshlrev_b32_e64 v13, 9, v14
    v_mfma_f32_16x16x32_bf16 v[80:83], a[232:235], a[240:243], v[80:83]
    ds_read_b64_tr_b16 a[214:215], v165 offset:38144
    s_add_u32 m0, s50, 73728
    s_mov_b32 s48, 983040
    v_lshl_add_u32 v13, v5, 2, v13
    v_mfma_f32_16x16x32_bf16 v[76:79], a[232:235], a[236:239], v[76:79]
    buffer_load_dwordx4 v152, s[8:11], s48 offen offset:0 lds
    v_mfma_f32_16x16x32_bf16 v[92:95], a[232:235], a[252:255], v[92:95]
    ds_read_b128 a[196:199], v158 offset:43008
    v_add_u32 v13, 1344, v13
    v_mfma_f32_16x16x32_bf16 v[72:75], a[228:231], a[252:255], v[72:75]
    ds_read_b64_tr_b16 a[216:217], v166 offset:36864
    v_cndmask_b32 v8, v8, v12, vcc
    v_mfma_f32_16x16x32_bf16 v[52:55], a[224:227], a[252:255], v[52:55]
    ds_read_b64_tr_b16 a[218:219], v166 offset:38144
    v_cndmask_b32 v10, v10, v13, vcc
    v_mfma_f32_16x16x32_bf16 v[32:35], a[220:223], a[252:255], v[32:35]
    s_waitcnt lgkmcnt(11)
    v_mfma_f32_16x16x32_bf16 v[16:19], a[184:187], a[200:203], v[16:19]
    ds_read_b64_tr_b16 a[236:237], v162 offset:47104
    v_cndmask_b32 v11, v11, 40, vcc
    s_waitcnt lgkmcnt(10)
    v_mfma_f32_16x16x32_bf16 v[20:23], a[184:187], a[204:207], v[20:23]
    ds_read_b64_tr_b16 a[238:239], v162 offset:48384
    v_lshl_add_u32 v192, v8, 4, s3
    s_waitcnt lgkmcnt(10)
    v_mfma_f32_16x16x32_bf16 v[40:43], a[188:191], a[204:207], v[40:43]
    ds_read_b128 a[220:223], v159 offset:36864
    v_xor_b32 v8, v8, v11
    v_mfma_f32_16x16x32_bf16 v[36:39], a[188:191], a[200:203], v[36:39]
    ds_read_b64_tr_b16 a[240:241], v163 offset:47104
    v_lshl_add_u32 v193, v8, 4, s60
    s_waitcnt lgkmcnt(9)
    v_mfma_f32_16x16x32_bf16 v[56:59], a[192:195], a[200:203], v[56:59]
    ds_read_b64_tr_b16 a[242:243], v163 offset:48384
    v_cmp_gt_u32 vcc, 56, v0
    v_mfma_f32_16x16x32_bf16 v[60:63], a[192:195], a[204:207], v[60:63]
    buffer_load_dwordx4 v153, s[8:11], s48 offen offset:1024 lds
    v_mfma_f32_16x16x32_bf16 v[64:67], a[192:195], a[208:211], v[64:67]
    ds_read_b128 a[224:227], v159 offset:38912
    v_mov_b32_e64 v12, 1073741824
    v_mfma_f32_16x16x32_bf16 v[44:47], a[188:191], a[208:211], v[44:47]
    ds_read_b64_tr_b16 a[244:245], v164 offset:47104
    v_min_u32_e64 v13, 1, v2
    v_mfma_f32_16x16x32_bf16 v[24:27], a[184:187], a[208:211], v[24:27]
    ds_read_b64_tr_b16 a[246:247], v164 offset:48384
    s_waitcnt lgkmcnt(11)
    v_mfma_f32_16x16x32_bf16 v[28:31], a[184:187], a[212:215], v[28:31]
    ds_read_b128 a[228:231], v159 offset:40960
    v_cndmask_b32 v181, v12, v10, vcc
    v_mfma_f32_16x16x32_bf16 v[48:51], a[188:191], a[212:215], v[48:51]
    buffer_load_dwordx4 v154, s[8:11], s48 offen offset:2048 lds
    v_mfma_f32_16x16x32_bf16 v[68:71], a[192:195], a[212:215], v[68:71]
    ds_read_b64_tr_b16 a[248:249], v165 offset:47104
    v_cmp_gt_u32 vcc, 1792, v181
    s_waitcnt lgkmcnt(12)
    v_mfma_f32_16x16x32_bf16 v[88:91], a[196:199], a[212:215], v[88:91]
    ds_read_b64_tr_b16 a[250:251], v165 offset:48384
    v_lshlrev_b32 v13, 6, v13
    v_mfma_f32_16x16x32_bf16 v[84:87], a[196:199], a[208:211], v[84:87]
    ds_read_b128 a[232:235], v159 offset:43008
    v_add_u32_e64 v13, 64, v13
    v_mfma_f32_16x16x32_bf16 v[80:83], a[196:199], a[204:207], v[80:83]
    ds_read_b64_tr_b16 a[252:253], v166 offset:47104
    v_cndmask_b32 v10, v12, v10, vcc
    v_mfma_f32_16x16x32_bf16 v[76:79], a[196:199], a[200:203], v[76:79]
    ds_read_b64_tr_b16 a[254:255], v166 offset:48384
    v_add_u32 v182, v10, v13
    s_waitcnt lgkmcnt(14)
    v_mfma_f32_16x16x32_bf16 v[92:95], a[196:199], a[216:219], v[92:95]
    buffer_load_dwordx4 v155, s[8:11], s48 offen offset:3072 lds
    v_mfma_f32_16x16x32_bf16 v[72:75], a[192:195], a[216:219], v[72:75]
    v_add_u32 v183, v182, v13
    v_mfma_f32_16x16x32_bf16 v[52:55], a[188:191], a[216:219], v[52:55]
    s_add_u32 m0, s50, 77824
    v_mfma_f32_16x16x32_bf16 v[32:35], a[184:187], a[216:219], v[32:35]
    buffer_load_dwordx4 v156, s[8:11], s48 offen offset:0 lds
    s_waitcnt vmcnt(9) lgkmcnt(0)
    s_barrier
    v_mfma_f32_16x16x32_bf16 v[16:19], a[220:223], a[236:239], v[16:19]
    ds_read_b64_tr_b16 a[200:201], v162 offset:0
    v_add_u32_e64 v184, v183, v13
    v_mfma_f32_16x16x32_bf16 v[20:23], a[220:223], a[240:243], v[20:23]
    ds_read_b64_tr_b16 a[202:203], v162 offset:1280
    s_lshl_b32 s68, s39, 3
    v_mfma_f32_16x16x32_bf16 v[40:43], a[224:227], a[240:243], v[40:43]
    ds_read_b128 a[184:187], v158 offset:0
    s_add_u32 m0, s49, 36864
    s_mov_b32 s47, 640
    s_lshr_b32 s3, s40, 2
    v_mfma_f32_16x16x32_bf16 v[36:39], a[224:227], a[236:239], v[36:39]
    buffer_load_dwordx4 v148, s[4:7], s47 offen offset:0 lds
    v_mfma_f32_16x16x32_bf16 v[56:59], a[228:231], a[236:239], v[56:59]
    ds_read_b64_tr_b16 a[204:205], v163 offset:0
    s_add_u32 s68, s68, s3
    v_mfma_f32_16x16x32_bf16 v[60:63], a[228:231], a[240:243], v[60:63]
    ds_read_b64_tr_b16 a[206:207], v163 offset:1280
    s_and_b32 s69, s40, 3
    v_mfma_f32_16x16x32_bf16 v[64:67], a[228:231], a[244:247], v[64:67]
    buffer_load_dwordx4 v149, s[4:7], s47 offen offset:1024 lds
    v_mfma_f32_16x16x32_bf16 v[44:47], a[224:227], a[244:247], v[44:47]
    ds_read_b128 a[188:191], v158 offset:2048
    v_mul_u32_u24_e64 v8, 49, v0
    v_mfma_f32_16x16x32_bf16 v[24:27], a[220:223], a[244:247], v[24:27]
    ds_read_b64_tr_b16 a[208:209], v164 offset:0
    v_lshrrev_b32_e64 v8, 10, v8
    v_mfma_f32_16x16x32_bf16 v[28:31], a[220:223], a[248:251], v[28:31]
    buffer_load_dwordx4 v150, s[4:7], s47 offen offset:2048 lds
    v_mfma_f32_16x16x32_bf16 v[48:51], a[224:227], a[248:251], v[48:51]
    ds_read_b64_tr_b16 a[210:211], v164 offset:1280
    v_mul_u32_u24_e64 v9, 21, v8
    v_mfma_f32_16x16x32_bf16 v[68:71], a[228:231], a[248:251], v[68:71]
    ds_read_b128 a[192:195], v158 offset:4096
    v_sub_u32_e64 v9, v0, v9
    v_mfma_f32_16x16x32_bf16 v[88:91], a[232:235], a[248:251], v[88:91]
    buffer_load_dwordx4 v151, s[4:7], s47 offen offset:3072 lds
    v_mfma_f32_16x16x32_bf16 v[84:87], a[232:235], a[244:247], v[84:87]
    ds_read_b64_tr_b16 a[212:213], v165 offset:0
    v_min_u32_e64 v9, 19, v9
    v_mfma_f32_16x16x32_bf16 v[80:83], a[232:235], a[240:243], v[80:83]
    ds_read_b64_tr_b16 a[214:215], v165 offset:1280
    s_add_u32 m0, s50, 36864
    s_mov_b32 s48, 1228800
    v_lshrrev_b32_e64 v10, 2, v9
    v_mfma_f32_16x16x32_bf16 v[76:79], a[232:235], a[236:239], v[76:79]
    buffer_load_dwordx4 v152, s[8:11], s48 offen offset:0 lds
    v_mfma_f32_16x16x32_bf16 v[92:95], a[232:235], a[252:255], v[92:95]
    ds_read_b128 a[196:199], v158 offset:6144
    v_and_b32 v9, 3, v9
    v_mfma_f32_16x16x32_bf16 v[72:75], a[228:231], a[252:255], v[72:75]
    ds_read_b64_tr_b16 a[216:217], v166 offset:0
    v_sub_u32 v11, 4, v10
    v_mfma_f32_16x16x32_bf16 v[52:55], a[224:227], a[252:255], v[52:55]
    ds_read_b64_tr_b16 a[218:219], v166 offset:1280
    v_cmp_eq_u32 vcc, 1, s42
    v_mfma_f32_16x16x32_bf16 v[32:35], a[220:223], a[252:255], v[32:35]
    s_waitcnt lgkmcnt(11)
    v_mfma_f32_16x16x32_bf16 v[16:19], a[184:187], a[200:203], v[16:19]
    ds_read_b64_tr_b16 a[236:237], v162 offset:10240
    v_lshlrev_b32_e64 v9, 4, v9
    s_waitcnt lgkmcnt(10)
    v_mfma_f32_16x16x32_bf16 v[20:23], a[184:187], a[204:207], v[20:23]
    ds_read_b64_tr_b16 a[238:239], v162 offset:11520
    v_mul_u32_u24 v8, 1280, v8
    s_waitcnt lgkmcnt(10)
    v_mfma_f32_16x16x32_bf16 v[40:43], a[188:191], a[204:207], v[40:43]
    ds_read_b128 a[220:223], v159 offset:0
    v_cndmask_b32 v10, v10, v11, vcc
    v_mfma_f32_16x16x32_bf16 v[36:39], a[188:191], a[200:203], v[36:39]
    ds_read_b64_tr_b16 a[240:241], v163 offset:10240
    v_lshl_add_u32 v9, v10, 6, v9
    s_waitcnt lgkmcnt(9)
    v_mfma_f32_16x16x32_bf16 v[56:59], a[192:195], a[200:203], v[56:59]
    ds_read_b64_tr_b16 a[242:243], v163 offset:11520
    s_mul_i32 s3, s38, 204800
    s_nop 0
    v_mfma_f32_16x16x32_bf16 v[60:63], a[192:195], a[204:207], v[60:63]
    buffer_load_dwordx4 v153, s[8:11], s48 offen offset:1024 lds
    v_mfma_f32_16x16x32_bf16 v[64:67], a[192:195], a[208:211], v[64:67]
    ds_read_b128 a[224:227], v159 offset:2048
    s_mul_i32 s55, s69, 320
    v_mfma_f32_16x16x32_bf16 v[44:47], a[188:191], a[208:211], v[44:47]
    ds_read_b64_tr_b16 a[244:245], v164 offset:10240
    s_add_u32 s3, s3, s55
    v_mfma_f32_16x16x32_bf16 v[24:27], a[184:187], a[208:211], v[24:27]
    ds_read_b64_tr_b16 a[246:247], v164 offset:11520
    s_waitcnt lgkmcnt(11)
    v_mfma_f32_16x16x32_bf16 v[28:31], a[184:187], a[212:215], v[28:31]
    ds_read_b128 a[228:231], v159 offset:4096
    v_add3_u32 v174, v8, v9, s3
    v_mfma_f32_16x16x32_bf16 v[48:51], a[188:191], a[212:215], v[48:51]
    buffer_load_dwordx4 v154, s[8:11], s48 offen offset:2048 lds
    v_mfma_f32_16x16x32_bf16 v[68:71], a[192:195], a[212:215], v[68:71]
    ds_read_b64_tr_b16 a[248:249], v165 offset:10240
    v_add_u32 v175, 2832, v174
    s_waitcnt lgkmcnt(12)
    v_mfma_f32_16x16x32_bf16 v[88:91], a[196:199], a[212:215], v[88:91]
    s_nop 0
    ds_read_b64_tr_b16 a[250:251], v165 offset:11520
    v_add_u32 v176, 5664, v174
    v_mfma_f32_16x16x32_bf16 v[84:87], a[196:199], a[208:211], v[84:87]
    ds_read_b128 a[232:235], v159 offset:6144
    v_add_u32 v177, 8496, v174
    v_mfma_f32_16x16x32_bf16 v[80:83], a[196:199], a[204:207], v[80:83]
    ds_read_b64_tr_b16 a[252:253], v166 offset:10240
    v_cmp_gt_u32 vcc, 21, v0
    v_mfma_f32_16x16x32_bf16 v[76:79], a[196:199], a[200:203], v[76:79]
    ds_read_b64_tr_b16 a[254:255], v166 offset:11520
    v_mov_b32_e64 v9, 1073741824
    s_waitcnt lgkmcnt(14)
    v_mfma_f32_16x16x32_bf16 v[92:95], a[196:199], a[216:219], v[92:95]
    buffer_load_dwordx4 v155, s[8:11], s48 offen offset:3072 lds
    v_mfma_f32_16x16x32_bf16 v[72:75], a[192:195], a[216:219], v[72:75]
    v_lshlrev_b32_e64 v8, 5, v6
    v_mfma_f32_16x16x32_bf16 v[52:55], a[188:191], a[216:219], v[52:55]
    s_add_u32 m0, s50, 40960
    v_mfma_f32_16x16x32_bf16 v[32:35], a[184:187], a[216:219], v[32:35]
    buffer_load_dwordx4 v156, s[8:11], s48 offen offset:0 lds
    s_waitcnt vmcnt(9) lgkmcnt(0)
    s_barrier
    v_mfma_f32_16x16x32_bf16 v[16:19], a[220:223], a[236:239], v[16:19]
    ds_read_b64_tr_b16 a[200:201], v167 offset:0
    v_cndmask_b32 v178, v9, v175, vcc
    v_mfma_f32_16x16x32_bf16 v[20:23], a[220:223], a[240:243], v[20:23]
    ds_read_b64_tr_b16 a[202:203], v167 offset:1280
    v_lshl_add_u32 v8, v5, 3, v8
    v_mfma_f32_16x16x32_bf16 v[40:43], a[224:227], a[240:243], v[40:43]
    ds_read_b128 a[184:187], v160 offset:0
    s_add_u32 m0, s49, 0
    s_mov_b32 s47, 768
    s_mul_i32 s55, s38, 14144
    v_mfma_f32_16x16x32_bf16 v[36:39], a[224:227], a[236:239], v[36:39]
    buffer_load_dwordx4 v148, s[4:7], s47 offen offset:0 lds
    v_mfma_f32_16x16x32_bf16 v[56:59], a[228:231], a[236:239], v[56:59]
    ds_read_b64_tr_b16 a[204:205], v168 offset:0
    s_add_u32 s55, s55, 50688
    v_mfma_f32_16x16x32_bf16 v[60:63], a[228:231], a[240:243], v[60:63]
    ds_read_b64_tr_b16 a[206:207], v168 offset:1280
    v_add_u32_e64 v8, s55, v8
    v_mfma_f32_16x16x32_bf16 v[64:67], a[228:231], a[244:247], v[64:67]
    buffer_load_dwordx4 v149, s[4:7], s47 offen offset:1024 lds
    v_mfma_f32_16x16x32_bf16 v[44:47], a[224:227], a[244:247], v[44:47]
    ds_read_b128 a[188:191], v160 offset:2048
    v_lshl_add_u32 v9, v4, 2, v3
    v_mfma_f32_16x16x32_bf16 v[24:27], a[220:223], a[244:247], v[24:27]
    ds_read_b64_tr_b16 a[208:209], v169 offset:0
    v_mul_u32_u24 v9, 336, v9
    v_mfma_f32_16x16x32_bf16 v[28:31], a[220:223], a[248:251], v[28:31]
    buffer_load_dwordx4 v150, s[4:7], s47 offen offset:2048 lds
    v_mfma_f32_16x16x32_bf16 v[48:51], a[224:227], a[248:251], v[48:51]
    ds_read_b64_tr_b16 a[210:211], v169 offset:1280
    v_add_u32_e64 v236, v8, v9
    v_mfma_f32_16x16x32_bf16 v[68:71], a[228:231], a[248:251], v[68:71]
    ds_read_b128 a[192:195], v160 offset:4096
    v_lshrrev_b32_e64 v9, 1, v4
    v_mfma_f32_16x16x32_bf16 v[88:91], a[232:235], a[248:251], v[88:91]
    buffer_load_dwordx4 v151, s[4:7], s47 offen offset:3072 lds
    v_mfma_f32_16x16x32_bf16 v[84:87], a[232:235], a[244:247], v[84:87]
    ds_read_b64_tr_b16 a[212:213], v170 offset:0
    v_mul_u32_u24_e64 v9, 20, v9
    v_mfma_f32_16x16x32_bf16 v[80:83], a[232:235], a[240:243], v[80:83]
    ds_read_b64_tr_b16 a[214:215], v170 offset:1280
    s_add_u32 m0, s50, 0
    s_mov_b32 s48, 1474560
    v_and_b32 v10, 1, v4
    v_mfma_f32_16x16x32_bf16 v[76:79], a[232:235], a[236:239], v[76:79]
    buffer_load_dwordx4 v152, s[8:11], s48 offen offset:0 lds
    v_mfma_f32_16x16x32_bf16 v[92:95], a[232:235], a[252:255], v[92:95]
    ds_read_b128 a[196:199], v160 offset:6144
    v_lshl_add_u32 v10, v3, 1, v10
    v_mfma_f32_16x16x32_bf16 v[72:75], a[228:231], a[252:255], v[72:75]
    ds_read_b64_tr_b16 a[216:217], v171 offset:0
    v_add3_u32 v9, v9, v10, 16
    v_mfma_f32_16x16x32_bf16 v[52:55], a[224:227], a[252:255], v[52:55]
    ds_read_b64_tr_b16 a[218:219], v171 offset:1280
    v_mul_u32_u24 v9, 336, v9
    v_mfma_f32_16x16x32_bf16 v[32:35], a[220:223], a[252:255], v[32:35]
    v_add_u32 v237, v8, v9
    s_waitcnt lgkmcnt(11)
    v_mfma_f32_16x16x32_bf16 v[16:19], a[184:187], a[200:203], v[16:19]
    ds_read_b64_tr_b16 a[236:237], v167 offset:10240
    s_waitcnt lgkmcnt(10)
    v_mfma_f32_16x16x32_bf16 v[20:23], a[184:187], a[204:207], v[20:23]
    ds_read_b64_tr_b16 a[238:239], v167 offset:11520
    s_waitcnt lgkmcnt(10)
    v_mfma_f32_16x16x32_bf16 v[40:43], a[188:191], a[204:207], v[40:43]
    ds_read_b128 a[220:223], v161 offset:0
    v_mfma_f32_16x16x32_bf16 v[36:39], a[188:191], a[200:203], v[36:39]
    ds_read_b64_tr_b16 a[240:241], v168 offset:10240
    s_waitcnt lgkmcnt(9)
    v_mfma_f32_16x16x32_bf16 v[56:59], a[192:195], a[200:203], v[56:59]
    ds_read_b64_tr_b16 a[242:243], v168 offset:11520
    s_nop 0
    v_mfma_f32_16x16x32_bf16 v[60:63], a[192:195], a[204:207], v[60:63]
    buffer_load_dwordx4 v153, s[8:11], s48 offen offset:1024 lds
    v_mfma_f32_16x16x32_bf16 v[64:67], a[192:195], a[208:211], v[64:67]
    ds_read_b128 a[224:227], v161 offset:2048
    v_mfma_f32_16x16x32_bf16 v[44:47], a[188:191], a[208:211], v[44:47]
    ds_read_b64_tr_b16 a[244:245], v169 offset:10240
    v_mfma_f32_16x16x32_bf16 v[24:27], a[184:187], a[208:211], v[24:27]
    ds_read_b64_tr_b16 a[246:247], v169 offset:11520
    s_waitcnt lgkmcnt(11)
    v_mfma_f32_16x16x32_bf16 v[28:31], a[184:187], a[212:215], v[28:31]
    ds_read_b128 a[228:231], v161 offset:4096
    v_mfma_f32_16x16x32_bf16 v[48:51], a[188:191], a[212:215], v[48:51]
    buffer_load_dwordx4 v154, s[8:11], s48 offen offset:2048 lds
    v_mfma_f32_16x16x32_bf16 v[68:71], a[192:195], a[212:215], v[68:71]
    ds_read_b64_tr_b16 a[248:249], v170 offset:10240
    s_waitcnt lgkmcnt(12)
    v_mfma_f32_16x16x32_bf16 v[88:91], a[196:199], a[212:215], v[88:91]
    ds_read_b64_tr_b16 a[250:251], v170 offset:11520
    v_mfma_f32_16x16x32_bf16 v[84:87], a[196:199], a[208:211], v[84:87]
    ds_read_b128 a[232:235], v161 offset:6144
    v_mfma_f32_16x16x32_bf16 v[80:83], a[196:199], a[204:207], v[80:83]
    ds_read_b64_tr_b16 a[252:253], v171 offset:10240
    v_mfma_f32_16x16x32_bf16 v[76:79], a[196:199], a[200:203], v[76:79]
    ds_read_b64_tr_b16 a[254:255], v171 offset:11520
    s_waitcnt lgkmcnt(14)
    s_nop 0
    v_mfma_f32_16x16x32_bf16 v[92:95], a[196:199], a[216:219], v[92:95]
    buffer_load_dwordx4 v155, s[8:11], s48 offen offset:3072 lds
    v_mfma_f32_16x16x32_bf16 v[72:75], a[192:195], a[216:219], v[72:75]
    v_mfma_f32_16x16x32_bf16 v[52:55], a[188:191], a[216:219], v[52:55]
    s_add_u32 m0, s50, 4096
    v_mfma_f32_16x16x32_bf16 v[32:35], a[184:187], a[216:219], v[32:35]
    buffer_load_dwordx4 v156, s[8:11], s48 offen offset:0 lds
    s_waitcnt vmcnt(9) lgkmcnt(0)
    s_barrier
    v_mfma_f32_16x16x32_bf16 v[16:19], a[220:223], a[236:239], v[16:19]
    ds_read_b64_tr_b16 a[200:201], v162 offset:36864
    v_mfma_f32_16x16x32_bf16 v[20:23], a[220:223], a[240:243], v[20:23]
    ds_read_b64_tr_b16 a[202:203], v162 offset:38144
    v_mfma_f32_16x16x32_bf16 v[40:43], a[224:227], a[240:243], v[40:43]
    ds_read_b128 a[184:187], v158 offset:36864
    s_add_u32 m0, s49, 73728
    s_mov_b32 s47, 896
    v_mfma_f32_16x16x32_bf16 v[36:39], a[224:227], a[236:239], v[36:39]
    buffer_load_dwordx4 v148, s[4:7], s47 offen offset:0 lds
    v_mfma_f32_16x16x32_bf16 v[56:59], a[228:231], a[236:239], v[56:59]
    ds_read_b64_tr_b16 a[204:205], v163 offset:36864
    v_mfma_f32_16x16x32_bf16 v[60:63], a[228:231], a[240:243], v[60:63]
    ds_read_b64_tr_b16 a[206:207], v163 offset:38144
    v_mfma_f32_16x16x32_bf16 v[64:67], a[228:231], a[244:247], v[64:67]
    buffer_load_dwordx4 v149, s[4:7], s47 offen offset:1024 lds
    v_mfma_f32_16x16x32_bf16 v[44:47], a[224:227], a[244:247], v[44:47]
    ds_read_b128 a[188:191], v158 offset:38912
    v_mfma_f32_16x16x32_bf16 v[24:27], a[220:223], a[244:247], v[24:27]
    ds_read_b64_tr_b16 a[208:209], v164 offset:36864
    v_mfma_f32_16x16x32_bf16 v[28:31], a[220:223], a[248:251], v[28:31]
    buffer_load_dwordx4 v150, s[4:7], s47 offen offset:2048 lds
    v_mfma_f32_16x16x32_bf16 v[48:51], a[224:227], a[248:251], v[48:51]
    ds_read_b64_tr_b16 a[210:211], v164 offset:38144
    v_mfma_f32_16x16x32_bf16 v[68:71], a[228:231], a[248:251], v[68:71]
    ds_read_b128 a[192:195], v158 offset:40960
    v_mfma_f32_16x16x32_bf16 v[88:91], a[232:235], a[248:251], v[88:91]
    buffer_load_dwordx4 v151, s[4:7], s47 offen offset:3072 lds
    v_mfma_f32_16x16x32_bf16 v[84:87], a[232:235], a[244:247], v[84:87]
    ds_read_b64_tr_b16 a[212:213], v165 offset:36864
    v_mfma_f32_16x16x32_bf16 v[80:83], a[232:235], a[240:243], v[80:83]
    ds_read_b64_tr_b16 a[214:215], v165 offset:38144
    s_add_u32 m0, s50, 73728
    s_mov_b32 s48, 1720320
    v_mfma_f32_16x16x32_bf16 v[76:79], a[232:235], a[236:239], v[76:79]
    buffer_load_dwordx4 v152, s[8:11], s48 offen offset:0 lds
    v_mfma_f32_16x16x32_bf16 v[92:95], a[232:235], a[252:255], v[92:95]
    ds_read_b128 a[196:199], v158 offset:43008
    v_mfma_f32_16x16x32_bf16 v[72:75], a[228:231], a[252:255], v[72:75]
    ds_read_b64_tr_b16 a[216:217], v166 offset:36864
    v_mfma_f32_16x16x32_bf16 v[52:55], a[224:227], a[252:255], v[52:55]
    ds_read_b64_tr_b16 a[218:219], v166 offset:38144
    v_mfma_f32_16x16x32_bf16 v[32:35], a[220:223], a[252:255], v[32:35]
    s_waitcnt lgkmcnt(11)
    v_mfma_f32_16x16x32_bf16 v[16:19], a[184:187], a[200:203], v[16:19]
    ds_read_b64_tr_b16 a[236:237], v162 offset:47104
    s_waitcnt lgkmcnt(10)
    v_mfma_f32_16x16x32_bf16 v[20:23], a[184:187], a[204:207], v[20:23]
    ds_read_b64_tr_b16 a[238:239], v162 offset:48384
    s_waitcnt lgkmcnt(10)
    v_mfma_f32_16x16x32_bf16 v[40:43], a[188:191], a[204:207], v[40:43]
    ds_read_b128 a[220:223], v159 offset:36864
    v_mfma_f32_16x16x32_bf16 v[36:39], a[188:191], a[200:203], v[36:39]
    ds_read_b64_tr_b16 a[240:241], v163 offset:47104
    s_waitcnt lgkmcnt(9)
    v_mfma_f32_16x16x32_bf16 v[56:59], a[192:195], a[200:203], v[56:59]
    ds_read_b64_tr_b16 a[242:243], v163 offset:48384
    v_mfma_f32_16x16x32_bf16 v[60:63], a[192:195], a[204:207], v[60:63]
    buffer_load_dwordx4 v153, s[8:11], s48 offen offset:1024 lds
    v_mfma_f32_16x16x32_bf16 v[64:67], a[192:195], a[208:211], v[64:67]
    ds_read_b128 a[224:227], v159 offset:38912
    v_mfma_f32_16x16x32_bf16 v[44:47], a[188:191], a[208:211], v[44:47]
    ds_read_b64_tr_b16 a[244:245], v164 offset:47104
    v_mfma_f32_16x16x32_bf16 v[24:27], a[184:187], a[208:211], v[24:27]
    ds_read_b64_tr_b16 a[246:247], v164 offset:48384
    s_waitcnt lgkmcnt(11)
    s_nop 0
    v_mfma_f32_16x16x32_bf16 v[28:31], a[184:187], a[212:215], v[28:31]
    ds_read_b128 a[228:231], v159 offset:40960
    v_mfma_f32_16x16x32_bf16 v[48:51], a[188:191], a[212:215], v[48:51]
    buffer_load_dwordx4 v154, s[8:11], s48 offen offset:2048 lds
    v_mfma_f32_16x16x32_bf16 v[68:71], a[192:195], a[212:215], v[68:71]
    ds_read_b64_tr_b16 a[248:249], v165 offset:47104
    s_waitcnt lgkmcnt(12)
    v_mfma_f32_16x16x32_bf16 v[88:91], a[196:199], a[212:215], v[88:91]
    s_nop 0
    ds_read_b64_tr_b16 a[250:251], v165 offset:48384
    v_mfma_f32_16x16x32_bf16 v[84:87], a[196:199], a[208:211], v[84:87]
    ds_read_b128 a[232:235], v159 offset:43008
    v_mfma_f32_16x16x32_bf16 v[80:83], a[196:199], a[204:207], v[80:83]
    ds_read_b64_tr_b16 a[252:253], v166 offset:47104
    v_mfma_f32_16x16x32_bf16 v[76:79], a[196:199], a[200:203], v[76:79]
    ds_read_b64_tr_b16 a[254:255], v166 offset:48384
    s_waitcnt lgkmcnt(14)
    s_nop 0
    v_mfma_f32_16x16x32_bf16 v[92:95], a[196:199], a[216:219], v[92:95]
    buffer_load_dwordx4 v155, s[8:11], s48 offen offset:3072 lds
    v_mfma_f32_16x16x32_bf16 v[72:75], a[192:195], a[216:219], v[72:75]
    v_mfma_f32_16x16x32_bf16 v[52:55], a[188:191], a[216:219], v[52:55]
    s_add_u32 m0, s50, 77824
    v_mfma_f32_16x16x32_bf16 v[32:35], a[184:187], a[216:219], v[32:35]
    buffer_load_dwordx4 v156, s[8:11], s48 offen offset:0 lds
    s_waitcnt vmcnt(9) lgkmcnt(0)
    s_barrier
    v_mfma_f32_16x16x32_bf16 v[16:19], a[220:223], a[236:239], v[16:19]
    ds_read_b64_tr_b16 a[200:201], v162 offset:0
    v_mfma_f32_16x16x32_bf16 v[20:23], a[220:223], a[240:243], v[20:23]
    ds_read_b64_tr_b16 a[202:203], v162 offset:1280
    v_mfma_f32_16x16x32_bf16 v[40:43], a[224:227], a[240:243], v[40:43]
    ds_read_b128 a[184:187], v158 offset:0
    s_add_u32 m0, s49, 36864
    s_mov_b32 s47, 1024
    v_mfma_f32_16x16x32_bf16 v[36:39], a[224:227], a[236:239], v[36:39]
    buffer_load_dwordx4 v148, s[4:7], s47 offen offset:0 lds
    v_mfma_f32_16x16x32_bf16 v[56:59], a[228:231], a[236:239], v[56:59]
    ds_read_b64_tr_b16 a[204:205], v163 offset:0
    v_mfma_f32_16x16x32_bf16 v[60:63], a[228:231], a[240:243], v[60:63]
    ds_read_b64_tr_b16 a[206:207], v163 offset:1280
    v_mfma_f32_16x16x32_bf16 v[64:67], a[228:231], a[244:247], v[64:67]
    buffer_load_dwordx4 v149, s[4:7], s47 offen offset:1024 lds
    v_mfma_f32_16x16x32_bf16 v[44:47], a[224:227], a[244:247], v[44:47]
    ds_read_b128 a[188:191], v158 offset:2048
    v_mfma_f32_16x16x32_bf16 v[24:27], a[220:223], a[244:247], v[24:27]
    ds_read_b64_tr_b16 a[208:209], v164 offset:0
    v_mfma_f32_16x16x32_bf16 v[28:31], a[220:223], a[248:251], v[28:31]
    buffer_load_dwordx4 v150, s[4:7], s47 offen offset:2048 lds
    v_mfma_f32_16x16x32_bf16 v[48:51], a[224:227], a[248:251], v[48:51]
    ds_read_b64_tr_b16 a[210:211], v164 offset:1280
    v_mfma_f32_16x16x32_bf16 v[68:71], a[228:231], a[248:251], v[68:71]
    ds_read_b128 a[192:195], v158 offset:4096
    v_mfma_f32_16x16x32_bf16 v[88:91], a[232:235], a[248:251], v[88:91]
    buffer_load_dwordx4 v151, s[4:7], s47 offen offset:3072 lds
    v_mfma_f32_16x16x32_bf16 v[84:87], a[232:235], a[244:247], v[84:87]
    ds_read_b64_tr_b16 a[212:213], v165 offset:0
    v_mfma_f32_16x16x32_bf16 v[80:83], a[232:235], a[240:243], v[80:83]
    ds_read_b64_tr_b16 a[214:215], v165 offset:1280
    s_add_u32 m0, s50, 36864
    s_mov_b32 s48, 1966080
    v_mfma_f32_16x16x32_bf16 v[76:79], a[232:235], a[236:239], v[76:79]
    buffer_load_dwordx4 v152, s[8:11], s48 offen offset:0 lds
    v_mfma_f32_16x16x32_bf16 v[92:95], a[232:235], a[252:255], v[92:95]
    ds_read_b128 a[196:199], v158 offset:6144
    v_mfma_f32_16x16x32_bf16 v[72:75], a[228:231], a[252:255], v[72:75]
    ds_read_b64_tr_b16 a[216:217], v166 offset:0
    v_mfma_f32_16x16x32_bf16 v[52:55], a[224:227], a[252:255], v[52:55]
    ds_read_b64_tr_b16 a[218:219], v166 offset:1280
    v_mfma_f32_16x16x32_bf16 v[32:35], a[220:223], a[252:255], v[32:35]
    s_waitcnt lgkmcnt(11)
    v_mfma_f32_16x16x32_bf16 v[16:19], a[184:187], a[200:203], v[16:19]
    ds_read_b64_tr_b16 a[236:237], v162 offset:10240
    s_waitcnt lgkmcnt(10)
    v_mfma_f32_16x16x32_bf16 v[20:23], a[184:187], a[204:207], v[20:23]
    ds_read_b64_tr_b16 a[238:239], v162 offset:11520
    s_waitcnt lgkmcnt(10)
    v_mfma_f32_16x16x32_bf16 v[40:43], a[188:191], a[204:207], v[40:43]
    ds_read_b128 a[220:223], v159 offset:0
    v_mfma_f32_16x16x32_bf16 v[36:39], a[188:191], a[200:203], v[36:39]
    ds_read_b64_tr_b16 a[240:241], v163 offset:10240
    s_waitcnt lgkmcnt(9)
    v_mfma_f32_16x16x32_bf16 v[56:59], a[192:195], a[200:203], v[56:59]
    global_load_dword v195, v196, s[36:37] offset:128 sc1
    v_mfma_f32_16x16x32_bf16 v[60:63], a[192:195], a[204:207], v[60:63]
    ds_read_b64_tr_b16 a[242:243], v163 offset:11520
    v_mfma_f32_16x16x32_bf16 v[64:67], a[192:195], a[208:211], v[64:67]
    ds_read_b128 a[224:227], v159 offset:2048
    v_mfma_f32_16x16x32_bf16 v[44:47], a[188:191], a[208:211], v[44:47]
    ds_read_b64_tr_b16 a[244:245], v164 offset:10240
    v_mfma_f32_16x16x32_bf16 v[24:27], a[184:187], a[208:211], v[24:27]
    buffer_load_dwordx4 v153, s[8:11], s48 offen offset:1024 lds
    s_waitcnt lgkmcnt(10)
    s_nop 0
    v_mfma_f32_16x16x32_bf16 v[28:31], a[184:187], a[212:215], v[28:31]
L_pg1:
    s_cbranch_execz L_ret
    ds_read_b64_tr_b16 a[246:247], v164 offset:11520
    v_mfma_f32_16x16x32_bf16 v[48:51], a[188:191], a[212:215], v[48:51]
    ds_read_b128 a[228:231], v159 offset:4096
    v_mfma_f32_16x16x32_bf16 v[68:71], a[192:195], a[212:215], v[68:71]
    ds_read_b64_tr_b16 a[248:249], v165 offset:10240
    s_waitcnt lgkmcnt(12)
    v_mfma_f32_16x16x32_bf16 v[88:91], a[196:199], a[212:215], v[88:91]
    buffer_load_dwordx4 v154, s[8:11], s48 offen offset:2048 lds
    v_mfma_f32_16x16x32_bf16 v[84:87], a[196:199], a[208:211], v[84:87]
    ds_read_b64_tr_b16 a[250:251], v165 offset:11520
    v_mfma_f32_16x16x32_bf16 v[80:83], a[196:199], a[204:207], v[80:83]
    ds_read_b128 a[232:235], v159 offset:6144
    v_mfma_f32_16x16x32_bf16 v[76:79], a[196:199], a[200:203], v[76:79]
    ds_read_b64_tr_b16 a[252:253], v166 offset:10240
    s_waitcnt lgkmcnt(13)
    s_nop 0
    v_mfma_f32_16x16x32_bf16 v[92:95], a[196:199], a[216:219], v[92:95]
    ds_read_b64_tr_b16 a[254:255], v166 offset:11520
    v_mfma_f32_16x16x32_bf16 v[72:75], a[192:195], a[216:219], v[72:75]
    buffer_load_dwordx4 v155, s[8:11], s48 offen offset:3072 lds
    v_mfma_f32_16x16x32_bf16 v[52:55], a[188:191], a[216:219], v[52:55]
    s_add_u32 m0, s50, 40960
    v_mfma_f32_16x16x32_bf16 v[32:35], a[184:187], a[216:219], v[32:35]
    buffer_load_dwordx4 v156, s[8:11], s48 offen offset:0 lds
    s_waitcnt vmcnt(10) lgkmcnt(0)
    s_barrier
    v_mfma_f32_16x16x32_bf16 v[16:19], a[220:223], a[236:239], v[16:19]
    ds_read_b64_tr_b16 a[200:201], v167 offset:0
    v_mfma_f32_16x16x32_bf16 v[20:23], a[220:223], a[240:243], v[20:23]
    ds_read_b64_tr_b16 a[202:203], v167 offset:1280
    v_mfma_f32_16x16x32_bf16 v[40:43], a[224:227], a[240:243], v[40:43]
    ds_read_b128 a[184:187], v160 offset:0
    s_add_u32 m0, s49, 0
    s_nop 0
    s_mov_b32 s47, 1152
    v_mfma_f32_16x16x32_bf16 v[36:39], a[224:227], a[236:239], v[36:39]
    buffer_load_dwordx4 v148, s[4:7], s47 offen offset:0 lds
    v_mfma_f32_16x16x32_bf16 v[56:59], a[228:231], a[236:239], v[56:59]
    ds_read_b64_tr_b16 a[204:205], v168 offset:0
    v_mfma_f32_16x16x32_bf16 v[60:63], a[228:231], a[240:243], v[60:63]
    ds_read_b64_tr_b16 a[206:207], v168 offset:1280
    v_mfma_f32_16x16x32_bf16 v[64:67], a[228:231], a[244:247], v[64:67]
    buffer_load_dwordx4 v149, s[4:7], s47 offen offset:1024 lds
    v_mfma_f32_16x16x32_bf16 v[44:47], a[224:227], a[244:247], v[44:47]
    ds_read_b128 a[188:191], v160 offset:2048
    v_mfma_f32_16x16x32_bf16 v[24:27], a[220:223], a[244:247], v[24:27]
    ds_read_b64_tr_b16 a[208:209], v169 offset:0
    v_mfma_f32_16x16x32_bf16 v[28:31], a[220:223], a[248:251], v[28:31]
    buffer_load_dwordx4 v150, s[4:7], s47 offen offset:2048 lds
    v_mfma_f32_16x16x32_bf16 v[48:51], a[224:227], a[248:251], v[48:51]
    ds_read_b64_tr_b16 a[210:211], v169 offset:1280
    v_mfma_f32_16x16x32_bf16 v[68:71], a[228:231], a[248:251], v[68:71]
    ds_read_b128 a[192:195], v160 offset:4096
    v_mfma_f32_16x16x32_bf16 v[88:91], a[232:235], a[248:251], v[88:91]
    buffer_load_dwordx4 v151, s[4:7], s47 offen offset:3072 lds
    v_mfma_f32_16x16x32_bf16 v[84:87], a[232:235], a[244:247], v[84:87]
    ds_read_b64_tr_b16 a[212:213], v170 offset:0
    v_mfma_f32_16x16x32_bf16 v[80:83], a[232:235], a[240:243], v[80:83]
    ds_read_b64_tr_b16 a[214:215], v170 offset:1280
    s_add_u32 m0, s50, 0
    s_mov_b32 s48, 2211840
    v_mfma_f32_16x16x32_bf16 v[76:79], a[232:235], a[236:239], v[76:79]
    s_nop 0
    buffer_load_dwordx4 v152, s[8:11], s48 offen offset:0 lds
    v_mfma_f32_16x16x32_bf16 v[92:95], a[232:235], a[252:255], v[92:95]
    ds_read_b128 a[196:199], v160 offset:6144
    v_mfma_f32_16x16x32_bf16 v[72:75], a[228:231], a[252:255], v[72:75]
    ds_read_b64_tr_b16 a[216:217], v171 offset:0
    v_mfma_f32_16x16x32_bf16 v[52:55], a[224:227], a[252:255], v[52:55]
    ds_read_b64_tr_b16 a[218:219], v171 offset:1280
    v_mfma_f32_16x16x32_bf16 v[32:35], a[220:223], a[252:255], v[32:35]
    s_waitcnt lgkmcnt(11)
    v_mfma_f32_16x16x32_bf16 v[16:19], a[184:187], a[200:203], v[16:19]
    ds_read_b64_tr_b16 a[236:237], v167 offset:10240
    s_waitcnt lgkmcnt(10)
    v_mfma_f32_16x16x32_bf16 v[20:23], a[184:187], a[204:207], v[20:23]
    ds_read_b64_tr_b16 a[238:239], v167 offset:11520
    s_waitcnt lgkmcnt(10)
    v_mfma_f32_16x16x32_bf16 v[40:43], a[188:191], a[204:207], v[40:43]
    ds_read_b128 a[220:223], v161 offset:0
    v_mfma_f32_16x16x32_bf16 v[36:39], a[188:191], a[200:203], v[36:39]
    ds_read_b64_tr_b16 a[240:241], v168 offset:10240
    s_waitcnt lgkmcnt(9)
    v_mfma_f32_16x16x32_bf16 v[56:59], a[192:195], a[200:203], v[56:59]
    buffer_load_dwordx4 v153, s[8:11], s48 offen offset:1024 lds
    v_mfma_f32_16x16x32_bf16 v[60:63], a[192:195], a[204:207], v[60:63]
    ds_read_b64_tr_b16 a[242:243], v168 offset:11520
    v_mfma_f32_16x16x32_bf16 v[64:67], a[192:195], a[208:211], v[64:67]
    ds_read_b128 a[224:227], v161 offset:2048
    v_mfma_f32_16x16x32_bf16 v[44:47], a[188:191], a[208:211], v[44:47]
    ds_read_b64_tr_b16 a[244:245], v169 offset:10240
    v_mfma_f32_16x16x32_bf16 v[24:27], a[184:187], a[208:211], v[24:27]
    buffer_load_dwordx4 v154, s[8:11], s48 offen offset:2048 lds
    s_waitcnt lgkmcnt(10)
    v_mfma_f32_16x16x32_bf16 v[28:31], a[184:187], a[212:215], v[28:31]
    ds_read_b64_tr_b16 a[246:247], v169 offset:11520
    v_mfma_f32_16x16x32_bf16 v[48:51], a[188:191], a[212:215], v[48:51]
    ds_read_b128 a[228:231], v161 offset:4096
    v_mfma_f32_16x16x32_bf16 v[68:71], a[192:195], a[212:215], v[68:71]
    ds_read_b64_tr_b16 a[248:249], v170 offset:10240
    s_waitcnt lgkmcnt(12)
    v_mfma_f32_16x16x32_bf16 v[88:91], a[196:199], a[212:215], v[88:91]
    buffer_load_dwordx4 v155, s[8:11], s48 offen offset:3072 lds
    v_mfma_f32_16x16x32_bf16 v[84:87], a[196:199], a[208:211], v[84:87]
    ds_read_b64_tr_b16 a[250:251], v170 offset:11520
    v_mfma_f32_16x16x32_bf16 v[80:83], a[196:199], a[204:207], v[80:83]
    ds_read_b128 a[232:235], v161 offset:6144
    s_waitcnt vmcnt(12)
    v_cmp_gt_u32 vcc, 1, v195
    v_mfma_f32_16x16x32_bf16 v[76:79], a[196:199], a[200:203], v[76:79]
    ds_read_b64_tr_b16 a[252:253], v171 offset:10240
    s_waitcnt lgkmcnt(13)
    v_mfma_f32_16x16x32_bf16 v[92:95], a[196:199], a[216:219], v[92:95]
    ds_read_b64_tr_b16 a[254:255], v171 offset:11520
    s_add_u32 m0, s50, 4096
    s_cbranch_vccz L_ok_7
    s_mov_b32 s43, 0
L_spin_8:
    s_sleep 4
    global_load_dword v195, v196, s[36:37] offset:128 sc1
    s_add_u32 s43, s43, 1
    s_cmp_ge_u32 s43, 20000
    s_waitcnt vmcnt(0)
    s_cbranch_scc1 L_ok_7
    v_cmp_gt_u32 vcc, 1, v195
    s_nop 1
    s_cbranch_vccnz L_spin_8
L_ok_7:
    v_mfma_f32_16x16x32_bf16 v[72:75], a[192:195], a[216:219], v[72:75]
    buffer_load_dwordx4 v156, s[8:11], s48 offen offset:0 lds
    v_mfma_f32_16x16x32_bf16 v[52:55], a[188:191], a[216:219], v[52:55]
    v_mfma_f32_16x16x32_bf16 v[32:35], a[184:187], a[216:219], v[32:35]
    s_lshl_b32 s0, s40, 2
    s_add_u32 s0, s0, s38
    s_lshl_b32 s0, s0, 7
    s_min_u32 s0, s0, L_end-L_phaseB
    v_mov_b32 v15, s0
    s_getpc_b64 s[0:1]
L_pc_6:
    s_add_u32 s0, s0, L_phaseB-L_pc_6
    s_addc_u32 s1, s1, 0
    global_load_dword v255, v15, s[0:1]
    s_waitcnt vmcnt(10) lgkmcnt(0)
    s_barrier
    v_mfma_f32_16x16x32_bf16 v[16:19], a[220:223], a[236:239], v[16:19]
    ds_read_b64_tr_b16 a[200:201], v162 offset:36864
    buffer_load_dwordx2 v[198:199], v186, s[28:31], 0 offen sc1
    v_mfma_f32_16x16x32_bf16 v[20:23], a[220:223], a[240:243], v[20:23]
    ds_read_b64_tr_b16 a[202:203], v162 offset:38144
    v_mfma_f32_16x16x32_bf16 v[40:43], a[224:227], a[240:243], v[40:43]
    ds_read_b128 a[184:187], v158 offset:36864
    buffer_load_dword v128, v187, s[28:31], 0 offen offset:0 sc1
    v_mfma_f32_16x16x32_bf16 v[36:39], a[224:227], a[236:239], v[36:39]
    ds_read_b64_tr_b16 a[204:205], v163 offset:36864
    v_mfma_f32_16x16x32_bf16 v[56:59], a[228:231], a[236:239], v[56:59]
    ds_read_b64_tr_b16 a[206:207], v163 offset:38144
    buffer_load_dword v130, v187, s[28:31], 0 offen offset:2560 sc1
    v_mfma_f32_16x16x32_bf16 v[60:63], a[228:231], a[240:243], v[60:63]
    v_mfma_f32_16x16x32_bf16 v[64:67], a[228:231], a[244:247], v[64:67]
    ds_read_b128 a[188:191], v158 offset:38912
    buffer_load_dword v132, v188, s[28:31], 0 offen offset:0 sc1
    v_mfma_f32_16x16x32_bf16 v[44:47], a[224:227], a[244:247], v[44:47]
    ds_read_b64_tr_b16 a[208:209], v164 offset:36864
    v_mfma_f32_16x16x32_bf16 v[24:27], a[220:223], a[244:247], v[24:27]
    ds_read_b64_tr_b16 a[210:211], v164 offset:38144
    buffer_load_dword v134, v188, s[28:31], 0 offen offset:2560 sc1
    v_mfma_f32_16x16x32_bf16 v[28:31], a[220:223], a[248:251], v[28:31]
    ds_read_b128 a[192:195], v158 offset:40960
    v_mfma_f32_16x16x32_bf16 v[48:51], a[224:227], a[248:251], v[48:51]
    ds_read_b64_tr_b16 a[212:213], v165 offset:36864
    v_mfma_f32_16x16x32_bf16 v[68:71], a[228:231], a[248:251], v[68:71]
    buffer_load_dword v136, v189, s[28:31], 0 offen offset:0 sc1
    v_mfma_f32_16x16x32_bf16 v[88:91], a[232:235], a[248:251], v[88:91]
    ds_read_b64_tr_b16 a[214:215], v165 offset:38144
    v_mfma_f32_16x16x32_bf16 v[84:87], a[232:235], a[244:247], v[84:87]
    ds_read_b128 a[196:199], v158 offset:43008
    s_add_u32 m0, s55, 56576
    s_mov_b32 s47, 0
    buffer_load_dwordx4 v174, s[12:15], s47 offen offset:0 lds
    s_nop 0
    v_mfma_f32_16x16x32_bf16 v[80:83], a[232:235], a[240:243], v[80:83]
    ds_read_b64_tr_b16 a[216:217], v166 offset:36864
    v_mfma_f32_16x16x32_bf16 v[76:79], a[232:235], a[236:239], v[76:79]
    ds_read_b64_tr_b16 a[218:219], v166 offset:38144
    buffer_load_dwordx4 v175, s[12:15], s47 offen offset:1008 lds
    v_mfma_f32_16x16x32_bf16 v[92:95], a[232:235], a[252:255], v[92:95]
    v_mfma_f32_16x16x32_bf16 v[72:75], a[228:231], a[252:255], v[72:75]
    buffer_load_dwordx4 v176, s[12:15], s47 offen offset:2016 lds
    v_mfma_f32_16x16x32_bf16 v[52:55], a[224:227], a[252:255], v[52:55]
    v_mfma_f32_16x16x32_bf16 v[32:35], a[220:223], a[252:255], v[32:35]
    s_waitcnt lgkmcnt(11)
    v_mfma_f32_16x16x32_bf16 v[16:19], a[184:187], a[200:203], v[16:19]
    ds_read_b64_tr_b16 a[236:237], v162 offset:47104
    s_waitcnt lgkmcnt(10)
    v_mfma_f32_16x16x32_bf16 v[20:23], a[184:187], a[204:207], v[20:23]
    ds_read_b64_tr_b16 a[238:239], v162 offset:48384
    s_waitcnt lgkmcnt(10)
    v_mfma_f32_16x16x32_bf16 v[40:43], a[188:191], a[204:207], v[40:43]
    ds_read_b128 a[220:223], v159 offset:36864
    v_mfma_f32_16x16x32_bf16 v[36:39], a[188:191], a[200:203], v[36:39]
    ds_read_b64_tr_b16 a[240:241], v163 offset:47104
    s_waitcnt lgkmcnt(9)
    v_mfma_f32_16x16x32_bf16 v[56:59], a[192:195], a[200:203], v[56:59]
    ds_read_b64_tr_b16 a[242:243], v163 offset:48384
    v_mfma_f32_16x16x32_bf16 v[60:63], a[192:195], a[204:207], v[60:63]
    buffer_load_dwordx4 v177, s[12:15], s47 offen offset:3024 lds
    v_mfma_f32_16x16x32_bf16 v[64:67], a[192:195], a[208:211], v[64:67]
    ds_read_b128 a[224:227], v159 offset:38912
    v_mfma_f32_16x16x32_bf16 v[44:47], a[188:191], a[208:211], v[44:47]
    ds_read_b64_tr_b16 a[244:245], v164 offset:47104
    v_mfma_f32_16x16x32_bf16 v[24:27], a[184:187], a[208:211], v[24:27]
    ds_read_b64_tr_b16 a[246:247], v164 offset:48384
    s_waitcnt lgkmcnt(11)
    v_mfma_f32_16x16x32_bf16 v[28:31], a[184:187], a[212:215], v[28:31]
    s_nop 0
    ds_read_b128 a[228:231], v159 offset:40960
    s_add_u32 m0, s55, 60608
    s_mov_b32 s47, 15360
    v_mfma_f32_16x16x32_bf16 v[48:51], a[188:191], a[212:215], v[48:51]
    buffer_load_dwordx4 v174, s[12:15], s47 offen offset:0 lds
    v_mfma_f32_16x16x32_bf16 v[68:71], a[192:195], a[212:215], v[68:71]
    ds_read_b64_tr_b16 a[248:249], v165 offset:47104
    s_waitcnt lgkmcnt(12)
    s_nop 0
    v_mfma_f32_16x16x32_bf16 v[88:91], a[196:199], a[212:215], v[88:91]
    ds_read_b64_tr_b16 a[250:251], v165 offset:48384
    v_mfma_f32_16x16x32_bf16 v[84:87], a[196:199], a[208:211], v[84:87]
    ds_read_b128 a[232:235], v159 offset:43008
    v_mfma_f32_16x16x32_bf16 v[80:83], a[196:199], a[204:207], v[80:83]
    ds_read_b64_tr_b16 a[252:253], v166 offset:47104
    v_mfma_f32_16x16x32_bf16 v[76:79], a[196:199], a[200:203], v[76:79]
    ds_read_b64_tr_b16 a[254:255], v166 offset:48384
    s_waitcnt lgkmcnt(14)
    v_mfma_f32_16x16x32_bf16 v[92:95], a[196:199], a[216:219], v[92:95]
    buffer_load_dwordx4 v175, s[12:15], s47 offen offset:1008 lds
    v_mfma_f32_16x16x32_bf16 v[72:75], a[192:195], a[216:219], v[72:75]
    v_mfma_f32_16x16x32_bf16 v[52:55], a[188:191], a[216:219], v[52:55]
    v_mfma_f32_16x16x32_bf16 v[32:35], a[184:187], a[216:219], v[32:35]
    buffer_load_dwordx4 v176, s[12:15], s47 offen offset:2016 lds
    s_waitcnt vmcnt(14) lgkmcnt(0)
    s_barrier
    s_nop 0
    v_mfma_f32_16x16x32_bf16 v[16:19], a[220:223], a[236:239], v[16:19]
    ds_read_b64_tr_b16 a[200:201], v162 offset:0
    buffer_load_dwordx4 v177, s[12:15], s47 offen offset:3024 lds
    v_mfma_f32_16x16x32_bf16 v[20:23], a[220:223], a[240:243], v[20:23]
    ds_read_b64_tr_b16 a[202:203], v162 offset:1280
    v_mfma_f32_16x16x32_bf16 v[40:43], a[224:227], a[240:243], v[40:43]
    ds_read_b128 a[184:187], v158 offset:0
    v_mfma_f32_16x16x32_bf16 v[36:39], a[224:227], a[236:239], v[36:39]
    ds_read_b64_tr_b16 a[204:205], v163 offset:0
    v_mfma_f32_16x16x32_bf16 v[56:59], a[228:231], a[236:239], v[56:59]
    ds_read_b64_tr_b16 a[206:207], v163 offset:1280
    v_mfma_f32_16x16x32_bf16 v[60:63], a[228:231], a[240:243], v[60:63]
    s_add_u32 m0, s55, 64640
    s_mov_b32 s47, 30720
    buffer_load_dwordx4 v174, s[12:15], s47 offen offset:0 lds
    v_mfma_f32_16x16x32_bf16 v[64:67], a[228:231], a[244:247], v[64:67]
    ds_read_b128 a[188:191], v158 offset:2048
    v_mfma_f32_16x16x32_bf16 v[44:47], a[224:227], a[244:247], v[44:47]
    ds_read_b64_tr_b16 a[208:209], v164 offset:0
    v_mfma_f32_16x16x32_bf16 v[24:27], a[220:223], a[244:247], v[24:27]
    ds_read_b64_tr_b16 a[210:211], v164 offset:1280
    v_mfma_f32_16x16x32_bf16 v[28:31], a[220:223], a[248:251], v[28:31]
    ds_read_b128 a[192:195], v158 offset:4096
    v_mfma_f32_16x16x32_bf16 v[48:51], a[224:227], a[248:251], v[48:51]
    ds_read_b64_tr_b16 a[212:213], v165 offset:0
    buffer_load_dwordx4 v175, s[12:15], s47 offen offset:1008 lds
    v_mfma_f32_16x16x32_bf16 v[68:71], a[228:231], a[248:251], v[68:71]
    v_mfma_f32_16x16x32_bf16 v[88:91], a[232:235], a[248:251], v[88:91]
    ds_read_b64_tr_b16 a[214:215], v165 offset:1280
    v_mfma_f32_16x16x32_bf16 v[84:87], a[232:235], a[244:247], v[84:87]
    ds_read_b128 a[196:199], v158 offset:6144
    v_mfma_f32_16x16x32_bf16 v[80:83], a[232:235], a[240:243], v[80:83]
    ds_read_b64_tr_b16 a[216:217], v166 offset:0
    v_mfma_f32_16x16x32_bf16 v[76:79], a[232:235], a[236:239], v[76:79]
    ds_read_b64_tr_b16 a[218:219], v166 offset:1280
    buffer_load_dwordx4 v176, s[12:15], s47 offen offset:2016 lds
    v_mfma_f32_16x16x32_bf16 v[92:95], a[232:235], a[252:255], v[92:95]
    v_mfma_f32_16x16x32_bf16 v[72:75], a[228:231], a[252:255], v[72:75]
    v_mfma_f32_16x16x32_bf16 v[52:55], a[224:227], a[252:255], v[52:55]
    v_mfma_f32_16x16x32_bf16 v[32:35], a[220:223], a[252:255], v[32:35]
    s_waitcnt lgkmcnt(11)
    v_mfma_f32_16x16x32_bf16 v[16:19], a[184:187], a[200:203], v[16:19]
    ds_read_b64_tr_b16 a[236:237], v162 offset:10240
    buffer_load_dwordx4 v177, s[12:15], s47 offen offset:3024 lds
    s_waitcnt lgkmcnt(10)
    v_mfma_f32_16x16x32_bf16 v[20:23], a[184:187], a[204:207], v[20:23]
    ds_read_b64_tr_b16 a[238:239], v162 offset:11520
    s_waitcnt lgkmcnt(10)
    v_mfma_f32_16x16x32_bf16 v[40:43], a[188:191], a[204:207], v[40:43]
    ds_read_b128 a[220:223], v159 offset:0
    v_mfma_f32_16x16x32_bf16 v[36:39], a[188:191], a[200:203], v[36:39]
    ds_read_b64_tr_b16 a[240:241], v163 offset:10240
    s_waitcnt lgkmcnt(9)
    v_mfma_f32_16x16x32_bf16 v[56:59], a[192:195], a[200:203], v[56:59]
    ds_read_b64_tr_b16 a[242:243], v163 offset:11520
    v_mfma_f32_16x16x32_bf16 v[60:63], a[192:195], a[204:207], v[60:63]
    ds_read_b128 a[224:227], v159 offset:2048
    v_mfma_f32_16x16x32_bf16 v[64:67], a[192:195], a[208:211], v[64:67]
    ds_read_b64_tr_b16 a[244:245], v164 offset:10240
    s_add_u32 m0, s55, 68672
    s_mov_b32 s47, 46080
    buffer_load_dwordx4 v174, s[12:15], s47 offen offset:0 lds
    v_mfma_f32_16x16x32_bf16 v[44:47], a[188:191], a[208:211], v[44:47]
    ds_read_b64_tr_b16 a[246:247], v164 offset:11520
    v_mfma_f32_16x16x32_bf16 v[24:27], a[184:187], a[208:211], v[24:27]
    ds_read_b128 a[228:231], v159 offset:4096
    s_waitcnt vmcnt(17)
    v_min3_u32 v195, v198, v199, v128
    s_waitcnt lgkmcnt(12)
    v_mfma_f32_16x16x32_bf16 v[28:31], a[184:187], a[212:215], v[28:31]
    ds_read_b64_tr_b16 a[248:249], v165 offset:10240
    s_waitcnt vmcnt(15)
    v_min3_u32 v195, v195, v130, v132
    v_mfma_f32_16x16x32_bf16 v[48:51], a[188:191], a[212:215], v[48:51]
    ds_read_b64_tr_b16 a[250:251], v165 offset:11520
    v_mfma_f32_16x16x32_bf16 v[68:71], a[192:195], a[212:215], v[68:71]
    ds_read_b128 a[232:235], v159 offset:6144
    s_waitcnt vmcnt(13)
    v_min3_u32 v195, v195, v134, v136
    s_waitcnt lgkmcnt(14)
    v_mfma_f32_16x16x32_bf16 v[88:91], a[196:199], a[212:215], v[88:91]
    ds_read_b64_tr_b16 a[252:253], v166 offset:10240
    v_cmp_gt_u32 vcc, 1, v195
    v_mfma_f32_16x16x32_bf16 v[84:87], a[196:199], a[208:211], v[84:87]
    ds_read_b64_tr_b16 a[254:255], v166 offset:11520
    buffer_load_dwordx4 v178, s[12:15], s47 offen offset:1008 lds
    v_mfma_f32_16x16x32_bf16 v[80:83], a[196:199], a[204:207], v[80:83]
    s_cbranch_vccz L_ok_9
    s_mov_b32 s43, 0
L_spin_10:
    s_sleep 4
    s_nop 0
    buffer_load_dwordx2 v[198:199], v186, s[28:31], 0 offen sc1
    buffer_load_dword v128, v187, s[28:31], 0 offen offset:0 sc1
    buffer_load_dword v130, v187, s[28:31], 0 offen offset:2560 sc1
    buffer_load_dword v132, v188, s[28:31], 0 offen offset:0 sc1
    buffer_load_dword v134, v188, s[28:31], 0 offen offset:2560 sc1
    buffer_load_dword v136, v189, s[28:31], 0 offen offset:0 sc1
    s_add_u32 s43, s43, 1
    s_cmp_ge_u32 s43, 20000
    s_waitcnt vmcnt(0)
    s_cbranch_scc1 L_ok_9
    v_min3_u32 v195, v198, v199, v128
    v_min3_u32 v195, v195, v130, v132
    v_min3_u32 v195, v195, v134, v136
    v_cmp_gt_u32 vcc, 1, v195
    s_nop 1
    s_cbranch_vccnz L_spin_10
L_ok_9:
    v_mfma_f32_16x16x32_bf16 v[76:79], a[196:199], a[200:203], v[76:79]
    s_waitcnt lgkmcnt(14)
    v_mfma_f32_16x16x32_bf16 v[92:95], a[196:199], a[216:219], v[92:95]
    v_mfma_f32_16x16x32_bf16 v[72:75], a[192:195], a[216:219], v[72:75]
    v_mfma_f32_16x16x32_bf16 v[52:55], a[188:191], a[216:219], v[52:55]
    v_mfma_f32_16x16x32_bf16 v[32:35], a[184:187], a[216:219], v[32:35]
    s_waitcnt lgkmcnt(0)
    s_barrier
    v_mfma_f32_16x16x32_bf16 v[16:19], a[220:223], a[236:239], v[16:19]
    ds_write_b64 v172, v[198:199]
    ds_read_b128 v[96:99], v173 offset:0
    s_add_u32 m0, s55, 0
    s_mov_b32 s47, 51200
    buffer_load_dwordx4 v174, s[12:15], s47 offen offset:0 lds
    v_mfma_f32_16x16x32_bf16 v[20:23], a[220:223], a[240:243], v[20:23]
    ds_read_b128 v[112:115], v173 offset:64
    ds_read_b128 v[100:103], v173 offset:128
    v_mfma_f32_16x16x32_bf16 v[24:27], a[220:223], a[244:247], v[24:27]
    ds_read_b128 v[116:119], v173 offset:192
    ds_read_b128 v[104:107], v173 offset:256
    v_mfma_f32_16x16x32_bf16 v[28:31], a[220:223], a[248:251], v[28:31]
    ds_read_b128 v[120:123], v173 offset:320
    v_mfma_f32_16x16x32_bf16 v[32:35], a[220:223], a[252:255], v[32:35]
    ds_read_b128 v[108:111], v173 offset:384
    ds_read_b128 v[124:127], v173 offset:448
    v_mfma_f32_16x16x32_bf16 v[36:39], a[224:227], a[236:239], v[36:39]
    s_waitcnt vmcnt(1)
    ds_read_b64_tr_b16 a[0:1], v236 offset:56576
    buffer_load_dwordx4 v175, s[12:15], s47 offen offset:1008 lds
    s_nop 0
    v_mfma_f32_16x16x32_bf16 v[40:43], a[224:227], a[240:243], v[40:43]
    ds_read_b64_tr_b16 a[2:3], v236 offset:57248
    ds_read_b64_tr_b16 a[4:5], v236 offset:56640
    v_mfma_f32_16x16x32_bf16 v[44:47], a[224:227], a[244:247], v[44:47]
    ds_read_b64_tr_b16 a[6:7], v236 offset:57312
    v_mfma_f32_16x16x32_bf16 v[48:51], a[224:227], a[248:251], v[48:51]
    ds_read_b64_tr_b16 a[8:9], v236 offset:56704
    ds_read_b64_tr_b16 a[10:11], v236 offset:57376
    v_mfma_f32_16x16x32_bf16 v[52:55], a[224:227], a[252:255], v[52:55]
    ds_read_b64_tr_b16 a[12:13], v236 offset:56768
    ds_read_b64_tr_b16 a[14:15], v236 offset:57440
    v_mfma_f32_16x16x32_bf16 v[56:59], a[228:231], a[236:239], v[56:59]
    ds_read_b64_tr_b16 a[16:17], v236 offset:56832
    ds_read_b64_tr_b16 a[18:19], v236 offset:57504
    buffer_load_dwordx4 v176, s[12:15], s47 offen offset:2016 lds
    v_mfma_f32_16x16x32_bf16 v[60:63], a[228:231], a[240:243], v[60:63]
    ds_read_b64_tr_b16 a[20:21], v236 offset:63296
    v_mfma_f32_16x16x32_bf16 v[64:67], a[228:231], a[244:247], v[64:67]
    ds_read_b64_tr_b16 a[22:23], v236 offset:63968
    ds_read_b64_tr_b16 a[24:25], v236 offset:63360
    v_mfma_f32_16x16x32_bf16 v[68:71], a[228:231], a[248:251], v[68:71]
    ds_read_b64_tr_b16 a[26:27], v236 offset:64032
    ds_read_b64_tr_b16 a[28:29], v236 offset:63424
    v_mfma_f32_16x16x32_bf16 v[72:75], a[228:231], a[252:255], v[72:75]
    ds_read_b64_tr_b16 a[30:31], v236 offset:64096
    ds_read_b64_tr_b16 a[32:33], v236 offset:63488
    v_mfma_f32_16x16x32_bf16 v[76:79], a[232:235], a[236:239], v[76:79]
    ds_read_b64_tr_b16 a[34:35], v236 offset:64160
    buffer_load_dwordx4 v177, s[12:15], s47 offen offset:3024 lds
    v_mfma_f32_16x16x32_bf16 v[80:83], a[232:235], a[240:243], v[80:83]
    ds_read_b64_tr_b16 a[36:37], v236 offset:63552
    ds_read_b64_tr_b16 a[38:39], v236 offset:64224
    v_mfma_f32_16x16x32_bf16 v[84:87], a[232:235], a[244:247], v[84:87]
    ds_read_b64_tr_b16 a[160:161], v237 offset:56576
    ds_read_b64_tr_b16 a[164:165], v237 offset:56640
    v_mfma_f32_16x16x32_bf16 v[88:91], a[232:235], a[248:251], v[88:91]
    ds_read_b64_tr_b16 a[168:169], v237 offset:56704
    ds_read_b64_tr_b16 a[172:173], v237 offset:56768
    v_mfma_f32_16x16x32_bf16 v[92:95], a[232:235], a[252:255], v[92:95]
    ds_read_b64_tr_b16 a[176:177], v237 offset:56832
    s_waitcnt lgkmcnt(14)
    v_pk_fma_f32 v[32:33], v[96:97], v[136:137], v[32:33] op_sel_hi:[1,0,1]
    v_pk_fma_f32 v[34:35], v[98:99], v[136:137], v[34:35] op_sel_hi:[1,0,1]
    v_pk_fma_f32 v[24:25], v[96:97], v[132:133], v[24:25] op_sel_hi:[1,0,1]
    s_nop 0
    v_pk_fma_f32 v[26:27], v[98:99], v[132:133], v[26:27] op_sel_hi:[1,0,1]
    v_pk_fma_f32 v[16:17], v[96:97], v[128:129], v[16:17] op_sel_hi:[1,0,1]
    v_pk_fma_f32 v[18:19], v[98:99], v[128:129], v[18:19] op_sel_hi:[1,0,1]
    v_pk_fma_f32 v[28:29], v[96:97], v[134:135], v[28:29] op_sel_hi:[1,0,1]
    v_pk_fma_f32 v[30:31], v[98:99], v[134:135], v[30:31] op_sel_hi:[1,0,1]
    v_pk_fma_f32 v[20:21], v[96:97], v[130:131], v[20:21] op_sel_hi:[1,0,1]
    v_pk_fma_f32 v[22:23], v[98:99], v[130:131], v[22:23] op_sel_hi:[1,0,1]
    v_pk_fma_f32 v[32:33], v[32:33], v[112:113], v[142:143]
    v_pk_fma_f32 v[34:35], v[34:35], v[114:115], v[142:143]
    v_pk_fma_f32 v[24:25], v[24:25], v[112:113], v[138:139]
    v_pk_fma_f32 v[26:27], v[26:27], v[114:115], v[138:139]
    v_pk_fma_f32 v[16:17], v[16:17], v[112:113], v[138:139]
    v_pk_fma_f32 v[18:19], v[18:19], v[114:115], v[138:139]
    v_pk_mul_f32 v[28:29], v[28:29], v[112:113]
    v_pk_mul_f32 v[30:31], v[30:31], v[114:115]
    v_pk_mul_f32 v[20:21], v[20:21], v[112:113]
    v_pk_mul_f32 v[22:23], v[22:23], v[114:115]
    v_pk_fma_f32 v[208:209], v[32:33], s[62:63], v[140:141]
    s_add_u32 m0, s55, 4032
    s_mov_b32 s47, 66560
    buffer_load_dwordx4 v174, s[12:15], s47 offen offset:0 lds
    v_pk_fma_f32 v[210:211], v[34:35], s[62:63], v[140:141]
    v_pk_fma_f32 v[204:205], v[24:25], s[62:63], v[140:141]
    v_pk_fma_f32 v[206:207], v[26:27], s[62:63], v[140:141]
    v_pk_fma_f32 v[200:201], v[16:17], s[62:63], v[140:141]
    v_pk_fma_f32 v[202:203], v[18:19], s[62:63], v[140:141]
    v_cvt_pk_bf16_f32 v224, v28, v29
    v_cvt_pk_bf16_f32 v225, v30, v31
    v_cvt_pk_bf16_f32 v216, v20, v21
    v_cvt_pk_bf16_f32 v217, v22, v23
    v_exp_f32 v208, v208 clamp
    v_exp_f32 v209, v209 clamp
    v_exp_f32 v210, v210 clamp
    v_exp_f32 v211, v211 clamp
    v_exp_f32 v204, v204 clamp
    v_exp_f32 v205, v205 clamp
    v_exp_f32 v206, v206 clamp
    buffer_load_dwordx4 v175, s[12:15], s47 offen offset:1008 lds
    v_exp_f32 v207, v207 clamp
    v_exp_f32 v200, v200 clamp
    v_exp_f32 v201, v201 clamp
    v_exp_f32 v202, v202 clamp
    v_exp_f32 v203, v203 clamp
    v_max_f32 v32, v146, v32
    v_max_f32 v33, v146, v33
    v_max_f32 v34, v146, v34
    v_max_f32 v35, v146, v35
    v_max_f32 v24, v138, v24
    v_max_f32 v25, v138, v25
    v_max_f32 v26, v138, v26
    v_max_f32 v27, v138, v27
    v_max_f32 v16, v138, v16
    v_max_f32 v17, v138, v17
    v_max_f32 v18, v138, v18
    v_max_f32 v19, v138, v19
    buffer_load_dwordx4 v176, s[12:15], s47 offen offset:2016 lds
    v_pk_fma_f32 v[32:33], v[208:209], v[144:145], v[32:33]
    v_pk_fma_f32 v[34:35], v[210:211], v[144:145], v[34:35]
    v_pk_add_f32 v[24:25], v[24:25], v[204:205]
    v_pk_add_f32 v[26:27], v[26:27], v[206:207]
    v_pk_add_f32 v[16:17], v[16:17], v[200:201]
    v_pk_add_f32 v[18:19], v[18:19], v[202:203]
    v_cvt_pk_bf16_f32 v228, v32, v33
    v_cvt_pk_bf16_f32 v229, v34, v35
    v_cvt_pk_bf16_f32 v220, v24, v25
    v_cvt_pk_bf16_f32 v221, v26, v27
    v_cvt_pk_bf16_f32 v212, v16, v17
    v_cvt_pk_bf16_f32 v213, v18, v19
    v_cndmask_b32 v232, v228, v147, s[66:67]
    v_cndmask_b32 v233, v229, v147, s[66:67]
    v_pk_fma_f32 v[52:53], v[100:101], v[136:137], v[52:53] op_sel_hi:[1,0,1]
    v_pk_fma_f32 v[54:55], v[102:103], v[136:137], v[54:55] op_sel_hi:[1,0,1]
    v_pk_fma_f32 v[44:45], v[100:101], v[132:133], v[44:45] op_sel_hi:[1,0,1]
    buffer_load_dwordx4 v177, s[12:15], s47 offen offset:3024 lds
    v_pk_fma_f32 v[46:47], v[102:103], v[132:133], v[46:47] op_sel_hi:[1,0,1]
    v_pk_fma_f32 v[36:37], v[100:101], v[128:129], v[36:37] op_sel_hi:[1,0,1]
    v_pk_fma_f32 v[38:39], v[102:103], v[128:129], v[38:39] op_sel_hi:[1,0,1]
    v_pk_fma_f32 v[48:49], v[100:101], v[134:135], v[48:49] op_sel_hi:[1,0,1]
    v_pk_fma_f32 v[50:51], v[102:103], v[134:135], v[50:51] op_sel_hi:[1,0,1]
    v_pk_fma_f32 v[40:41], v[100:101], v[130:131], v[40:41] op_sel_hi:[1,0,1]
    v_pk_fma_f32 v[42:43], v[102:103], v[130:131], v[42:43] op_sel_hi:[1,0,1]
    v_pk_fma_f32 v[52:53], v[52:53], v[116:117], v[142:143]
    v_pk_fma_f32 v[54:55], v[54:55], v[118:119], v[142:143]
    v_pk_fma_f32 v[44:45], v[44:45], v[116:117], v[138:139]
    v_pk_fma_f32 v[46:47], v[46:47], v[118:119], v[138:139]
    v_pk_fma_f32 v[36:37], v[36:37], v[116:117], v[138:139]
    v_pk_fma_f32 v[38:39], v[38:39], v[118:119], v[138:139]
    v_pk_mul_f32 v[48:49], v[48:49], v[116:117]
    v_pk_mul_f32 v[50:51], v[50:51], v[118:119]
    v_pk_mul_f32 v[40:41], v[40:41], v[116:117]
    v_pk_mul_f32 v[42:43], v[42:43], v[118:119]
    s_add_u32 m0, s55, 8064
    s_mov_b32 s47, 81920
    buffer_load_dwordx4 v174, s[12:15], s47 offen offset:0 lds
    v_pk_fma_f32 v[208:209], v[52:53], s[62:63], v[140:141]
    v_pk_fma_f32 v[210:211], v[54:55], s[62:63], v[140:141]
    v_pk_fma_f32 v[204:205], v[44:45], s[62:63], v[140:141]
    v_pk_fma_f32 v[206:207], v[46:47], s[62:63], v[140:141]
    v_pk_fma_f32 v[200:201], v[36:37], s[62:63], v[140:141]
    v_pk_fma_f32 v[202:203], v[38:39], s[62:63], v[140:141]
    v_cvt_pk_bf16_f32 v226, v48, v49
    v_cvt_pk_bf16_f32 v227, v50, v51
    v_cvt_pk_bf16_f32 v218, v40, v41
    v_cvt_pk_bf16_f32 v219, v42, v43
    v_exp_f32 v208, v208 clamp
    v_exp_f32 v209, v209 clamp
    v_exp_f32 v210, v210 clamp
    v_exp_f32 v211, v211 clamp
    v_exp_f32 v204, v204 clamp
    v_exp_f32 v205, v205 clamp
    v_exp_f32 v206, v206 clamp
    buffer_load_dwordx4 v175, s[12:15], s47 offen offset:1008 lds
    v_exp_f32 v207, v207 clamp
    v_exp_f32 v200, v200 clamp
    v_exp_f32 v201, v201 clamp
    v_exp_f32 v202, v202 clamp
    v_exp_f32 v203, v203 clamp
    v_max_f32 v52, v146, v52
    v_max_f32 v53, v146, v53
    v_max_f32 v54, v146, v54
    v_max_f32 v55, v146, v55
    v_max_f32 v44, v138, v44
    v_max_f32 v45, v138, v45
    v_max_f32 v46, v138, v46
    v_max_f32 v47, v138, v47
    v_max_f32 v36, v138, v36
    v_max_f32 v37, v138, v37
    v_max_f32 v38, v138, v38
    v_max_f32 v39, v138, v39
    buffer_load_dwordx4 v176, s[12:15], s47 offen offset:2016 lds
    v_pk_fma_f32 v[52:53], v[208:209], v[144:145], v[52:53]
    v_pk_fma_f32 v[54:55], v[210:211], v[144:145], v[54:55]
    v_pk_add_f32 v[44:45], v[44:45], v[204:205]
    v_pk_add_f32 v[46:47], v[46:47], v[206:207]
    v_pk_add_f32 v[36:37], v[36:37], v[200:201]
    v_pk_add_f32 v[38:39], v[38:39], v[202:203]
    v_cvt_pk_bf16_f32 v230, v52, v53
    v_cvt_pk_bf16_f32 v231, v54, v55
    v_cvt_pk_bf16_f32 v222, v44, v45
    v_cvt_pk_bf16_f32 v223, v46, v47
L_pg2:
    s_cbranch_execz L_ret
    v_cvt_pk_bf16_f32 v214, v36, v37
    v_cvt_pk_bf16_f32 v215, v38, v39
    v_cndmask_b32 v234, v230, v147, s[66:67]
    s_nop 0
    v_cndmask_b32 v235, v231, v147, s[66:67]
    v_mfma_f32_16x16x32_bf16 v[32:35], v[224:227], v[220:223], 0
    v_mfma_f32_16x16x32_bf16 v[36:39], v[224:227], v[228:231], 0
    v_mfma_f32_16x16x32_bf16 v[40:43], v[232:235], v[220:223], 0
    buffer_load_dwordx4 v177, s[12:15], s47 offen offset:3024 lds
    v_mfma_f32_16x16x32_bf16 v[28:31], v[232:235], v[228:231], 0
    v_mfma_f32_16x16x32_bf16 v[20:23], v[216:219], v[228:231], 0
    v_mfma_f32_16x16x32_bf16 v[24:27], v[232:235], v[212:215], 0
    v_mfma_f32_16x16x32_bf16 v[16:19], v[216:219], v[212:215], 0
    v_pk_fma_f32 v[72:73], v[104:105], v[136:137], v[72:73] op_sel_hi:[1,0,1]
    v_pk_fma_f32 v[74:75], v[106:107], v[136:137], v[74:75] op_sel_hi:[1,0,1]
    v_pk_fma_f32 v[64:65], v[104:105], v[132:133], v[64:65] op_sel_hi:[1,0,1]
    v_pk_fma_f32 v[66:67], v[106:107], v[132:133], v[66:67] op_sel_hi:[1,0,1]
    v_pk_fma_f32 v[56:57], v[104:105], v[128:129], v[56:57] op_sel_hi:[1,0,1]
    v_pk_fma_f32 v[58:59], v[106:107], v[128:129], v[58:59] op_sel_hi:[1,0,1]
    v_pk_fma_f32 v[68:69], v[104:105], v[134:135], v[68:69] op_sel_hi:[1,0,1]
    v_pk_fma_f32 v[70:71], v[106:107], v[134:135], v[70:71] op_sel_hi:[1,0,1]
    v_pk_fma_f32 v[60:61], v[104:105], v[130:131], v[60:61] op_sel_hi:[1,0,1]
    v_pk_fma_f32 v[62:63], v[106:107], v[130:131], v[62:63] op_sel_hi:[1,0,1]
    v_pk_fma_f32 v[72:73], v[72:73], v[120:121], v[142:143]
    v_pk_fma_f32 v[74:75], v[74:75], v[122:123], v[142:143]
    s_add_u32 m0, s55, 12096
    s_mov_b32 s47, 97280
    buffer_load_dwordx4 v174, s[12:15], s47 offen offset:0 lds
    v_pk_fma_f32 v[64:65], v[64:65], v[120:121], v[138:139]
    v_pk_fma_f32 v[66:67], v[66:67], v[122:123], v[138:139]
    v_pk_fma_f32 v[56:57], v[56:57], v[120:121], v[138:139]
    v_pk_fma_f32 v[58:59], v[58:59], v[122:123], v[138:139]
    v_pk_mul_f32 v[68:69], v[68:69], v[120:121]
    v_pk_mul_f32 v[70:71], v[70:71], v[122:123]
    v_pk_mul_f32 v[60:61], v[60:61], v[120:121]
    v_pk_mul_f32 v[62:63], v[62:63], v[122:123]
    v_pk_fma_f32 v[208:209], v[72:73], s[62:63], v[140:141]
    v_pk_fma_f32 v[210:211], v[74:75], s[62:63], v[140:141]
    v_pk_fma_f32 v[204:205], v[64:65], s[62:63], v[140:141]
    v_pk_fma_f32 v[206:207], v[66:67], s[62:63], v[140:141]
    v_pk_fma_f32 v[200:201], v[56:57], s[62:63], v[140:141]
    v_pk_fma_f32 v[202:203], v[58:59], s[62:63], v[140:141]
    v_cvt_pk_bf16_f32 v224, v68, v69
    v_cvt_pk_bf16_f32 v225, v70, v71
    v_cvt_pk_bf16_f32 v216, v60, v61
    buffer_load_dwordx4 v178, s[12:15], s47 offen offset:1008 lds
    v_cvt_pk_bf16_f32 v217, v62, v63
    v_exp_f32 v208, v208 clamp
    v_exp_f32 v209, v209 clamp
    v_exp_f32 v210, v210 clamp
    v_exp_f32 v211, v211 clamp
    v_exp_f32 v204, v204 clamp
    v_exp_f32 v205, v205 clamp
    v_exp_f32 v206, v206 clamp
    v_exp_f32 v207, v207 clamp
    v_exp_f32 v200, v200 clamp
    v_exp_f32 v201, v201 clamp
    v_exp_f32 v202, v202 clamp
    v_exp_f32 v203, v203 clamp
    v_max_f32 v72, v146, v72
    v_max_f32 v73, v146, v73
    v_max_f32 v74, v146, v74
    v_max_f32_e64 v75, v146, v75
    s_waitcnt lgkmcnt(0)
    s_add_u32 m0, s55, 56576
    s_mov_b32 s47, 102400
    buffer_load_dwordx4 v174, s[12:15], s47 offen offset:0 lds
    v_max_f32 v64, v138, v64
    v_max_f32 v65, v138, v65
    v_max_f32 v66, v138, v66
    v_max_f32 v67, v138, v67
    v_max_f32 v56, v138, v56
    v_max_f32 v57, v138, v57
    v_max_f32 v58, v138, v58
    v_max_f32 v59, v138, v59
    v_pk_fma_f32 v[72:73], v[208:209], v[144:145], v[72:73]
    v_pk_fma_f32 v[74:75], v[210:211], v[144:145], v[74:75]
    v_pk_add_f32 v[64:65], v[64:65], v[204:205]
    v_pk_add_f32 v[66:67], v[66:67], v[206:207]
    v_pk_add_f32 v[56:57], v[56:57], v[200:201]
    v_pk_add_f32 v[58:59], v[58:59], v[202:203]
    v_cvt_pk_bf16_f32 v228, v72, v73
    v_cvt_pk_bf16_f32 v229, v74, v75
    v_cvt_pk_bf16_f32 v220, v64, v65
    buffer_load_dwordx4 v175, s[12:15], s47 offen offset:1008 lds
    v_cvt_pk_bf16_f32 v221, v66, v67
    v_cvt_pk_bf16_f32 v212, v56, v57
    v_cvt_pk_bf16_f32 v213, v58, v59
    v_cndmask_b32 v232, v228, v147, s[66:67]
    v_cndmask_b32 v233, v229, v147, s[66:67]
    v_pk_fma_f32 v[92:93], v[108:109], v[136:137], v[92:93] op_sel_hi:[1,0,1]
    v_pk_fma_f32 v[94:95], v[110:111], v[136:137], v[94:95] op_sel_hi:[1,0,1]
    v_pk_fma_f32 v[84:85], v[108:109], v[132:133], v[84:85] op_sel_hi:[1,0,1]
    v_pk_fma_f32 v[86:87], v[110:111], v[132:133], v[86:87] op_sel_hi:[1,0,1]
    v_pk_fma_f32 v[76:77], v[108:109], v[128:129], v[76:77] op_sel_hi:[1,0,1]
    v_pk_fma_f32 v[78:79], v[110:111], v[128:129], v[78:79] op_sel_hi:[1,0,1]
    v_pk_fma_f32 v[88:89], v[108:109], v[134:135], v[88:89] op_sel_hi:[1,0,1]
    v_pk_fma_f32 v[90:91], v[110:111], v[134:135], v[90:91] op_sel_hi:[1,0,1]
    v_pk_fma_f32 v[80:81], v[108:109], v[130:131], v[80:81] op_sel_hi:[1,0,1]
    v_pk_fma_f32 v[82:83], v[110:111], v[130:131], v[82:83] op_sel_hi:[1,0,1]
    v_pk_fma_f32 v[92:93], v[92:93], v[124:125], v[142:143]
    v_pk_fma_f32 v[94:95], v[94:95], v[126:127], v[142:143]
    buffer_load_dwordx4 v176, s[12:15], s47 offen offset:2016 lds
    v_pk_fma_f32 v[84:85], v[84:85], v[124:125], v[138:139]
    v_pk_fma_f32 v[86:87], v[86:87], v[126:127], v[138:139]
    v_pk_fma_f32 v[76:77], v[76:77], v[124:125], v[138:139]
    v_pk_fma_f32 v[78:79], v[78:79], v[126:127], v[138:139]
    v_pk_mul_f32 v[88:89], v[88:89], v[124:125]
    v_pk_mul_f32 v[90:91], v[90:91], v[126:127]
    v_pk_mul_f32 v[80:81], v[80:81], v[124:125]
    v_pk_mul_f32 v[82:83], v[82:83], v[126:127]
    v_pk_fma_f32 v[208:209], v[92:93], s[62:63], v[140:141]
    v_pk_fma_f32 v[210:211], v[94:95], s[62:63], v[140:141]
    v_pk_fma_f32 v[204:205], v[84:85], s[62:63], v[140:141]
    v_pk_fma_f32 v[206:207], v[86:87], s[62:63], v[140:141]
    v_pk_fma_f32 v[200:201], v[76:77], s[62:63], v[140:141]
    v_pk_fma_f32 v[202:203], v[78:79], s[62:63], v[140:141]
    v_cvt_pk_bf16_f32 v226, v88, v89
    v_cvt_pk_bf16_f32 v227, v90, v91
    v_cvt_pk_bf16_f32 v218, v80, v81
    buffer_load_dwordx4 v177, s[12:15], s47 offen offset:3024 lds
    v_cvt_pk_bf16_f32 v219, v82, v83
    v_exp_f32 v208, v208 clamp
    v_exp_f32 v209, v209 clamp
    v_exp_f32 v210, v210 clamp
    v_exp_f32 v211, v211 clamp
    v_exp_f32 v204, v204 clamp
    v_exp_f32 v205, v205 clamp
    v_exp_f32 v206, v206 clamp
    v_exp_f32 v207, v207 clamp
    v_exp_f32 v200, v200 clamp
    v_exp_f32 v201, v201 clamp
    v_exp_f32 v202, v202 clamp
    v_exp_f32 v203, v203 clamp
    v_max_f32 v92, v146, v92
    v_max_f32 v93, v146, v93
    v_max_f32 v94, v146, v94
    v_max_f32 v95, v146, v95
    v_max_f32 v84, v138, v84
    v_max_f32 v85, v138, v85
    v_max_f32 v86, v138, v86
    v_max_f32 v87, v138, v87
    v_max_f32 v76, v138, v76
    v_max_f32 v77, v138, v77
    v_max_f32 v78, v138, v78
    v_max_f32 v79, v138, v79
    v_pk_fma_f32 v[92:93], v[208:209], v[144:145], v[92:93]
    v_pk_fma_f32 v[94:95], v[210:211], v[144:145], v[94:95]
    v_pk_add_f32 v[84:85], v[84:85], v[204:205]
    v_pk_add_f32 v[86:87], v[86:87], v[206:207]
    v_pk_add_f32 v[76:77], v[76:77], v[200:201]
    v_pk_add_f32 v[78:79], v[78:79], v[202:203]
    v_cvt_pk_bf16_f32 v230, v92, v93
    v_cvt_pk_bf16_f32 v231, v94, v95
    v_cvt_pk_bf16_f32 v222, v84, v85
    v_cvt_pk_bf16_f32 v223, v86, v87
    v_cvt_pk_bf16_f32 v214, v76, v77
    v_cvt_pk_bf16_f32 v215, v78, v79
    v_cndmask_b32 v234, v230, v147, s[66:67]
    v_cndmask_b32 v235, v231, v147, s[66:67]
    v_mfma_f32_16x16x32_bf16 v[32:35], v[224:227], v[220:223], v[32:35]
    v_mfma_f32_16x16x32_bf16 v[36:39], v[224:227], v[228:231], v[36:39]
    v_mfma_f32_16x16x32_bf16 v[40:43], v[232:235], v[220:223], v[40:43]
    v_mfma_f32_16x16x32_bf16 v[28:31], v[232:235], v[228:231], v[28:31]
    v_mfma_f32_16x16x32_bf16 v[20:23], v[216:219], v[228:231], v[20:23]
    v_mfma_f32_16x16x32_bf16 v[24:27], v[232:235], v[212:215], v[24:27]
    v_mfma_f32_16x16x32_bf16 v[16:19], v[216:219], v[212:215], v[16:19]
    ds_write_b128 v190, v[32:35] offset:0
    ds_write_b128 v190, v[36:39] offset:4096
    ds_write_b128 v190, v[40:43] offset:5120
    ds_write_b128 v190, v[28:31] offset:3072
    s_nop 1
    ds_write_b128 v190, v[20:23] offset:1024
    ds_write_b128 v190, v[24:27] offset:2048
    s_waitcnt lgkmcnt(0)
    s_barrier
    ds_read_b128 v[44:47], v191
    ds_read_b128 v[48:51], v192
    ds_read_b128 v[52:55], v193
    s_waitcnt lgkmcnt(2)
    v_pk_add_f32 v[16:17], v[16:17], v[44:45]
    v_pk_add_f32 v[18:19], v[18:19], v[46:47]
    buffer_atomic_add_f32 v16, v180, s[28:31], s64 offen offset:0
    buffer_atomic_add_f32 v17, v180, s[28:31], s64 offen offset:64
    buffer_atomic_add_f32 v18, v180, s[28:31], s64 offen offset:128
    buffer_atomic_add_f32 v19, v180, s[28:31], s64 offen offset:192
    s_waitcnt lgkmcnt(0)
    v_pk_add_f32 v[48:49], v[48:49], v[52:53]
    v_pk_add_f32 v[50:51], v[50:51], v[54:55]
    buffer_atomic_add_f32 v48, v181, s[28:31], s64 offen
    buffer_atomic_add_f32 v49, v182, s[28:31], s64 offen
    buffer_atomic_add_f32 v50, v183, s[28:31], s64 offen
    buffer_atomic_add_f32 v51, v184, s[28:31], s64 offen
    s_waitcnt vmcnt(12)
    s_add_u32 m0, s55, 60608
    s_mov_b32 s47, 117760
    buffer_load_dwordx4 v174, s[12:15], s47 offen offset:0 lds
    ds_read_b64_tr_b16 a[40:41], v236 offset:0
    ds_read_b64_tr_b16 a[42:43], v236 offset:672
    ds_read_b64_tr_b16 a[44:45], v236 offset:64
    ds_read_b64_tr_b16 a[46:47], v236 offset:736
    ds_read_b64_tr_b16 a[48:49], v236 offset:128
    ds_read_b64_tr_b16 a[50:51], v236 offset:800
    ds_read_b64_tr_b16 a[52:53], v236 offset:192
    ds_read_b64_tr_b16 a[54:55], v236 offset:864
    ds_read_b64_tr_b16 a[56:57], v236 offset:256
    ds_read_b64_tr_b16 a[58:59], v236 offset:928
    ds_read_b64_tr_b16 a[60:61], v236 offset:6720
    ds_read_b64_tr_b16 a[62:63], v236 offset:7392
    ds_read_b64_tr_b16 a[64:65], v236 offset:6784
    ds_read_b64_tr_b16 a[66:67], v236 offset:7456
    ds_read_b64_tr_b16 a[68:69], v236 offset:6848
    ds_read_b64_tr_b16 a[70:71], v236 offset:7520
    ds_read_b64_tr_b16 a[72:73], v236 offset:6912
    ds_read_b64_tr_b16 a[74:75], v236 offset:7584
    ds_read_b64_tr_b16 a[76:77], v236 offset:6976
    ds_read_b64_tr_b16 a[78:79], v236 offset:7648
    ds_read_b64_tr_b16 a[162:163], v237 offset:0
    ds_read_b64_tr_b16 a[166:167], v237 offset:64
    ds_read_b64_tr_b16 a[170:171], v237 offset:128
    ds_read_b64_tr_b16 a[174:175], v237 offset:192
    ds_read_b64_tr_b16 a[178:179], v237 offset:256
    s_lshr_b32 s3, s68, 2
    s_mul_i32 s3, s3, 5
    s_add_u32 s3, s3, s38
    s_lshl_b32 s3, s3, 7
    buffer_load_dwordx4 v175, s[12:15], s47 offen offset:1008 lds
    s_add_u32 s44, s3, 16384
    v_and_b32 v8, 1, v0
    v_lshlrev_b32 v243, 7, v8
    v_and_b32 v8, 31, v0
    s_lshl_b32 s3, s68, 1
    s_add_u32 s45, s3, s41
    s_lshl_b32 s3, s45, 4
    v_lshrrev_b32 v9, 2, v0
    v_add_u32 v9, s3, v9
    v_mul_u32_u24 v9, 1280, v9
    v_lshl_add_u32 v112, v5, 4, v9
    s_mul_i32 s50, s69, 320
    s_lshl_b32 s3, s42, 8
    s_add_u32 s9, s50, s3
    s_lshl_b32 s3, s42, 7
    s_add_u32 s10, s50, s3
    s_add_u32 s10, s10, 64
    s_lshl_b32 s3, s42, 28
    s_add_u32 s11, s50, s3
    s_add_u32 s11, s11, 128
    v_lshlrev_b32 v11, 3, v3
    v_add_u32 v12, v11, v4
    v_lshlrev_b32 v12, 6, v12
    v_lshl_add_u32 v12, v6, 5, v12
    v_lshl_add_u32 v12, v5, 3, v12
    v_add_u32 v235, s55, v12
    v_sub_u32 v11, v8, v11
    v_and_b32 v12, 1, v11
    v_lshlrev_b32 v12, 4, v12
    v_lshlrev_b32 v12, v12, v253
    buffer_load_dwordx4 v176, s[12:15], s47 offen offset:2016 lds
    v_mul_u32_u24 v12, 0x3f80, v12
    v_lshrrev_b32 v11, 1, v11
    v_mov_b32 v10, 1073741824
    v_cmp_eq_u32 vcc, 0, v11
    v_cmp_eq_u32 s[60:61], 1, v11
    v_mov_b32 v226, 0
    v_cndmask_b32 v13, 0, v12, vcc
    v_cndmask_b32 v14, 0, v12, s[60:61]
    v_accvgpr_write_b32 a252, v13
    v_accvgpr_write_b32 a253, v14
    v_cmp_eq_u32 vcc, 2, v11
    v_cmp_eq_u32 s[60:61], 3, v11
    v_mov_b32_e64 v227, 0
    v_cndmask_b32 v13, 0, v12, vcc
    v_cndmask_b32 v14, 0, v12, s[60:61]
    v_accvgpr_write_b32 a254, v13
    v_accvgpr_write_b32 a255, v14
    v_lshlrev_b32_e64 v11, 4, v8
    v_lshl_add_u32 v12, v3, 9, v11
    v_add_u32 v11, 1024, v11
    v_cmp_eq_u32 vcc, 2, v5
    v_bfe_u32 v13, v8, 2, 1
    v_and_b32 v14, 1, v8
    v_lshl_add_u32 v13, v13, 1, v14
    v_cndmask_b32 v13, v13, 4, vcc
    v_cmp_eq_u32 vcc, 3, v5
    v_lshlrev_b32 v13, 7, v13
    v_add_u32 v13, 1280, v13
    v_cndmask_b32 v13, v13, v10, vcc
    buffer_load_dwordx4 v177, s[12:15], s47 offen offset:3024 lds
    v_cmp_le_u32 vcc, 24, v8
    s_lshl_b32 s3, s68, 2
    s_add_u32 s52, s3, s69
    v_cndmask_b32 v13, v13, v10, vcc
    v_cmp_gt_u32 vcc, 16, v8
    v_lshl_add_u32 v14, v3, 5, v13
    v_add_u32 v13, 64, v13
    v_cndmask_b32 v238, v14, v12, vcc
    v_add_u32 v12, 256, v12
    v_add_u32 v14, 16, v14
    v_cndmask_b32 v239, v14, v12, vcc
    v_cndmask_b32 v11, v13, v11, vcc
    v_cmp_eq_u32 vcc, 0, v3
    s_add_u32 s3, s3, s38
    s_mul_i32 s3, s3, 10240
    v_cndmask_b32 v240, v10, v11, vcc
    v_cndmask_b32 v241, v11, v10, vcc
    s_add_u32 s54, s3, 1048576
    s_mul_i32 s8, s38, 10240
    s_lshl_b32 s52, s52, 7
    s_add_u32 s52, s52, 32768
    s_mul_i32 s62, s41, 5
    s_lshl_b32 s3, s42, 2
    s_sub_u32 s63, 5, s62
    s_add_u32 s62, s62, s3
    s_add_u32 s63, s63, s3
    s_mul_i32 s62, s62, 6144
    s_mul_i32 s63, s63, 6144
    s_add_u32 s62, s62, 98304
    s_waitcnt vmcnt(4)
    s_barrier
    buffer_store_dword v253, v252, s[28:31], s46 offen sc1
    s_add_u32 s63, s63, 98304
    s_nop 0
    s_add_u32 m0, s55, 64640
    s_mov_b32 s47, 133120
    buffer_load_dwordx4 v174, s[12:15], s47 offen offset:0 lds
    s_mul_i32 s0, s42, -12288
    s_add_u32 s0, s0, 6144
    s_lshl_b32 s1, s42, 11
    s_mul_i32 s50, s69, 5
    buffer_load_dwordx4 v175, s[12:15], s47 offen offset:1008 lds
    s_lshl_b32 s50, s50, 7
    s_add_u32 s50, s50, s45
    s_lshl_b32 s50, s50, 10
    s_add_u32 s50, s50, 5242880
    buffer_load_dwordx4 v176, s[12:15], s47 offen offset:2016 lds
    s_lshl_b32 s3, s42, 19
    s_add_u32 s48, s50, s3
    s_lshl_b32 s3, s42, 18
    s_add_u32 s49, s50, s3
    buffer_load_dwordx4 v177, s[12:15], s47 offen offset:3024 lds
    s_add_u32 s49, s49, 131072
    s_lshl_b32 s3, s42, 30
    s_add_u32 s50, s50, s3
    s_add_u32 s50, s50, 262144
    s_add_u32 m0, s55, 68672
    s_mov_b32 s47, 148480
    buffer_load_dwordx4 v174, s[12:15], s47 offen offset:0 lds
    s_sub_u32 s60, 0, s42
    s_mov_b32 s61, s60
    v_and_b32 v8, 1, v0
    v_lshl_add_u32 v8, v4, 1, v8
    buffer_load_dwordx4 v178, s[12:15], s47 offen offset:1008 lds
    v_lshlrev_b32_e64 v8, 2, v8
    v_lshl_add_u32 v8, v2, 5, v8
    v_cndmask_b32 v15, v8, v10, s[58:59]
    s_lshl_b32 s51, s45, 10
    s_waitcnt lgkmcnt(0)
    s_add_u32 m0, s55, 0
    s_mov_b32 s47, 153600
    buffer_load_dwordx4 v174, s[12:15], s47 offen offset:0 lds
    s_add_u32 s51, s51, 196608
    s_lshl_b32 s3, s69, 1
    s_add_u32 s3, s3, s42
    s_lshl_b32 s3, s3, 7
    buffer_load_dwordx4 v175, s[12:15], s47 offen offset:1008 lds
    s_add_u32 s53, s51, s3
    v_mul_u32_u24 v11, 2560, v5
    v_xor_b32 v12, s41, v6
    v_lshl_add_u32 v11, v12, 3, v11
    buffer_load_dwordx4 v176, s[12:15], s47 offen offset:2016 lds
    v_lshl_add_u32 v11, v4, 4, v11
    v_add_u32_e64 v11, s8, v11
    v_lshl_add_u32 v12, v3, 7, v11
    v_mul_u32_u24 v13, 640, v3
    buffer_load_dwordx4 v177, s[12:15], s47 offen offset:3024 lds
    v_add_u32 v13, v13, v11
    s_mul_i32 s67, s40, 52
    s_lshr_b32 s67, s67, 8
    s_mul_i32 s3, s67, 5
    s_add_u32 m0, s55, 4032
    s_mov_b32 s47, 168960
    buffer_load_dwordx4 v174, s[12:15], s47 offen offset:0 lds
    s_sub_u32 s66, s40, s3
    s_and_b32 s3, s39, 1
    s_mul_i32 s3, s3, 5
    s_add_u32 s66, s66, s3
    buffer_load_dwordx4 v175, s[12:15], s47 offen offset:1008 lds
    s_lshr_b32 s3, s39, 1
    s_mul_i32 s3, s3, 6
    s_add_u32 s67, s67, s3
    s_mul_i32 s64, s38, 24576
    buffer_load_dwordx4 v176, s[12:15], s47 offen offset:2016 lds
    s_and_b32 s65, s38, 2
    v_lshlrev_b32 v9, 1, v2
    v_and_b32 v8, 7, v0
    v_xor_b32_e64 v8, v8, v9
    buffer_load_dwordx4 v177, s[12:15], s47 offen offset:3024 lds
    v_lshrrev_b32_e64 v9, 3, v0
    v_mul_u32_u24 v9, 3072, v9
    v_lshl_add_u32 v8, v8, 4, v9
    s_mul_i32 s3, s38, 12288
    s_add_u32 m0, s55, 8064
    s_mov_b32 s47, 184320
    buffer_load_dwordx4 v174, s[12:15], s47 offen offset:0 lds
    s_add_u32 s3, s3, s67
    s_lshl_b32 s3, s3, 7
    v_add_u32_e64 v244, s3, v8
    v_add_u32 v245, 23552, v244
    buffer_load_dwordx4 v175, s[12:15], s47 offen offset:1008 lds
    v_add_u32 v246, 47104, v244
    v_add_u32 v247, 70656, v244
    v_lshl_add_u32 v8, v6, 2, v4
    v_lshrrev_b32_e64 v9, 1, v8
    buffer_load_dwordx4 v176, s[12:15], s47 offen offset:2016 lds
    v_lshl_add_u32 v8, v3, 4, v8
    v_lshlrev_b32 v8, 7, v8
    v_lshl_add_u32 v8, v5, 3, v8
    v_xor_b32 v9, s65, v9
    buffer_load_dword v242, v243, s[28:31], s44 offen sc1
    v_lshl_add_u32 v8, v9, 5, v8
    v_add_u32 v248, s64, v8
    v_xor_b32 v249, 32, v248
    v_xor_b32_e64 v250, 64, v248
    buffer_load_dwordx4 v177, s[12:15], s47 offen offset:3024 lds
    v_xor_b32 v251, 96, v248
    s_waitcnt vmcnt(13)
    ds_read_b64_tr_b16 a[80:81], v236 offset:56576
    s_nop 0
    ds_read_b64_tr_b16 a[82:83], v236 offset:57248
    s_add_u32 m0, s55, 12096
    s_mov_b32 s47, 199680
    buffer_load_dwordx4 v174, s[12:15], s47 offen offset:0 lds
    ds_read_b64_tr_b16 a[84:85], v236 offset:56640
    ds_read_b64_tr_b16 a[86:87], v236 offset:57312
    ds_read_b64_tr_b16 a[88:89], v236 offset:56704
    ds_read_b64_tr_b16 a[90:91], v236 offset:57376
    buffer_load_dwordx4 v178, s[12:15], s47 offen offset:1008 lds
    ds_read_b64_tr_b16 a[92:93], v236 offset:56768
    ds_read_b64_tr_b16 a[94:95], v236 offset:57440
    ds_read_b64_tr_b16 a[96:97], v236 offset:56832
    ds_read_b64_tr_b16 a[98:99], v236 offset:57504
    ds_read_b64_tr_b16 a[100:101], v236 offset:63296
    ds_read_b64_tr_b16 a[102:103], v236 offset:63968
    ds_read_b64_tr_b16 a[104:105], v236 offset:63360
    ds_read_b64_tr_b16 a[106:107], v236 offset:64032
    ds_read_b64_tr_b16 a[108:109], v236 offset:63424
    ds_read_b64_tr_b16 a[110:111], v236 offset:64096
    ds_read_b64_tr_b16 a[112:113], v236 offset:63488
    ds_read_b64_tr_b16 a[114:115], v236 offset:64160
    ds_read_b64_tr_b16 a[116:117], v236 offset:63552
    ds_read_b64_tr_b16 a[118:119], v236 offset:64224
    ds_read_b64_tr_b16 a[180:181], v237 offset:56576
    ds_read_b64_tr_b16 a[184:185], v237 offset:56640
    ds_read_b64_tr_b16 a[188:189], v237 offset:56704
    ds_read_b64_tr_b16 a[192:193], v237 offset:56768
    ds_read_b64_tr_b16 a[196:197], v237 offset:56832
    s_waitcnt lgkmcnt(0)
    s_add_u32 m0, s55, 56576
    s_nop 0
    buffer_load_dwordx4 v112, s[4:7], s9 offen lds
    s_add_u32 m0, s55, 57600
    s_nop 0
    buffer_load_dwordx4 v112, s[4:7], s10 offen lds
    s_add_u32 m0, s55, 58624
    s_nop 0
    buffer_load_dwordx4 v112, s[4:7], s11 offen lds
    s_waitcnt vmcnt(6)
    v_cmp_gt_u32 vcc, 1, v242
    s_nop 0
    s_cbranch_vccz L_ok_11
    s_mov_b32 s43, 0
L_spin_12:
    s_sleep 4
    buffer_load_dword v242, v243, s[28:31], s44 offen sc1
    s_add_u32 s43, s43, 1
    s_cmp_ge_u32 s43, 20000
    s_waitcnt vmcnt(0)
    s_cbranch_scc1 L_ok_11
    v_cmp_gt_u32 vcc, 1, v242
    s_nop 1
    s_cbranch_vccnz L_spin_12
L_ok_11:
    s_add_u32 m0, s8, 0
    s_nop 0
    buffer_load_dwordx4 v7, s[28:31], s54 offen offset:0 sc1 lds
    buffer_load_dwordx4 v7, s[28:31], s54 offen offset:1024 sc1 lds
    buffer_load_dwordx4 v7, s[28:31], s54 offen offset:2048 sc1 lds
    buffer_load_dwordx4 v7, s[28:31], s54 offen offset:3072 sc1 lds
    s_add_u32 s54, s54, 4096
    s_add_u32 m0, s8, 4096
    s_nop 0
    s_nop 0
    buffer_load_dwordx4 v7, s[28:31], s54 offen offset:0 sc1 lds
    buffer_load_dwordx4 v7, s[28:31], s54 offen offset:1024 sc1 lds
    buffer_load_dwordx4 v7, s[28:31], s54 offen offset:2048 sc1 lds
    buffer_load_dwordx4 v7, s[28:31], s54 offen offset:3072 sc1 lds
    s_add_u32 s54, s54, 4096
    s_add_u32 m0, s8, 8192
    s_nop 0
    buffer_load_dwordx4 v7, s[28:31], s54 offen offset:0 sc1 lds
    s_lshl_b32 s44, s38, 12
    v_and_b32 v8, 31, v0
    v_lshlrev_b32_e64 v243, 7, v8
    s_lshl_b32 s46, s38, 14
    s_add_u32 s46, s46, 131072
    buffer_load_dword v242, v243, s[28:31], s44 offen sc1
    buffer_load_dwordx4 v7, s[28:31], s54 offen offset:1024 sc1 lds
    s_branch L_phaseB
L_helper2:
    s_load_dwordx2 s[28:29], s[0:1], 80
    s_load_dwordx2 s[12:13], s[0:1], 16
    s_nop 0
    s_load_dwordx2 s[16:17], s[0:1], 32
    s_load_dwordx2 s[32:33], s[0:1], 40
    s_load_dwordx2 s[20:21], s[0:1], 48
    s_load_dwordx2 s[34:35], s[0:1], 56
    s_load_dwordx2 s[24:25], s[0:1], 64
    s_lshr_b32 s41, s38, 1
    s_and_b32 s42, s38, 1
    s_mov_b32 s14, 819200
    s_mov_b32 s15, 0x20000
    s_mov_b32 s18, 6291456
    s_mov_b32 s19, 0x20000
    s_mov_b32 s22, 6291456
    s_mov_b32 s23, 0x20000
    s_mov_b32 s26, 2621440
    s_mov_b32 s27, 0x20000
    s_mov_b32 s30, 16777216
    s_mov_b32 s31, 0x20000
    s_load_dwordx2 s[36:37], s[0:1], 72
    v_lshrrev_b32 v3, 5, v0
    v_bfe_u32 v4, v0, 2, 2
    v_and_b32 v6, 1, v2
    v_lshlrev_b32_e64 v7, 4, v0
    s_mov_b32 s56, 0xaaaaaaaa
    s_mov_b32 s57, 0xaaaaaaaa
    s_mov_b32 s58, 0xcccccccc
    s_mov_b32 s59, 0xcccccccc
    s_cmp_eq_u32 s38, 0
    s_cselect_b64 vcc, 1, 0
    v_mov_b32 v253, 1073741824
    v_cndmask_b32 v252, v253, 0, vcc
    v_mov_b32 v253, 1
    s_mul_i32 s52, s39, 6
    s_add_u32 s52, s52, s53
    s_lshl_b32 s51, s52, 2
    s_add_u32 s51, s51, s38
    s_lshl_b32 s44, s51, 10
    s_add_u32 s45, s44, 196608
    s_add_u32 s46, s44, 393216
    s_cmp_lt_u32 s52, 16
    s_cselect_b32 s46, s46, 1073741824
    v_mov_b32 v8, 0
    v_mov_b32 v9, 0
    v_mov_b32 v10, 0
    v_mov_b32 v11, 0
    v_mov_b32 v195, 0
    v_mov_b32 v196, 0
    s_waitcnt lgkmcnt(0)
    buffer_store_dwordx4 v[8:11], v7, s[28:31], s44 offen sc1
    buffer_store_dwordx4 v[8:11], v7, s[28:31], s45 offen sc1
    buffer_store_dwordx4 v[8:11], v7, s[28:31], s46 offen sc1
    v_mov_b32 v15, 0x3f803f80
    v_lshlrev_b32 v13, 2, v13
    v_and_b32 v12, 1, v4
    v_lshl_add_u32 v13, v12, 5, v13
    v_lshl_add_u32 v13, v5, 6, v13
    v_mov_b32_e64 v12, 1073741824
    v_cndmask_b32 v13, v13, v12, s[58:59]
    s_lshl_b32 s47, s47, 7
    s_add_u32 s47, s47, 524288
    buffer_store_dword v8, v13, s[28:31], s47 offen sc1
    s_nop 0
    buffer_load_dwordx4 v[48:51], v14, s[4:7], 0 offen offset:512
    buffer_load_dwordx4 v[52:55], v14, s[4:7], s48 offen offset:512
    buffer_load_dwordx4 v[56:59], v14, s[4:7], 0 offen offset:640
    buffer_load_dwordx4 v[60:63], v14, s[4:7], s48 offen offset:640
    buffer_load_dwordx4 v[64:67], v14, s[4:7], 0 offen offset:768
    s_waitcnt vmcnt(16)
    v_dot2_f32_bf16 v96, v16, v15, 0
    v_dot2_f32_bf16 v97, v16, v16, 0
    s_nop 0
    v_dot2_f32_bf16 v98, v17, v15, 0
    v_dot2_f32_bf16 v99, v17, v17, 0
    v_dot2_f32_bf16 v100, v18, v15, 0
    v_dot2_f32_bf16 v101, v18, v18, 0
    v_dot2_f32_bf16 v102, v19, v15, 0
    v_dot2_f32_bf16 v103, v19, v19, 0
    buffer_load_dwordx4 v[68:71], v14, s[4:7], s48 offen offset:768
    s_waitcnt vmcnt(16)
    s_nop 0
    v_dot2_f32_bf16 v104, v20, v15, 0
    v_dot2_f32_bf16 v105, v20, v20, 0
    v_dot2_f32_bf16 v106, v21, v15, 0
    v_dot2_f32_bf16 v107, v21, v21, 0
    v_dot2_f32_bf16 v108, v22, v15, 0
    v_dot2_f32_bf16 v109, v22, v22, 0
    v_dot2_f32_bf16 v110, v23, v15, 0
    v_dot2_f32_bf16 v111, v23, v23, 0
    buffer_load_dwordx4 v[72:75], v14, s[4:7], 0 offen offset:896
    s_waitcnt vmcnt(16)
    v_dot2_f32_bf16 v96, v24, v15, v96
    v_dot2_f32_bf16 v97, v24, v24, v97
    s_nop 0
    v_dot2_f32_bf16 v98, v25, v15, v98
    v_dot2_f32_bf16 v99, v25, v25, v99
    v_dot2_f32_bf16 v100, v26, v15, v100
    v_dot2_f32_bf16 v101, v26, v26, v101
    v_dot2_f32_bf16 v102, v27, v15, v102
    v_dot2_f32_bf16 v103, v27, v27, v103
    buffer_load_dwordx4 v[76:79], v14, s[4:7], s48 offen offset:896
    s_waitcnt vmcnt(16)
    s_nop 0
    v_dot2_f32_bf16 v104, v28, v15, v104
L_pg3:
    s_cbranch_execz L_ret
    v_dot2_f32_bf16 v105, v28, v28, v105
    v_dot2_f32_bf16 v106, v29, v15, v106
    s_nop 0
    v_dot2_f32_bf16 v107, v29, v29, v107
    v_dot2_f32_bf16 v108, v30, v15, v108
    v_dot2_f32_bf16 v109, v30, v30, v109
    v_dot2_f32_bf16 v110, v31, v15, v110
    v_dot2_f32_bf16 v111, v31, v31, v111
    buffer_load_dwordx4 v[80:83], v14, s[4:7], 0 offen offset:1024
    s_waitcnt vmcnt(16)
    v_dot2_f32_bf16 v96, v32, v15, v96
    s_nop 0
    v_dot2_f32_bf16 v97, v32, v32, v97
    v_dot2_f32_bf16 v98, v33, v15, v98
    v_dot2_f32_bf16 v99, v33, v33, v99
    v_dot2_f32_bf16 v100, v34, v15, v100
    v_dot2_f32_bf16 v101, v34, v34, v101
    v_dot2_f32_bf16 v102, v35, v15, v102
    v_dot2_f32_bf16 v103, v35, v35, v103
    buffer_load_dwordx4 v[84:87], v14, s[4:7], s48 offen offset:1024
    s_waitcnt vmcnt(16)
    v_dot2_f32_bf16 v104, v36, v15, v104
    v_dot2_f32_bf16 v105, v36, v36, v105
    v_dot2_f32_bf16 v106, v37, v15, v106
    s_nop 0
    v_dot2_f32_bf16 v107, v37, v37, v107
    v_dot2_f32_bf16 v108, v38, v15, v108
    v_dot2_f32_bf16 v109, v38, v38, v109
    v_dot2_f32_bf16 v110, v39, v15, v110
    v_dot2_f32_bf16 v111, v39, v39, v111
    buffer_load_dwordx4 v[88:91], v14, s[4:7], 0 offen offset:1152
    s_waitcnt vmcnt(16)
    v_dot2_f32_bf16 v96, v40, v15, v96
    s_nop 0
    v_dot2_f32_bf16 v97, v40, v40, v97
    v_dot2_f32_bf16 v98, v41, v15, v98
    v_dot2_f32_bf16 v99, v41, v41, v99
    v_dot2_f32_bf16 v100, v42, v15, v100
    v_dot2_f32_bf16 v101, v42, v42, v101
    v_dot2_f32_bf16 v102, v43, v15, v102
    v_dot2_f32_bf16 v103, v43, v43, v103
    buffer_load_dwordx4 v[92:95], v14, s[4:7], s48 offen offset:1152
    s_waitcnt vmcnt(16)
    v_dot2_f32_bf16 v104, v44, v15, v104
    v_dot2_f32_bf16 v105, v44, v44, v105
    v_dot2_f32_bf16 v106, v45, v15, v106
    s_nop 0
    v_dot2_f32_bf16 v107, v45, v45, v107
    v_dot2_f32_bf16 v108, v46, v15, v108
    v_dot2_f32_bf16 v109, v46, v46, v109
    v_dot2_f32_bf16 v110, v47, v15, v110
    v_dot2_f32_bf16 v111, v47, v47, v111
    s_waitcnt vmcnt(12)
    s_barrier
    s_cmp_lg_u32 s38, 0
    s_cbranch_scc1 L_noarr_13
    s_mov_b64 exec, 1
    global_atomic_add v195, v196, v253, s[36:37] sc0 sc1
    s_mov_b64 exec, -1
L_noarr_13:
    s_waitcnt vmcnt(11)
    v_dot2_f32_bf16 v96, v48, v15, v96
    v_dot2_f32_bf16 v97, v48, v48, v97
    s_nop 0
    v_dot2_f32_bf16 v98, v49, v15, v98
    v_dot2_f32_bf16 v99, v49, v49, v99
    v_dot2_f32_bf16 v100, v50, v15, v100
    v_dot2_f32_bf16 v101, v50, v50, v101
    v_dot2_f32_bf16 v102, v51, v15, v102
    v_dot2_f32_bf16 v103, v51, v51, v103
    s_waitcnt vmcnt(10)
    v_dot2_f32_bf16 v104, v52, v15, v104
    s_nop 0
    v_dot2_f32_bf16 v105, v52, v52, v105
    v_dot2_f32_bf16 v106, v53, v15, v106
    v_dot2_f32_bf16 v107, v53, v53, v107
    v_dot2_f32_bf16 v108, v54, v15, v108
    v_dot2_f32_bf16 v109, v54, v54, v109
    v_dot2_f32_bf16 v110, v55, v15, v110
    v_dot2_f32_bf16 v111, v55, v55, v111
    s_waitcnt vmcnt(9)
    s_nop 0
    v_dot2_f32_bf16 v96, v56, v15, v96
    v_dot2_f32_bf16 v97, v56, v56, v97
    v_dot2_f32_bf16 v98, v57, v15, v98
    v_dot2_f32_bf16 v99, v57, v57, v99
    v_dot2_f32_bf16 v100, v58, v15, v100
    v_dot2_f32_bf16 v101, v58, v58, v101
    v_dot2_f32_bf16 v102, v59, v15, v102
    v_dot2_f32_bf16 v103, v59, v59, v103
    s_waitcnt vmcnt(8)
    v_dot2_f32_bf16 v104, v60, v15, v104
    v_dot2_f32_bf16 v105, v60, v60, v105
    v_dot2_f32_bf16 v106, v61, v15, v106
    s_nop 0
    v_dot2_f32_bf16 v107, v61, v61, v107
    v_dot2_f32_bf16 v108, v62, v15, v108
    v_dot2_f32_bf16 v109, v62, v62, v109
    v_dot2_f32_bf16 v110, v63, v15, v110
    v_dot2_f32_bf16 v111, v63, v63, v111
    s_waitcnt vmcnt(7)
    v_dot2_f32_bf16 v96, v64, v15, v96
    v_dot2_f32_bf16 v97, v64, v64, v97
    s_nop 0
    v_dot2_f32_bf16 v98, v65, v15, v98
    v_dot2_f32_bf16 v99, v65, v65, v99
    v_dot2_f32_bf16 v100, v66, v15, v100
    v_dot2_f32_bf16 v101, v66, v66, v101
    v_dot2_f32_bf16 v102, v67, v15, v102
    v_dot2_f32_bf16 v103, v67, v67, v103
    s_waitcnt vmcnt(6)
    v_dot2_f32_bf16 v104, v68, v15, v104
    s_nop 0
    v_dot2_f32_bf16 v105, v68, v68, v105
    v_dot2_f32_bf16 v106, v69, v15, v106
    v_dot2_f32_bf16 v107, v69, v69, v107
    v_dot2_f32_bf16 v108, v70, v15, v108
    v_dot2_f32_bf16 v109, v70, v70, v109
    v_dot2_f32_bf16 v110, v71, v15, v110
    v_dot2_f32_bf16 v111, v71, v71, v111
    s_waitcnt vmcnt(5)
    s_nop 0
    v_dot2_f32_bf16 v96, v72, v15, v96
    v_dot2_f32_bf16 v97, v72, v72, v97
    v_dot2_f32_bf16 v98, v73, v15, v98
    v_dot2_f32_bf16 v99, v73, v73, v99
    v_dot2_f32_bf16 v100, v74, v15, v100
    v_dot2_f32_bf16 v101, v74, v74, v101
    v_dot2_f32_bf16 v102, v75, v15, v102
    v_dot2_f32_bf16 v103, v75, v75, v103
    s_waitcnt vmcnt(4)
    v_dot2_f32_bf16 v104, v76, v15, v104
    v_dot2_f32_bf16 v105, v76, v76, v105
    v_dot2_f32_bf16 v106, v77, v15, v106
    s_nop 0
    v_dot2_f32_bf16 v107, v77, v77, v107
    v_dot2_f32_bf16 v108, v78, v15, v108
    v_dot2_f32_bf16 v109, v78, v78, v109
    v_dot2_f32_bf16 v110, v79, v15, v110
    v_dot2_f32_bf16 v111, v79, v79, v111
    s_waitcnt vmcnt(3)
    v_dot2_f32_bf16 v96, v80, v15, v96
    v_dot2_f32_bf16 v97, v80, v80, v97
    s_nop 0
    v_dot2_f32_bf16 v98, v81, v15, v98
    v_dot2_f32_bf16 v99, v81, v81, v99
    v_dot2_f32_bf16 v100, v82, v15, v100
    v_dot2_f32_bf16 v101, v82, v82, v101
    v_dot2_f32_bf16 v102, v83, v15, v102
    v_dot2_f32_bf16 v103, v83, v83, v103
    s_waitcnt vmcnt(2)
    v_dot2_f32_bf16 v104, v84, v15, v104
    s_nop 0
    v_dot2_f32_bf16 v105, v84, v84, v105
    v_dot2_f32_bf16 v106, v85, v15, v106
    v_dot2_f32_bf16 v107, v85, v85, v107
    v_dot2_f32_bf16 v108, v86, v15, v108
    v_dot2_f32_bf16 v109, v86, v86, v109
    v_dot2_f32_bf16 v110, v87, v15, v110
    v_dot2_f32_bf16 v111, v87, v87, v111
    s_waitcnt vmcnt(1)
    s_nop 0
    v_dot2_f32_bf16 v96, v88, v15, v96
    v_dot2_f32_bf16 v97, v88, v88, v97
    v_dot2_f32_bf16 v98, v89, v15, v98
    v_dot2_f32_bf16 v99, v89, v89, v99
    v_dot2_f32_bf16 v100, v90, v15, v100
    v_dot2_f32_bf16 v101, v90, v90, v101
    v_dot2_f32_bf16 v102, v91, v15, v102
    v_dot2_f32_bf16 v103, v91, v91, v103
    s_waitcnt vmcnt(0)
    v_dot2_f32_bf16 v104, v92, v15, v104
    v_dot2_f32_bf16 v105, v92, v92, v105
    v_dot2_f32_bf16 v106, v93, v15, v106
    s_nop 0
    v_dot2_f32_bf16 v107, v93, v93, v107
    v_dot2_f32_bf16 v108, v94, v15, v108
    v_dot2_f32_bf16 v109, v94, v94, v109
    v_dot2_f32_bf16 v110, v95, v15, v110
    v_dot2_f32_bf16 v111, v95, v95, v111
    s_waitcnt vmcnt(0)
    v_readfirstlane_b32 s3, v195
    s_nop 0
    s_cmp_lg_u32 s3, 47
    s_cbranch_scc1 L_nogo_14
    s_nop 0
    global_store_dword v196, v253, s[36:37] offset:128 sc1
L_nogo_14:
    v_pk_add_f32 v[96:97], v[96:97], v[100:101]
    v_pk_add_f32 v[98:99], v[98:99], v[102:103]
    v_pk_add_f32 v[104:105], v[104:105], v[108:109]
    v_pk_add_f32 v[106:107], v[106:107], v[110:111]
    v_pk_add_f32 v[96:97], v[96:97], v[98:99]
    v_pk_add_f32 v[104:105], v[104:105], v[106:107]
    s_nop 0
    v_add_f32_dpp v100, v96, v96 row_half_mirror row_mask:0xf bank_mask:0xf
    v_add_f32_dpp v101, v97, v97 row_half_mirror row_mask:0xf bank_mask:0xf
    s_nop 0
    v_add_f32_dpp v100, v104, v104 row_half_mirror row_mask:0xf bank_mask:0xa
    v_add_f32_dpp v101, v105, v105 row_half_mirror row_mask:0xf bank_mask:0xa
    s_nop 0
    v_add_f32_dpp v98, v100, v100 quad_perm:[1,0,3,2] row_mask:0xf bank_mask:0xf
    v_add_f32_dpp v99, v101, v101 quad_perm:[1,0,3,2] row_mask:0xf bank_mask:0xf
    s_nop 0
    v_add_f32_dpp v96, v98, v98 quad_perm:[2,3,0,1] row_mask:0xf bank_mask:0xf
    v_add_f32_dpp v97, v99, v99 quad_perm:[2,3,0,1] row_mask:0xf bank_mask:0xf
    v_mul_f32 v96, 0xbacccccd, v96
    v_mul_f32 v97, 0x3acccccd, v97
    v_fma_f32 v97, -v96, v96, v97
    v_max_f32 v97, 0, v97
    v_add_f32 v97, 0x3727c5ac, v97
    v_rsq_f32 v97, v97
    s_nop 0
    v_cndmask_b32 v96, v96, v97, s[56:57]
    v_or_b32 v96, 1, v96
    buffer_store_dword v96, v13, s[28:31], s47 offen sc1
    s_branch L_hjoin
L_hcol2:
    s_load_dwordx2 s[28:29], s[0:1], 80
    s_load_dwordx2 s[12:13], s[0:1], 16
    s_nop 0
    s_load_dwordx2 s[16:17], s[0:1], 32
    s_load_dwordx2 s[32:33], s[0:1], 40
    s_load_dwordx2 s[20:21], s[0:1], 48
    s_load_dwordx2 s[34:35], s[0:1], 56
    s_load_dwordx2 s[24:25], s[0:1], 64
    s_lshr_b32 s41, s38, 1
    s_and_b32 s42, s38, 1
    s_mov_b32 s14, 819200
    s_mov_b32 s15, 0x20000
    s_mov_b32 s18, 6291456
    s_mov_b32 s19, 0x20000
    s_mov_b32 s22, 6291456
    s_mov_b32 s23, 0x20000
    s_mov_b32 s26, 2621440
    s_mov_b32 s27, 0x20000
    s_mov_b32 s30, 16777216
    s_mov_b32 s31, 0x20000
    s_load_dwordx2 s[36:37], s[0:1], 72
    v_lshrrev_b32 v3, 5, v0
    v_bfe_u32 v4, v0, 2, 2
    v_and_b32 v6, 1, v2
    v_lshlrev_b32_e64 v7, 4, v0
    s_mov_b32 s56, 0xaaaaaaaa
    s_mov_b32 s57, 0xaaaaaaaa
    s_mov_b32 s58, 0xcccccccc
    s_mov_b32 s59, 0xcccccccc
    s_cmp_eq_u32 s38, 0
    s_cselect_b64 vcc, 1, 0
    v_mov_b32 v253, 1073741824
    v_cndmask_b32 v252, v253, 0, vcc
    v_mov_b32 v253, 1
    s_mul_i32 s52, s39, 6
    s_add_u32 s52, s52, s53
    s_lshl_b32 s51, s52, 2
    s_add_u32 s51, s51, s38
    s_lshl_b32 s44, s51, 10
    s_add_u32 s45, s44, 196608
    s_add_u32 s46, s44, 393216
    s_cmp_lt_u32 s52, 16
    s_cselect_b32 s46, s46, 1073741824
    v_mov_b32 v8, 0
    v_mov_b32 v9, 0
    v_mov_b32 v10, 0
    v_mov_b32 v11, 0
    v_mov_b32 v195, 0
    v_mov_b32 v196, 0
    s_waitcnt lgkmcnt(0)
    buffer_store_dwordx4 v[8:11], v7, s[28:31], s44 offen sc1
    buffer_store_dwordx4 v[8:11], v7, s[28:31], s45 offen sc1
    buffer_store_dwordx4 v[8:11], v7, s[28:31], s46 offen sc1
    v_mov_b32 v12, 0x3f80
    v_mov_b32 v15, 0x3f800000
    v_cmp_eq_u32 vcc, 0, v1
    v_cmp_eq_u32 s[44:45], 1, v1
    s_nop 0
    v_cndmask_b32 v13, 0, v12, vcc
    v_cndmask_b32 v180, v13, v15, s[44:45]
    v_cmp_eq_u32 vcc, 2, v1
    v_cmp_eq_u32 s[44:45], 3, v1
    s_nop 0
    v_cndmask_b32 v13, 0, v12, vcc
    v_cndmask_b32 v181, v13, v15, s[44:45]
    v_cmp_eq_u32 vcc, 4, v1
    v_cmp_eq_u32 s[44:45], 5, v1
    s_nop 0
    v_cndmask_b32 v13, 0, v12, vcc
    v_cndmask_b32 v182, v13, v15, s[44:45]
    v_cmp_eq_u32 vcc, 6, v1
    v_cmp_eq_u32 s[44:45], 7, v1
    s_nop 0
    v_cndmask_b32 v13, 0, v12, vcc
    v_cndmask_b32 v183, v13, v15, s[44:45]
    v_lshlrev_b32 v184, 5, v1
    v_lshl_add_u32 v184, v2, 4, v184
    v_mov_b32 v12, 1073741824
    v_cmp_gt_u32 vcc, 2, v2
    s_lshl_b32 s47, s47, 9
    s_add_u32 s47, s47, 540672
    s_cmp_eq_u32 s38, 0
    s_cselect_b32 s47, s47, 1073741824
    v_cndmask_b32 v184, v12, v184, vcc
    buffer_store_dwordx4 v[8:11], v184, s[28:31], s47 offen sc1
    buffer_load_dwordx4 v[48:51], v14, s[8:11], s48 offen
    s_add_u32 s48, s48, 61440
    buffer_load_dwordx4 v[52:55], v14, s[8:11], s48 offen
    s_add_u32 s48, s48, 61440
    buffer_load_dwordx4 v[56:59], v14, s[8:11], s48 offen
    s_add_u32 s48, s48, 61440
    buffer_load_dwordx4 v[60:63], v14, s[8:11], s48 offen
    s_add_u32 s48, s48, 61440
    buffer_load_dwordx4 v[64:67], v14, s[8:11], s48 offen
    s_add_u32 s48, s48, 61440
    s_waitcnt vmcnt(16)
    v_mfma_f32_16x16x32_bf16 v[176:179], v[180:183], v[16:19], 0
    buffer_load_dwordx4 v[68:71], v14, s[8:11], s48 offen
    s_add_u32 s48, s48, 61440
    s_waitcnt vmcnt(16)
    v_mfma_f32_16x16x32_bf16 v[176:179], v[180:183], v[20:23], v[176:179]
    buffer_load_dwordx4 v[72:75], v14, s[8:11], s48 offen
    s_add_u32 s48, s48, 61440
    s_waitcnt vmcnt(16)
    v_mfma_f32_16x16x32_bf16 v[176:179], v[180:183], v[24:27], v[176:179]
    buffer_load_dwordx4 v[76:79], v14, s[8:11], s48 offen
    s_add_u32 s48, s48, 61440
    s_waitcnt vmcnt(16)
    v_mfma_f32_16x16x32_bf16 v[176:179], v[180:183], v[28:31], v[176:179]
    buffer_load_dwordx4 v[80:83], v14, s[8:11], s48 offen
    s_add_u32 s48, s48, 61440
    s_waitcnt vmcnt(16)
    v_mfma_f32_16x16x32_bf16 v[176:179], v[180:183], v[32:35], v[176:179]
    buffer_load_dwordx4 v[84:87], v14, s[8:11], s48 offen
    s_add_u32 s48, s48, 61440
    s_waitcnt vmcnt(16)
    v_mfma_f32_16x16x32_bf16 v[176:179], v[180:183], v[36:39], v[176:179]
    buffer_load_dwordx4 v[88:91], v14, s[8:11], s48 offen
    s_add_u32 s48, s48, 61440
    s_waitcnt vmcnt(16)
    v_mfma_f32_16x16x32_bf16 v[176:179], v[180:183], v[40:43], v[176:179]
    buffer_load_dwordx4 v[92:95], v14, s[8:11], s48 offen
    s_add_u32 s48, s48, 61440
    s_waitcnt vmcnt(16)
    v_mfma_f32_16x16x32_bf16 v[176:179], v[180:183], v[44:47], v[176:179]
    buffer_load_dwordx4 v[96:99], v14, s[8:11], s48 offen
    s_add_u32 s48, s48, 61440
    s_waitcnt vmcnt(13)
    s_barrier
    s_cmp_lg_u32 s38, 0
    s_cbranch_scc1 L_noarr_15
    s_mov_b64 exec, 1
    global_atomic_add v195, v196, v253, s[36:37] sc0 sc1
    s_mov_b64 exec, -1
L_noarr_15:
    s_waitcnt vmcnt(12)
    v_mfma_f32_16x16x32_bf16 v[176:179], v[180:183], v[48:51], v[176:179]
    buffer_load_dwordx4 v[100:103], v14, s[8:11], s48 offen
    s_add_u32 s48, s48, 61440
    s_waitcnt vmcnt(12)
    v_mfma_f32_16x16x32_bf16 v[176:179], v[180:183], v[52:55], v[176:179]
    buffer_load_dwordx4 v[104:107], v14, s[8:11], s48 offen
    s_add_u32 s48, s48, 61440
    s_waitcnt vmcnt(12)
    v_mfma_f32_16x16x32_bf16 v[176:179], v[180:183], v[56:59], v[176:179]
    buffer_load_dwordx4 v[108:111], v14, s[8:11], s48 offen
    s_add_u32 s48, s48, 61440
    s_waitcnt vmcnt(12)
    v_mfma_f32_16x16x32_bf16 v[176:179], v[180:183], v[60:63], v[176:179]
    buffer_load_dwordx4 v[112:115], v14, s[8:11], s48 offen
    s_add_u32 s48, s48, 61440
    s_waitcnt vmcnt(12)
    v_mfma_f32_16x16x32_bf16 v[176:179], v[180:183], v[64:67], v[176:179]
    buffer_load_dwordx4 v[116:119], v14, s[8:11], s48 offen
    s_add_u32 s48, s48, 61440
    s_waitcnt vmcnt(12)
    v_mfma_f32_16x16x32_bf16 v[176:179], v[180:183], v[68:71], v[176:179]
    buffer_load_dwordx4 v[120:123], v14, s[8:11], s48 offen
    s_add_u32 s48, s48, 61440
    s_waitcnt vmcnt(12)
    v_mfma_f32_16x16x32_bf16 v[176:179], v[180:183], v[72:75], v[176:179]
    buffer_load_dwordx4 v[124:127], v14, s[8:11], s48 offen
    s_add_u32 s48, s48, 61440
    s_waitcnt vmcnt(12)
    v_mfma_f32_16x16x32_bf16 v[176:179], v[180:183], v[76:79], v[176:179]
    buffer_load_dwordx4 v[128:131], v14, s[8:11], s48 offen
    s_add_u32 s48, s48, 61440
    s_waitcnt vmcnt(12)
    v_mfma_f32_16x16x32_bf16 v[176:179], v[180:183], v[80:83], v[176:179]
    buffer_load_dwordx4 v[132:135], v14, s[8:11], s48 offen
    s_add_u32 s48, s48, 61440
    s_waitcnt vmcnt(12)
    v_mfma_f32_16x16x32_bf16 v[176:179], v[180:183], v[84:87], v[176:179]
    buffer_load_dwordx4 v[136:139], v14, s[8:11], s48 offen
    s_add_u32 s48, s48, 61440
    s_waitcnt vmcnt(12)
    v_mfma_f32_16x16x32_bf16 v[176:179], v[180:183], v[88:91], v[176:179]
    buffer_load_dwordx4 v[140:143], v14, s[8:11], s48 offen
    s_add_u32 s48, s48, 61440
    s_waitcnt vmcnt(12)
    v_mfma_f32_16x16x32_bf16 v[176:179], v[180:183], v[92:95], v[176:179]
    buffer_load_dwordx4 v[144:147], v14, s[8:11], s48 offen
    s_add_u32 s48, s48, 61440
    s_waitcnt vmcnt(12)
    v_mfma_f32_16x16x32_bf16 v[176:179], v[180:183], v[96:99], v[176:179]
    buffer_load_dwordx4 v[148:151], v14, s[8:11], s48 offen
    s_add_u32 s48, s48, 61440
    s_waitcnt vmcnt(12)
    v_mfma_f32_16x16x32_bf16 v[176:179], v[180:183], v[100:103], v[176:179]
    buffer_load_dwordx4 v[152:155], v14, s[8:11], s48 offen
    s_add_u32 s48, s48, 61440
    v_readfirstlane_b32 s3, v195
    s_nop 0
    s_cmp_lg_u32 s3, 47
    s_cbranch_scc1 L_nogo_16
    global_store_dword v196, v253, s[36:37] offset:128 sc1
L_nogo_16:
    s_waitcnt vmcnt(12)
    v_mfma_f32_16x16x32_bf16 v[176:179], v[180:183], v[104:107], v[176:179]
    buffer_load_dwordx4 v[156:159], v14, s[8:11], s48 offen
    s_add_u32 s48, s48, 61440
    s_waitcnt vmcnt(12)
    v_mfma_f32_16x16x32_bf16 v[176:179], v[180:183], v[108:111], v[176:179]
    buffer_load_dwordx4 v[160:163], v14, s[8:11], s48 offen
    s_add_u32 s48, s48, 61440
    s_waitcnt vmcnt(12)
    v_mfma_f32_16x16x32_bf16 v[176:179], v[180:183], v[112:115], v[176:179]
    buffer_load_dwordx4 v[164:167], v14, s[8:11], s48 offen
    s_add_u32 s48, s48, 61440
    s_waitcnt vmcnt(12)
    v_mfma_f32_16x16x32_bf16 v[176:179], v[180:183], v[116:119], v[176:179]
    buffer_load_dwordx4 v[168:171], v14, s[8:11], s48 offen
    s_add_u32 s48, s48, 61440
    s_waitcnt vmcnt(12)
    v_mfma_f32_16x16x32_bf16 v[176:179], v[180:183], v[120:123], v[176:179]
    buffer_load_dwordx4 v[172:175], v14, s[8:11], s48 offen
    s_add_u32 s48, s48, 61440
    s_waitcnt vmcnt(12)
    v_mfma_f32_16x16x32_bf16 v[176:179], v[180:183], v[124:127], v[176:179]
    s_waitcnt vmcnt(11)
    v_mfma_f32_16x16x32_bf16 v[176:179], v[180:183], v[128:131], v[176:179]
    s_waitcnt vmcnt(10)
    v_mfma_f32_16x16x32_bf16 v[176:179], v[180:183], v[132:135], v[176:179]
    s_waitcnt vmcnt(9)
    v_mfma_f32_16x16x32_bf16 v[176:179], v[180:183], v[136:139], v[176:179]
    s_waitcnt vmcnt(8)
    v_mfma_f32_16x16x32_bf16 v[176:179], v[180:183], v[140:143], v[176:179]
    s_waitcnt vmcnt(7)
    v_mfma_f32_16x16x32_bf16 v[176:179], v[180:183], v[144:147], v[176:179]
    s_waitcnt vmcnt(6)
    v_mfma_f32_16x16x32_bf16 v[176:179], v[180:183], v[148:151], v[176:179]
    s_waitcnt vmcnt(5)
    v_mfma_f32_16x16x32_bf16 v[176:179], v[180:183], v[152:155], v[176:179]
    s_waitcnt vmcnt(4)
    v_mfma_f32_16x16x32_bf16 v[176:179], v[180:183], v[156:159], v[176:179]
    s_waitcnt vmcnt(3)
    v_mfma_f32_16x16x32_bf16 v[176:179], v[180:183], v[160:163], v[176:179]
    s_waitcnt vmcnt(2)
    v_mfma_f32_16x16x32_bf16 v[176:179], v[180:183], v[164:167], v[176:179]
    s_waitcnt vmcnt(1)
    v_mfma_f32_16x16x32_bf16 v[176:179], v[180:183], v[168:171], v[176:179]
    s_waitcnt vmcnt(0)
    v_mfma_f32_16x16x32_bf16 v[176:179], v[180:183], v[172:175], v[176:179]
    s_lshl_b32 s3, s38, 10
    v_add_u32_e64 v13, s3, v7
    s_nop 5
    ds_write_b128 v13, v[176:179]
    s_waitcnt lgkmcnt(0)
    s_barrier
    ds_read_b128 v[20:23], v7 offset:1024
    ds_read_b128 v[24:27], v7 offset:2048
    ds_read_b128 v[28:31], v7 offset:3072
    s_waitcnt lgkmcnt(2)
    v_pk_add_f32 v[176:177], v[176:177], v[20:21]
    v_pk_add_f32 v[178:179], v[178:179], v[22:23]
    s_waitcnt lgkmcnt(1)
    v_pk_add_f32 v[176:177], v[176:177], v[24:25]
    v_pk_add_f32 v[178:179], v[178:179], v[26:27]
    s_waitcnt lgkmcnt(0)
    v_pk_add_f32 v[176:177], v[176:177], v[28:29]
    v_pk_add_f32 v[178:179], v[178:179], v[30:31]
    v_or_b32 v176, 1, v176
    v_or_b32 v177, 1, v177
    v_or_b32 v178, 1, v178
    v_or_b32 v179, 1, v179
    buffer_store_dwordx4 v[176:179], v184, s[28:31], s47 offen sc1
L_hjoin:
    s_barrier
    v_min_u32 v12, 33, v0
    v_lshlrev_b32 v12, 7, v12
    s_mul_i32 s46, s51, 4352
    s_lshl_b32 s3, s53, 2
    s_add_u32 s3, s3, s38
    s_mul_i32 s44, s3, 5
    s_mul_i32 s3, s3, 2
    s_add_u32 s3, s3, 48
    s_cmp_ge_u32 s53, 4
    s_cselect_b32 s3, s3, s44
    s_cselect_b32 s45, 1073741824, 8192
    s_mul_i32 s44, s39, 96
    s_add_u32 s3, s3, s44
    s_lshl_b32 s10, s3, 13
    v_lshlrev_b32 v198, 7, v0
    buffer_load_dword v255, v12, s[12:15], s46 offen
    s_and_b32 s3, s51, 31
    s_lshl_b32 s3, s3, 7
    v_mov_b32_e64 v13, s3
    global_load_dword v255, v13, s[34:35]
    v_min_u32 v13, 2944, v13
    global_load_dword v255, v13, s[32:33]
    s_mov_b32 s11, s45
    buffer_load_dword v255, v198, s[20:23], s10 offen
    s_add_u32 s10, s10, 8192
    buffer_load_dword v255, v198, s[20:23], s10 offen
    s_add_u32 s10, s10, s11
    buffer_load_dword v255, v198, s[20:23], s10 offen
    s_add_u32 s10, s10, 8192
    buffer_load_dword v255, v198, s[20:23], s10 offen
    s_add_u32 s10, s10, 8192
    buffer_load_dword v255, v198, s[20:23], s10 offen
    v_min_u32 v15, 7, v0
    v_lshlrev_b32 v15, 21, v15
    v_bfe_u32 v14, v15, 21, 1
    v_lshl_add_u32 v14, v14, 20, v15
    s_cmp_eq_u32 s38, 0
    s_cselect_b32 s0, 0, 1073741824
    s_add_u32 s0, s0, 983040
    buffer_load_dword v255, v14, s[28:31], s0 offen
    s_cmp_eq_u32 s38, 1
    s_cselect_b32 s0, 0, 1073741824
    buffer_load_dword v255, v15, s[16:19], s0 offen
    s_cmp_eq_u32 s38, 2
    s_cselect_b32 s0, 0, 1073741824
    buffer_load_dword v255, v15, s[20:23], s0 offen
    s_cmp_eq_u32 s38, 3
    s_cselect_b32 s0, 0, 1073741824
    buffer_load_dword v255, v15, s[24:27], s0 offen
    s_mov_b64 exec, 0
    s_cmp_lg_u32 s38, 0
    s_cbranch_scc1 L_wn_18
    s_call_b64 s[62:63], L_pg4
    s_call_b64 s[62:63], L_pg11
    s_nop 0
    s_branch L_wd_17
L_wn_18:
    s_cmp_lg_u32 s38, 1
    s_cbranch_scc1 L_wn_19
    s_call_b64 s[62:63], L_pg8
    s_call_b64 s[62:63], L_pg12
    s_nop 0
    s_branch L_wd_17
L_wn_19:
    s_cmp_lg_u32 s38, 2
    s_cbranch_scc1 L_wn_20
    s_call_b64 s[62:63], L_pg9
    s_call_b64 s[62:63], L_pg13
    s_nop 0
    s_branch L_wd_17
L_wn_20:
    s_call_b64 s[62:63], L_pg10
    s_call_b64 s[62:63], L_pg14
    s_nop 0
L_wd_17:
    s_mov_b64 exec, -1
    s_lshl_b32 s68, s39, 3
    s_lshr_b32 s3, s40, 2
    s_add_u32 s68, s68, s3
    s_and_b32 s69, s40, 3
    v_mul_u32_u24 v8, 49, v0
    v_lshrrev_b32 v8, 10, v8
    v_mul_u32_u24 v9, 21, v8
    v_sub_u32 v9, v0, v9
    v_min_u32 v9, 19, v9
    v_lshrrev_b32 v10, 2, v9
    v_and_b32 v9, 3, v9
    v_sub_u32_e64 v11, 4, v10
    v_cmp_eq_u32 vcc, 1, s42
    v_lshlrev_b32 v9, 4, v9
    v_mul_u32_u24 v8, 1280, v8
    v_cndmask_b32 v10, v10, v11, vcc
    v_lshl_add_u32 v9, v10, 6, v9
    s_mul_i32 s3, s38, 204800
    s_mul_i32 s55, s69, 320
    s_add_u32 s3, s3, s55
    v_add3_u32 v174, v8, v9, s3
    v_add_u32 v175, 2832, v174
    v_add_u32 v176, 5664, v174
    v_add_u32 v177, 8496, v174
    v_cmp_gt_u32 vcc, 21, v0
    v_mov_b32 v9, 1073741824
    v_lshlrev_b32 v8, 5, v6
    v_cndmask_b32 v178, v9, v175, vcc
    v_lshl_add_u32 v8, v5, 3, v8
    s_mul_i32 s55, s38, 14144
    s_add_u32 s55, s55, 50688
    v_add_u32 v8, s55, v8
    v_lshl_add_u32 v9, v4, 2, v3
    v_mul_u32_u24 v9, 336, v9
    v_add_u32 v236, v8, v9
    v_lshrrev_b32 v9, 1, v4
    v_mul_u32_u24 v9, 20, v9
    v_and_b32 v10, 1, v4
    v_lshl_add_u32 v10, v3, 1, v10
    v_add3_u32 v9, v9, v10, 16
    v_mul_u32_u24 v9, 336, v9
    v_add_u32 v237, v8, v9
    s_lshr_b32 s3, s68, 2
    s_mul_i32 s3, s3, 5
    s_add_u32 s3, s3, s38
    s_lshl_b32 s3, s3, 7
    s_add_u32 s44, s3, 16384
    v_and_b32 v8, 1, v0
    v_lshlrev_b32 v243, 7, v8
    v_and_b32 v8, 31, v0
    s_lshl_b32 s3, s68, 1
    s_add_u32 s45, s3, s41
    s_lshl_b32 s3, s45, 4
    v_lshrrev_b32 v9, 2, v0
    v_add_u32_e64 v9, s3, v9
    v_mul_u32_u24 v9, 1280, v9
    v_lshl_add_u32 v112, v5, 4, v9
    s_mul_i32 s50, s69, 320
    s_lshl_b32 s3, s42, 8
    s_add_u32 s9, s50, s3
    s_lshl_b32 s3, s42, 7
    s_add_u32 s10, s50, s3
    s_add_u32 s10, s10, 64
    s_lshl_b32 s3, s42, 28
    s_add_u32 s11, s50, s3
    s_add_u32 s11, s11, 128
    v_lshlrev_b32 v11, 3, v3
    v_add_u32 v12, v11, v4
    v_lshlrev_b32 v12, 6, v12
    v_lshl_add_u32 v12, v6, 5, v12
    v_lshl_add_u32 v12, v5, 3, v12
    v_add_u32 v235, s55, v12
    v_sub_u32 v11, v8, v11
    v_and_b32 v12, 1, v11
    v_lshlrev_b32 v12, 4, v12
    v_lshlrev_b32 v12, v12, v253
    v_mul_u32_u24 v12, 0x3f80, v12
    v_lshrrev_b32 v11, 1, v11
    v_mov_b32 v10, 1073741824
    v_cmp_eq_u32 vcc, 0, v11
    v_cmp_eq_u32 s[60:61], 1, v11
    v_mov_b32 v226, 0
    v_cndmask_b32 v13, 0, v12, vcc
    v_cndmask_b32 v14, 0, v12, s[60:61]
    v_accvgpr_write_b32 a252, v13
    v_accvgpr_write_b32 a253, v14
    v_cmp_eq_u32 vcc, 2, v11
    v_cmp_eq_u32 s[60:61], 3, v11
    v_mov_b32_e64 v227, 0
    v_cndmask_b32 v13, 0, v12, vcc
    v_cndmask_b32 v14, 0, v12, s[60:61]
    v_accvgpr_write_b32 a254, v13
L_pg4:
    s_cbranch_execz L_ret
    v_accvgpr_write_b32 a255, v14
    v_lshlrev_b32 v11, 4, v8
    v_lshl_add_u32 v12, v3, 9, v11
    v_add_u32 v11, 1024, v11
    v_cmp_eq_u32 vcc, 2, v5
    v_bfe_u32 v13, v8, 2, 1
    v_and_b32 v14, 1, v8
    v_lshl_add_u32 v13, v13, 1, v14
    v_cndmask_b32 v13, v13, 4, vcc
    v_cmp_eq_u32 vcc, 3, v5
    v_lshlrev_b32 v13, 7, v13
    v_add_u32 v13, 1280, v13
    v_cndmask_b32 v13, v13, v10, vcc
    v_cmp_le_u32 vcc, 24, v8
    s_lshl_b32 s3, s68, 2
    s_add_u32 s52, s3, s69
    v_cndmask_b32 v13, v13, v10, vcc
    v_cmp_gt_u32 vcc, 16, v8
    v_lshl_add_u32 v14, v3, 5, v13
    v_add_u32 v13, 64, v13
    v_cndmask_b32 v238, v14, v12, vcc
    v_add_u32 v12, 256, v12
    v_add_u32_e64 v14, 16, v14
    v_cndmask_b32 v239, v14, v12, vcc
    v_cndmask_b32 v11, v13, v11, vcc
    v_cmp_eq_u32 vcc, 0, v3
    s_add_u32 s3, s3, s38
    s_mul_i32 s3, s3, 10240
    v_cndmask_b32 v240, v10, v11, vcc
    v_cndmask_b32 v241, v11, v10, vcc
    s_add_u32 s54, s3, 1048576
    s_mul_i32 s8, s38, 10240
    s_lshl_b32 s52, s52, 7
    s_add_u32 s52, s52, 32768
    s_mul_i32 s62, s41, 5
    s_lshl_b32 s3, s42, 2
    s_sub_u32 s63, 5, s62
    s_add_u32 s62, s62, s3
    s_add_u32 s63, s63, s3
    s_mul_i32 s62, s62, 6144
    s_mul_i32 s63, s63, 6144
    s_add_u32 s62, s62, 98304
    s_add_u32 s63, s63, 98304
    s_mul_i32 s0, s42, -12288
    s_add_u32 s0, s0, 6144
    s_lshl_b32 s1, s42, 11
    s_mul_i32 s50, s69, 5
    s_lshl_b32 s50, s50, 7
    s_add_u32 s50, s50, s45
    s_lshl_b32 s50, s50, 10
    s_add_u32 s50, s50, 5242880
    s_lshl_b32 s3, s42, 19
    s_add_u32 s48, s50, s3
    s_lshl_b32 s3, s42, 18
    s_add_u32 s49, s50, s3
    s_add_u32 s49, s49, 131072
    s_lshl_b32 s3, s42, 30
    s_add_u32 s50, s50, s3
    s_add_u32 s50, s50, 262144
    s_sub_u32 s60, 0, s42
    s_mov_b32 s61, s60
    v_and_b32 v8, 1, v0
    v_lshl_add_u32 v8, v4, 1, v8
    v_lshlrev_b32 v8, 2, v8
    v_lshl_add_u32 v8, v2, 5, v8
    v_cndmask_b32 v15, v8, v10, s[58:59]
    s_lshl_b32 s51, s45, 10
    s_add_u32 s51, s51, 196608
    s_lshl_b32 s3, s69, 1
    s_add_u32 s3, s3, s42
    s_lshl_b32 s3, s3, 7
    s_add_u32 s53, s51, s3
    v_mul_u32_u24 v11, 2560, v5
    v_xor_b32 v12, s41, v6
    v_lshl_add_u32 v11, v12, 3, v11
    v_lshl_add_u32 v11, v4, 4, v11
    v_add_u32 v11, s8, v11
    v_lshl_add_u32 v12, v3, 7, v11
    v_mul_u32_u24 v13, 640, v3
    v_add_u32 v13, v13, v11
    s_mul_i32 s67, s40, 52
    s_lshr_b32 s67, s67, 8
    s_mul_i32 s3, s67, 5
    s_sub_u32 s66, s40, s3
    s_and_b32 s3, s39, 1
    s_mul_i32 s3, s3, 5
    s_add_u32 s66, s66, s3
    s_lshr_b32 s3, s39, 1
    s_mul_i32 s3, s3, 6
    s_add_u32 s67, s67, s3
    s_mul_i32 s64, s38, 24576
    s_and_b32 s65, s38, 2
    v_lshlrev_b32 v9, 1, v2
    v_and_b32 v8, 7, v0
    v_xor_b32 v8, v8, v9
    v_lshrrev_b32 v9, 3, v0
    v_mul_u32_u24 v9, 3072, v9
    v_lshl_add_u32 v8, v8, 4, v9
    s_mul_i32 s3, s38, 12288
    s_add_u32 s3, s3, s67
    s_lshl_b32 s3, s3, 7
    v_add_u32_e64 v244, s3, v8
    v_add_u32 v245, 23552, v244
    v_add_u32 v246, 47104, v244
    v_add_u32 v247, 70656, v244
    v_lshl_add_u32 v8, v6, 2, v4
    v_lshrrev_b32_e64 v9, 1, v8
    v_lshl_add_u32 v8, v3, 4, v8
    v_lshlrev_b32 v8, 7, v8
    v_lshl_add_u32 v8, v5, 3, v8
    v_xor_b32 v9, s65, v9
    v_lshl_add_u32 v8, v9, 5, v8
    v_add_u32 v248, s64, v8
    v_xor_b32 v249, 32, v248
    v_xor_b32_e64 v250, 64, v248
    v_xor_b32 v251, 96, v248
    global_load_dword v195, v196, s[36:37] offset:128 sc1
    s_add_u32 m0, s55, 56576
    s_mov_b32 s47, 0
    buffer_load_dwordx4 v174, s[12:15], s47 offen offset:0 lds
    buffer_load_dwordx4 v175, s[12:15], s47 offen offset:1008 lds
    s_nop 0
    buffer_load_dwordx4 v176, s[12:15], s47 offen offset:2016 lds
    buffer_load_dwordx4 v177, s[12:15], s47 offen offset:3024 lds
    s_add_u32 m0, s55, 60608
    s_mov_b32 s47, 15360
    buffer_load_dwordx4 v174, s[12:15], s47 offen offset:0 lds
    buffer_load_dwordx4 v175, s[12:15], s47 offen offset:1008 lds
    buffer_load_dwordx4 v176, s[12:15], s47 offen offset:2016 lds
    buffer_load_dwordx4 v177, s[12:15], s47 offen offset:3024 lds
    s_add_u32 m0, s55, 64640
    s_mov_b32 s47, 30720
    buffer_load_dwordx4 v174, s[12:15], s47 offen offset:0 lds
    buffer_load_dwordx4 v175, s[12:15], s47 offen offset:1008 lds
    buffer_load_dwordx4 v176, s[12:15], s47 offen offset:2016 lds
    buffer_load_dwordx4 v177, s[12:15], s47 offen offset:3024 lds
    s_add_u32 m0, s55, 68672
    s_mov_b32 s47, 46080
    buffer_load_dwordx4 v174, s[12:15], s47 offen offset:0 lds
    buffer_load_dwordx4 v178, s[12:15], s47 offen offset:1008 lds
    s_add_u32 m0, s55, 0
    s_mov_b32 s47, 51200
    s_nop 0
    buffer_load_dwordx4 v174, s[12:15], s47 offen offset:0 lds
    buffer_load_dwordx4 v175, s[12:15], s47 offen offset:1008 lds
    buffer_load_dwordx4 v176, s[12:15], s47 offen offset:2016 lds
    buffer_load_dwordx4 v177, s[12:15], s47 offen offset:3024 lds
    s_add_u32 m0, s55, 4032
    s_mov_b32 s47, 66560
    buffer_load_dwordx4 v174, s[12:15], s47 offen offset:0 lds
    buffer_load_dwordx4 v175, s[12:15], s47 offen offset:1008 lds
    buffer_load_dwordx4 v176, s[12:15], s47 offen offset:2016 lds
    buffer_load_dwordx4 v177, s[12:15], s47 offen offset:3024 lds
    s_add_u32 m0, s55, 8064
    s_mov_b32 s47, 81920
    buffer_load_dwordx4 v174, s[12:15], s47 offen offset:0 lds
    buffer_load_dwordx4 v175, s[12:15], s47 offen offset:1008 lds
    buffer_load_dwordx4 v176, s[12:15], s47 offen offset:2016 lds
    buffer_load_dwordx4 v177, s[12:15], s47 offen offset:3024 lds
    s_add_u32 m0, s55, 12096
    s_mov_b32 s47, 97280
    buffer_load_dwordx4 v174, s[12:15], s47 offen offset:0 lds
    buffer_load_dwordx4 v178, s[12:15], s47 offen offset:1008 lds
    s_waitcnt vmcnt(28)
    v_cmp_gt_u32 vcc, 1, v195
    s_nop 0
    s_cbranch_vccz L_ok_22
    s_mov_b32 s43, 0
L_spin_23:
    s_sleep 4
    global_load_dword v195, v196, s[36:37] offset:128 sc1
    s_add_u32 s43, s43, 1
    s_cmp_ge_u32 s43, 20000
    s_waitcnt vmcnt(0)
    s_cbranch_scc1 L_ok_22
    v_cmp_gt_u32 vcc, 1, v195
    s_nop 1
    s_cbranch_vccnz L_spin_23
L_ok_22:
    s_waitcnt vmcnt(14)
    ds_read_b64_tr_b16 a[0:1], v236 offset:56576
    ds_read_b64_tr_b16 a[2:3], v236 offset:57248
    ds_read_b64_tr_b16 a[4:5], v236 offset:56640
    s_nop 0
    ds_read_b64_tr_b16 a[6:7], v236 offset:57312
    ds_read_b64_tr_b16 a[8:9], v236 offset:56704
    ds_read_b64_tr_b16 a[10:11], v236 offset:57376
    ds_read_b64_tr_b16 a[12:13], v236 offset:56768
    ds_read_b64_tr_b16 a[14:15], v236 offset:57440
    ds_read_b64_tr_b16 a[16:17], v236 offset:56832
    ds_read_b64_tr_b16 a[18:19], v236 offset:57504
    ds_read_b64_tr_b16 a[20:21], v236 offset:63296
    ds_read_b64_tr_b16 a[22:23], v236 offset:63968
    ds_read_b64_tr_b16 a[24:25], v236 offset:63360
    ds_read_b64_tr_b16 a[26:27], v236 offset:64032
    ds_read_b64_tr_b16 a[28:29], v236 offset:63424
    ds_read_b64_tr_b16 a[30:31], v236 offset:64096
    ds_read_b64_tr_b16 a[32:33], v236 offset:63488
    ds_read_b64_tr_b16 a[34:35], v236 offset:64160
    ds_read_b64_tr_b16 a[36:37], v236 offset:63552
    ds_read_b64_tr_b16 a[38:39], v236 offset:64224
    ds_read_b64_tr_b16 a[160:161], v237 offset:56576
    ds_read_b64_tr_b16 a[164:165], v237 offset:56640
    ds_read_b64_tr_b16 a[168:169], v237 offset:56704
    ds_read_b64_tr_b16 a[172:173], v237 offset:56768
    ds_read_b64_tr_b16 a[176:177], v237 offset:56832
    s_waitcnt lgkmcnt(0)
    s_add_u32 m0, s55, 56576
    s_nop 0
    s_mov_b32 s47, 102400
    buffer_load_dwordx4 v174, s[12:15], s47 offen offset:0 lds
    buffer_load_dwordx4 v175, s[12:15], s47 offen offset:1008 lds
    buffer_load_dwordx4 v176, s[12:15], s47 offen offset:2016 lds
    buffer_load_dwordx4 v177, s[12:15], s47 offen offset:3024 lds
    s_add_u32 m0, s55, 60608
    s_mov_b32 s47, 117760
    buffer_load_dwordx4 v174, s[12:15], s47 offen offset:0 lds
    buffer_load_dwordx4 v175, s[12:15], s47 offen offset:1008 lds
    buffer_load_dwordx4 v176, s[12:15], s47 offen offset:2016 lds
    buffer_load_dwordx4 v177, s[12:15], s47 offen offset:3024 lds
    s_add_u32 m0, s55, 64640
    s_mov_b32 s47, 133120
    buffer_load_dwordx4 v174, s[12:15], s47 offen offset:0 lds
    buffer_load_dwordx4 v175, s[12:15], s47 offen offset:1008 lds
    buffer_load_dwordx4 v176, s[12:15], s47 offen offset:2016 lds
    buffer_load_dwordx4 v177, s[12:15], s47 offen offset:3024 lds
    s_add_u32 m0, s55, 68672
    s_mov_b32 s47, 148480
    buffer_load_dwordx4 v174, s[12:15], s47 offen offset:0 lds
    buffer_load_dwordx4 v178, s[12:15], s47 offen offset:1008 lds
    s_waitcnt vmcnt(14)
    ds_read_b64_tr_b16 a[40:41], v236 offset:0
    ds_read_b64_tr_b16 a[42:43], v236 offset:672
    s_nop 0
    ds_read_b64_tr_b16 a[44:45], v236 offset:64
    ds_read_b64_tr_b16 a[46:47], v236 offset:736
    ds_read_b64_tr_b16 a[48:49], v236 offset:128
    ds_read_b64_tr_b16 a[50:51], v236 offset:800
    ds_read_b64_tr_b16 a[52:53], v236 offset:192
    ds_read_b64_tr_b16 a[54:55], v236 offset:864
    ds_read_b64_tr_b16 a[56:57], v236 offset:256
    ds_read_b64_tr_b16 a[58:59], v236 offset:928
    ds_read_b64_tr_b16 a[60:61], v236 offset:6720
    ds_read_b64_tr_b16 a[62:63], v236 offset:7392
    ds_read_b64_tr_b16 a[64:65], v236 offset:6784
    ds_read_b64_tr_b16 a[66:67], v236 offset:7456
    ds_read_b64_tr_b16 a[68:69], v236 offset:6848
    ds_read_b64_tr_b16 a[70:71], v236 offset:7520
    ds_read_b64_tr_b16 a[72:73], v236 offset:6912
    ds_read_b64_tr_b16 a[74:75], v236 offset:7584
    ds_read_b64_tr_b16 a[76:77], v236 offset:6976
    ds_read_b64_tr_b16 a[78:79], v236 offset:7648
    ds_read_b64_tr_b16 a[162:163], v237 offset:0
    ds_read_b64_tr_b16 a[166:167], v237 offset:64
    ds_read_b64_tr_b16 a[170:171], v237 offset:128
    ds_read_b64_tr_b16 a[174:175], v237 offset:192
    ds_read_b64_tr_b16 a[178:179], v237 offset:256
    s_waitcnt lgkmcnt(0)
    buffer_load_dword v242, v243, s[28:31], s44 offen sc1
    s_add_u32 m0, s55, 0
    s_mov_b32 s47, 153600
    buffer_load_dwordx4 v174, s[12:15], s47 offen offset:0 lds
    buffer_load_dwordx4 v175, s[12:15], s47 offen offset:1008 lds
    buffer_load_dwordx4 v176, s[12:15], s47 offen offset:2016 lds
    buffer_load_dwordx4 v177, s[12:15], s47 offen offset:3024 lds
    s_add_u32 m0, s55, 4032
    s_mov_b32 s47, 168960
    buffer_load_dwordx4 v174, s[12:15], s47 offen offset:0 lds
    buffer_load_dwordx4 v175, s[12:15], s47 offen offset:1008 lds
    buffer_load_dwordx4 v176, s[12:15], s47 offen offset:2016 lds
    buffer_load_dwordx4 v177, s[12:15], s47 offen offset:3024 lds
    s_add_u32 m0, s55, 8064
    s_mov_b32 s47, 184320
    buffer_load_dwordx4 v174, s[12:15], s47 offen offset:0 lds
    buffer_load_dwordx4 v175, s[12:15], s47 offen offset:1008 lds
    buffer_load_dwordx4 v176, s[12:15], s47 offen offset:2016 lds
    buffer_load_dwordx4 v177, s[12:15], s47 offen offset:3024 lds
    s_add_u32 m0, s55, 12096
    s_mov_b32 s47, 199680
    buffer_load_dwordx4 v174, s[12:15], s47 offen offset:0 lds
    buffer_load_dwordx4 v178, s[12:15], s47 offen offset:1008 lds
    s_waitcnt vmcnt(15)
    ds_read_b64_tr_b16 a[80:81], v236 offset:56576
    s_nop 0
    ds_read_b64_tr_b16 a[82:83], v236 offset:57248
    ds_read_b64_tr_b16 a[84:85], v236 offset:56640
    ds_read_b64_tr_b16 a[86:87], v236 offset:57312
    ds_read_b64_tr_b16 a[88:89], v236 offset:56704
    ds_read_b64_tr_b16 a[90:91], v236 offset:57376
    ds_read_b64_tr_b16 a[92:93], v236 offset:56768
    ds_read_b64_tr_b16 a[94:95], v236 offset:57440
    ds_read_b64_tr_b16 a[96:97], v236 offset:56832
    ds_read_b64_tr_b16 a[98:99], v236 offset:57504
    ds_read_b64_tr_b16 a[100:101], v236 offset:63296
    ds_read_b64_tr_b16 a[102:103], v236 offset:63968
    ds_read_b64_tr_b16 a[104:105], v236 offset:63360
    ds_read_b64_tr_b16 a[106:107], v236 offset:64032
    ds_read_b64_tr_b16 a[108:109], v236 offset:63424
    ds_read_b64_tr_b16 a[110:111], v236 offset:64096
    ds_read_b64_tr_b16 a[112:113], v236 offset:63488
    ds_read_b64_tr_b16 a[114:115], v236 offset:64160
    ds_read_b64_tr_b16 a[116:117], v236 offset:63552
    ds_read_b64_tr_b16 a[118:119], v236 offset:64224
    ds_read_b64_tr_b16 a[180:181], v237 offset:56576
    ds_read_b64_tr_b16 a[184:185], v237 offset:56640
    ds_read_b64_tr_b16 a[188:189], v237 offset:56704
    ds_read_b64_tr_b16 a[192:193], v237 offset:56768
    ds_read_b64_tr_b16 a[196:197], v237 offset:56832
    s_waitcnt lgkmcnt(0)
    s_add_u32 m0, s55, 56576
    s_nop 0
    buffer_load_dwordx4 v112, s[4:7], s9 offen lds
    s_add_u32 m0, s55, 57600
    s_nop 0
    buffer_load_dwordx4 v112, s[4:7], s10 offen lds
    s_add_u32 m0, s55, 58624
    s_nop 0
    buffer_load_dwordx4 v112, s[4:7], s11 offen lds
    s_waitcnt vmcnt(17)
    v_cmp_gt_u32 vcc, 1, v242
    s_nop 0
    s_cbranch_vccz L_ok_24
    s_mov_b32 s43, 0
L_spin_25:
    s_sleep 4
    buffer_load_dword v242, v243, s[28:31], s44 offen sc1
    s_add_u32 s43, s43, 1
    s_cmp_ge_u32 s43, 20000
    s_waitcnt vmcnt(0)
    s_cbranch_scc1 L_ok_24
    v_cmp_gt_u32 vcc, 1, v242
    s_nop 1
    s_cbranch_vccnz L_spin_25
L_ok_24:
    s_add_u32 m0, s8, 0
    s_nop 0
    buffer_load_dwordx4 v7, s[28:31], s54 offen offset:0 sc1 lds
    buffer_load_dwordx4 v7, s[28:31], s54 offen offset:1024 sc1 lds
    buffer_load_dwordx4 v7, s[28:31], s54 offen offset:2048 sc1 lds
    buffer_load_dwordx4 v7, s[28:31], s54 offen offset:3072 sc1 lds
    s_add_u32 s54, s54, 4096
    s_add_u32 m0, s8, 4096
    s_nop 0
    s_nop 0
    buffer_load_dwordx4 v7, s[28:31], s54 offen offset:0 sc1 lds
    buffer_load_dwordx4 v7, s[28:31], s54 offen offset:1024 sc1 lds
    buffer_load_dwordx4 v7, s[28:31], s54 offen offset:2048 sc1 lds
    buffer_load_dwordx4 v7, s[28:31], s54 offen offset:3072 sc1 lds
    s_add_u32 s54, s54, 4096
    s_add_u32 m0, s8, 8192
    s_nop 0
    buffer_load_dwordx4 v7, s[28:31], s54 offen offset:0 sc1 lds
    buffer_load_dwordx4 v7, s[28:31], s54 offen offset:1024 sc1 lds
    s_lshl_b32 s44, s38, 12
    v_and_b32 v8, 31, v0
    v_lshlrev_b32_e64 v243, 7, v8
    s_lshl_b32 s46, s38, 14
    s_add_u32 s46, s46, 131072
    buffer_load_dword v242, v243, s[28:31], s44 offen sc1
    s_waitcnt vmcnt(0)
    s_branch L_phaseB
L_roleq2:
    s_mul_i32 s44, s54, 5
    v_add_u32 v8, s44, v1
    v_add_u32 v9, 15, v8
    v_add_u32 v8, 10, v8
    v_cmp_gt_u32 vcc, 5, v1
    s_lshl_b32 s44, s54, 2
    s_sub_u32 s44, s44, 10
    v_cndmask_b32 v8, v9, v8, vcc
    v_cmp_gt_u32 vcc, 10, v1
    v_add_u32 v9, s44, v1
    s_mul_i32 s3, s45, 15360
    v_cndmask_b32 v8, v9, v8, vcc
    v_mul_u32_u24 v9, 3840, v2
    v_lshl_add_u32 v8, v8, 7, v9
    s_add_u32 s3, s3, 1228800
    v_add_u32 v157, s3, v8
    v_add_u32 v197, 614400, v157
    s_mul_i32 s3, s45, 13
    s_lshr_b32 s44, s39, 1
    s_lshl_b32 s44, s44, 9
    s_add_u32 s3, s3, s44
    v_lshrrev_b32 v8, 2, v0
    v_min_u32 v8, 12, v8
    v_add_u32 v8, s3, v8
    v_mul_u32_u24 v8, 1280, v8
    v_lshl_add_u32 v194, v5, 7, v8
    s_and_b32 s54, s39, 1
    s_sub_u32 s53, s40, 16
    s_lshl_b32 s3, s54, 1
    s_add_u32 s3, s3, s53
    s_sub_u32 s3, s3, 8
    s_lshr_b32 s52, s53, 1
    s_cmp_lt_u32 s53, 8
    s_cselect_b32 s52, s52, s3
    s_lshr_b32 s3, s40, 2
    s_cmp_lt_u32 s40, 16
    s_cselect_b32 s52, s3, s52
    s_and_b32 s3, s39, 6
    s_lshl_b32 s3, s3, 1
    s_add_u32 s52, s52, s3
    s_lshl_b32 s3, s52, 2
    s_add_u32 s3, s3, s38
    s_lshl_b32 s3, s3, 5
    s_lshl_b32 s49, s38, 12
    v_lshrrev_b32 v8, 3, v0
    v_add_u32 v8, s3, v8
    v_mul_u32_u24 v8, 1280, v8
    v_and_b32 v9, 7, v0
    v_xor_b32 v9, v9, v2
    v_lshl_add_u32 v148, v9, 4, v8
    v_xor_b32 v8, 64, v148
    v_add_u32 v149, 9216, v8
    v_add_u32 v150, 18432, v148
    v_add_u32 v151, 27648, v8
    s_mul_i32 s51, s54, 3
    s_and_b32 s3, s53, 1
    s_add_u32 s51, s51, s3
    s_cmp_lt_u32 s53, 8
    s_cselect_b32 s51, s51, 2
    s_lshl_b32 s45, s51, 8
    s_lshl_b32 s50, s38, 12
    s_add_u32 s50, s50, 16384
    s_mul_i32 s3, s38, 61440
    s_add_u32 s3, s3, s45
    v_lshlrev_b32 v8, 1, v2
    v_xor_b32 v8, v8, v1
    v_mul_u32_u24 v9, 3840, v2
    v_lshl_add_u32 v8, v8, 4, v9
    v_add_u32 v152, s3, v8
    v_add_u32 v153, 14336, v152
    v_xor_b32 v8, 128, v8
    v_add_u32 v8, s3, v8
    v_add_u32 v154, 28672, v8
    v_add_u32 v155, 43008, v8
    s_load_dwordx2 s[28:29], s[0:1], 80
    s_load_dwordx2 s[12:13], s[0:1], 16
    s_load_dwordx2 s[16:17], s[0:1], 32
    s_load_dwordx2 s[32:33], s[0:1], 40
    s_load_dwordx2 s[20:21], s[0:1], 48
    s_load_dwordx2 s[34:35], s[0:1], 56
    s_load_dwordx2 s[24:25], s[0:1], 64
    s_lshr_b32 s41, s38, 1
    s_and_b32 s42, s38, 1
    s_mov_b32 s14, 819200
    s_mov_b32 s15, 0x20000
    s_mov_b32 s18, 6291456
    s_mov_b32 s19, 0x20000
    s_mov_b32 s22, 6291456
    s_mov_b32 s23, 0x20000
    s_mov_b32 s26, 2621440
    s_mov_b32 s27, 0x20000
    s_mov_b32 s30, 16777216
    s_mov_b32 s31, 0x20000
    s_load_dwordx2 s[36:37], s[0:1], 72
    v_lshrrev_b32 v3, 5, v0
    v_bfe_u32 v4, v0, 2, 2
    v_and_b32 v6, 1, v2
    v_lshlrev_b32_e64 v7, 4, v0
    s_mov_b32 s56, 0xaaaaaaaa
    s_mov_b32 s57, 0xaaaaaaaa
    s_mov_b32 s58, 0xcccccccc
    s_mov_b32 s59, 0xcccccccc
    s_cmp_eq_u32 s38, 0
    s_cselect_b64 vcc, 1, 0
    v_mov_b32 v253, 1073741824
    v_cndmask_b32 v252, v253, 0, vcc
    v_mov_b32 v253, 1
    v_lshrrev_b32 v8, 1, v1
    v_xor_b32 v8, v8, v2
    v_lshlrev_b32_e64 v8, 4, v8
    v_lshl_add_u32 v8, v1, 7, v8
    s_lshl_b32 s3, s41, 13
    v_add_u32 v158, s3, v8
    v_xor_b32 v159, 64, v158
    v_lshl_add_u32 v8, v2, 3, v4
    v_lshlrev_b32 v8, 8, v8
    v_lshl_add_u32 v8, v5, 3, v8
    v_lshl_add_u32 v9, v6, 2, v4
    s_lshl_b32 s3, s42, 2
    v_xor_b32 v9, s3, v9
    v_lshl_add_u32 v8, v9, 5, v8
    v_add_u32 v162, 16384, v8
    v_xor_b32 v163, 32, v162
    v_xor_b32 v164, 64, v162
    v_xor_b32 v165, 96, v162
    v_add_u32 v160, 73728, v158
    v_add_u32 v161, 73728, v159
    v_add_u32 v167, 73728, v162
    v_add_u32 v168, 73728, v163
    v_add_u32 v169, 73728, v164
    v_add_u32 v170, 73728, v165
    s_mov_b64 exec, 0
    s_cmp_lg_u32 s38, 0
    s_cbranch_scc1 L_wn_27
    s_call_b64 s[62:63], L_pg5
    s_call_b64 s[62:63], L_pg9
    s_call_b64 s[62:63], L_pg13
    s_branch L_wd_26
L_wn_27:
    s_cmp_lg_u32 s38, 1
    s_cbranch_scc1 L_wn_28
    s_call_b64 s[62:63], L_pg6
    s_call_b64 s[62:63], L_pg10
    s_call_b64 s[62:63], L_pg14
    s_branch L_wd_26
L_wn_28:
    s_cmp_lg_u32 s38, 2
    s_cbranch_scc1 L_wn_29
    s_call_b64 s[62:63], L_pg7
    s_call_b64 s[62:63], L_pg11
    s_nop 0
    s_branch L_wd_26
L_wn_29:
    s_call_b64 s[62:63], L_pg8
    s_call_b64 s[62:63], L_pg12
    s_nop 0
L_wd_26:
    s_mov_b64 exec, -1
    v_mov_b32 v196, 0
    s_mov_b32 s62, 0x3fb8aa3b
    s_mov_b32 s63, 0x3fb8aa3b
    v_mov_b32 v138, 0x358637bd
    v_mov_b32 v139, 0x358637bd
    v_mov_b32 v140, 0xb5c1a2a0
    v_mov_b32 v141, 0xb5c1a2a0
    s_lshl_b32 s3, s52, 1
    s_add_u32 s3, s3, s41
    s_lshl_b32 s3, s3, 9
    s_add_u32 s3, s3, 524288
    v_lshl_add_u32 v186, v0, 3, s3
    s_lshl_b32 s3, s38, 9
    s_add_u32 s3, s3, 36864
    v_lshl_add_u32 v172, v0, 3, s3
    v_lshl_add_u32 v173, v2, 4, s3
    s_mul_i32 s46, s52, 5
    s_add_u32 s46, s46, s51
    s_lshl_b32 s46, s46, 7
    s_add_u32 s46, s46, 16384
    s_lshl_b32 s44, s51, 1
    s_add_u32 s44, s44, s42
    s_lshl_b32 s3, s44, 8
    s_add_u32 s3, s3, 540672
    v_lshl_add_u32 v187, v1, 2, s3
    s_lshl_b32 s3, s44, 2
    s_add_u32 s3, s3, 0
    s_mul_i32 s45, s3, 6554
    s_lshr_b32 s45, s45, 16
    s_mul_i32 s45, s45, 7680
    s_lshl_b32 s3, s3, 8
    s_add_u32 s64, s3, s45
    s_lshl_b32 s3, s44, 2
    s_add_u32 s3, s3, 1
    s_mul_i32 s45, s3, 6554
    s_lshr_b32 s45, s45, 16
    s_mul_i32 s45, s45, 7680
    s_lshl_b32 s3, s3, 8
    s_add_u32 s65, s3, s45
    s_lshl_b32 s3, s44, 2
    s_add_u32 m0, s49, 0
    s_mov_b32 s47, 0
    buffer_load_dwordx4 v148, s[4:7], s47 offen offset:0 lds
    buffer_load_dwordx4 v149, s[4:7], s47 offen offset:1024 lds
    buffer_load_dwordx4 v150, s[4:7], s47 offen offset:2048 lds
    buffer_load_dwordx4 v151, s[4:7], s47 offen offset:3072 lds
    s_add_u32 m0, s50, 0
    s_mov_b32 s48, 0
    s_nop 0
    buffer_load_dwordx4 v152, s[8:11], s48 offen offset:0 lds
    buffer_load_dwordx4 v153, s[8:11], s48 offen offset:1024 lds
    buffer_load_dwordx4 v154, s[8:11], s48 offen offset:2048 lds
    buffer_load_dwordx4 v155, s[8:11], s48 offen offset:3072 lds
    s_add_u32 m0, s49, 73728
    s_mov_b32 s47, 128
    buffer_load_dwordx4 v148, s[4:7], s47 offen offset:0 lds
    buffer_load_dwordx4 v149, s[4:7], s47 offen offset:1024 lds
    buffer_load_dwordx4 v150, s[4:7], s47 offen offset:2048 lds
    buffer_load_dwordx4 v151, s[4:7], s47 offen offset:3072 lds
    s_add_u32 m0, s50, 73728
    s_mov_b32 s48, 245760
    buffer_load_dwordx4 v152, s[8:11], s48 offen offset:0 lds
    buffer_load_dwordx4 v153, s[8:11], s48 offen offset:1024 lds
    buffer_load_dwordx4 v154, s[8:11], s48 offen offset:2048 lds
    buffer_load_dwordx4 v155, s[8:11], s48 offen offset:3072 lds
    s_waitcnt lgkmcnt(0)
    s_waitcnt vmcnt(8)
    s_barrier
    ds_read_b64_tr_b16 a[200:201], v162 offset:0
    ds_read_b64_tr_b16 a[202:203], v162 offset:1024
    s_nop 0
    ds_read_b128 a[184:187], v158 offset:0
    ds_read_b64_tr_b16 a[204:205], v163 offset:0
    ds_read_b64_tr_b16 a[206:207], v163 offset:1024
    ds_read_b128 a[188:191], v158 offset:2048
    ds_read_b64_tr_b16 a[208:209], v164 offset:0
    ds_read_b64_tr_b16 a[210:211], v164 offset:1024
    ds_read_b128 a[192:195], v158 offset:4096
    ds_read_b64_tr_b16 a[212:213], v165 offset:0
    ds_read_b64_tr_b16 a[214:215], v165 offset:1024
    ds_read_b128 a[196:199], v158 offset:6144
    s_waitcnt lgkmcnt(9)
    v_mfma_f32_16x16x32_bf16 v[16:19], a[184:187], a[200:203], 0
    s_nop 0
    ds_read_b64_tr_b16 a[236:237], v162 offset:8192
    ds_read_b64_tr_b16 a[238:239], v162 offset:9216
    s_add_u32 m0, s49, 36864
    s_mov_b32 s47, 256
    buffer_load_dwordx4 v148, s[4:7], s47 offen offset:0 lds
    s_waitcnt lgkmcnt(9)
    v_mfma_f32_16x16x32_bf16 v[20:23], a[184:187], a[204:207], 0
    ds_read_b128 a[220:223], v159 offset:0
    s_waitcnt lgkmcnt(9)
    v_mfma_f32_16x16x32_bf16 v[36:39], a[188:191], a[204:207], 0
    ds_read_b64_tr_b16 a[240:241], v163 offset:8192
    buffer_load_dwordx4 v149, s[4:7], s47 offen offset:1024 lds
    v_mfma_f32_16x16x32_bf16 v[32:35], a[188:191], a[200:203], 0
    ds_read_b64_tr_b16 a[242:243], v163 offset:9216
    s_waitcnt lgkmcnt(8)
    v_mfma_f32_16x16x32_bf16 v[48:51], a[192:195], a[200:203], 0
    ds_read_b128 a[224:227], v159 offset:2048
    s_nop 0
    buffer_load_dwordx4 v150, s[4:7], s47 offen offset:2048 lds
    v_mfma_f32_16x16x32_bf16 v[52:55], a[192:195], a[204:207], 0
    ds_read_b64_tr_b16 a[244:245], v164 offset:8192
    ds_read_b64_tr_b16 a[246:247], v164 offset:9216
    v_mfma_f32_16x16x32_bf16 v[56:59], a[192:195], a[208:211], 0
    ds_read_b128 a[228:231], v159 offset:4096
    buffer_load_dwordx4 v151, s[4:7], s47 offen offset:3072 lds
    v_mfma_f32_16x16x32_bf16 v[40:43], a[188:191], a[208:211], 0
    ds_read_b64_tr_b16 a[248:249], v165 offset:8192
    v_mfma_f32_16x16x32_bf16 v[24:27], a[184:187], a[208:211], 0
    ds_read_b64_tr_b16 a[250:251], v165 offset:9216
    s_add_u32 m0, s50, 36864
    s_mov_b32 s48, 491520
    buffer_load_dwordx4 v152, s[8:11], s48 offen offset:0 lds
    s_waitcnt lgkmcnt(12)
    v_mfma_f32_16x16x32_bf16 v[28:31], a[184:187], a[212:215], 0
    ds_read_b128 a[232:235], v159 offset:6144
    v_mfma_f32_16x16x32_bf16 v[44:47], a[188:191], a[212:215], 0
    buffer_load_dwordx4 v153, s[8:11], s48 offen offset:1024 lds
    v_mfma_f32_16x16x32_bf16 v[60:63], a[192:195], a[212:215], 0
    s_waitcnt lgkmcnt(12)
    v_mfma_f32_16x16x32_bf16 v[76:79], a[196:199], a[212:215], 0
    buffer_load_dwordx4 v154, s[8:11], s48 offen offset:2048 lds
    v_mfma_f32_16x16x32_bf16 v[72:75], a[196:199], a[208:211], 0
    v_mfma_f32_16x16x32_bf16 v[68:71], a[196:199], a[204:207], 0
L_pg5:
    s_cbranch_execz L_ret
    buffer_load_dwordx4 v155, s[8:11], s48 offen offset:3072 lds
    v_mfma_f32_16x16x32_bf16 v[64:67], a[196:199], a[200:203], 0
    s_waitcnt vmcnt(8) lgkmcnt(0)
    s_barrier
    v_mfma_f32_16x16x32_bf16 v[16:19], a[220:223], a[236:239], v[16:19]
    ds_read_b64_tr_b16 a[200:201], v167 offset:0
    s_add_u32 m0, s49, 0
    s_mov_b32 s47, 384
    buffer_load_dwordx4 v148, s[4:7], s47 offen offset:0 lds
    s_add_u32 s3, s3, 2
    v_mfma_f32_16x16x32_bf16 v[20:23], a[220:223], a[240:243], v[20:23]
    ds_read_b64_tr_b16 a[202:203], v167 offset:1024
    s_mul_i32 s45, s3, 6554
    s_nop 0
    v_mfma_f32_16x16x32_bf16 v[36:39], a[224:227], a[240:243], v[36:39]
    ds_read_b128 a[184:187], v160 offset:0
    v_mfma_f32_16x16x32_bf16 v[32:35], a[224:227], a[236:239], v[32:35]
    ds_read_b64_tr_b16 a[204:205], v168 offset:0
    buffer_load_dwordx4 v149, s[4:7], s47 offen offset:1024 lds
    s_lshr_b32 s45, s45, 16
    v_mfma_f32_16x16x32_bf16 v[48:51], a[228:231], a[236:239], v[48:51]
    ds_read_b64_tr_b16 a[206:207], v168 offset:1024
    s_nop 0
    v_mfma_f32_16x16x32_bf16 v[52:55], a[228:231], a[240:243], v[52:55]
    ds_read_b128 a[188:191], v160 offset:2048
    s_mul_i32 s45, s45, 7680
    v_mfma_f32_16x16x32_bf16 v[56:59], a[228:231], a[244:247], v[56:59]
    ds_read_b64_tr_b16 a[208:209], v169 offset:0
    buffer_load_dwordx4 v150, s[4:7], s47 offen offset:2048 lds
    v_mfma_f32_16x16x32_bf16 v[40:43], a[224:227], a[244:247], v[40:43]
    ds_read_b64_tr_b16 a[210:211], v169 offset:1024
    s_lshl_b32 s3, s3, 8
    v_mfma_f32_16x16x32_bf16 v[24:27], a[220:223], a[244:247], v[24:27]
    ds_read_b128 a[192:195], v160 offset:4096
    s_add_u32 s66, s3, s45
    v_mfma_f32_16x16x32_bf16 v[28:31], a[220:223], a[248:251], v[28:31]
    ds_read_b64_tr_b16 a[212:213], v170 offset:0
    buffer_load_dwordx4 v151, s[4:7], s47 offen offset:3072 lds
    v_mfma_f32_16x16x32_bf16 v[44:47], a[224:227], a[248:251], v[44:47]
    ds_read_b64_tr_b16 a[214:215], v170 offset:1024
    s_lshl_b32 s3, s44, 2
    v_mfma_f32_16x16x32_bf16 v[60:63], a[228:231], a[248:251], v[60:63]
    ds_read_b128 a[196:199], v160 offset:6144
    v_mfma_f32_16x16x32_bf16 v[76:79], a[232:235], a[248:251], v[76:79]
    buffer_load_dword v255, v157, s[8:11], 0 offen
    s_add_u32 s3, s3, 3
    v_mfma_f32_16x16x32_bf16 v[72:75], a[232:235], a[244:247], v[72:75]
    v_mfma_f32_16x16x32_bf16 v[68:71], a[232:235], a[240:243], v[68:71]
    s_mul_i32 s45, s3, 6554
    v_mfma_f32_16x16x32_bf16 v[64:67], a[232:235], a[236:239], v[64:67]
    s_waitcnt lgkmcnt(9)
    v_mfma_f32_16x16x32_bf16 v[16:19], a[184:187], a[200:203], v[16:19]
    ds_read_b64_tr_b16 a[236:237], v167 offset:8192
    s_lshr_b32 s45, s45, 16
    s_waitcnt lgkmcnt(8)
    v_mfma_f32_16x16x32_bf16 v[20:23], a[184:187], a[204:207], v[20:23]
    ds_read_b64_tr_b16 a[238:239], v167 offset:9216
    s_mul_i32 s45, s45, 7680
    s_waitcnt lgkmcnt(8)
    v_mfma_f32_16x16x32_bf16 v[36:39], a[188:191], a[204:207], v[36:39]
    ds_read_b128 a[220:223], v161 offset:0
    s_lshl_b32 s3, s3, 8
    v_mfma_f32_16x16x32_bf16 v[32:35], a[188:191], a[200:203], v[32:35]
    ds_read_b64_tr_b16 a[240:241], v168 offset:8192
    s_add_u32 m0, s50, 0
    s_mov_b32 s48, 737280
    s_waitcnt lgkmcnt(7)
    v_mfma_f32_16x16x32_bf16 v[48:51], a[192:195], a[200:203], v[48:51]
    buffer_load_dwordx4 v152, s[8:11], s48 offen offset:0 lds
    v_mfma_f32_16x16x32_bf16 v[52:55], a[192:195], a[204:207], v[52:55]
    ds_read_b64_tr_b16 a[242:243], v168 offset:9216
    s_add_u32 s67, s3, s45
    v_mfma_f32_16x16x32_bf16 v[56:59], a[192:195], a[208:211], v[56:59]
    ds_read_b128 a[224:227], v161 offset:2048
    s_lshl_b32 s3, s52, 1
    v_mfma_f32_16x16x32_bf16 v[40:43], a[188:191], a[208:211], v[40:43]
    ds_read_b64_tr_b16 a[244:245], v169 offset:8192
    s_add_u32 s3, s3, s41
    v_mfma_f32_16x16x32_bf16 v[24:27], a[184:187], a[208:211], v[24:27]
    ds_read_b64_tr_b16 a[246:247], v169 offset:9216
    s_waitcnt lgkmcnt(9)
    v_mfma_f32_16x16x32_bf16 v[28:31], a[184:187], a[212:215], v[28:31]
    s_nop 0
    buffer_load_dwordx4 v153, s[8:11], s48 offen offset:1024 lds
    v_mfma_f32_16x16x32_bf16 v[44:47], a[188:191], a[212:215], v[44:47]
    ds_read_b128 a[228:231], v161 offset:4096
    s_mul_i32 s3, s3, 81920
    v_mfma_f32_16x16x32_bf16 v[60:63], a[192:195], a[212:215], v[60:63]
    ds_read_b64_tr_b16 a[248:249], v170 offset:8192
    s_add_u32 s3, s3, 1048576
    s_waitcnt lgkmcnt(10)
    s_nop 0
    v_mfma_f32_16x16x32_bf16 v[76:79], a[196:199], a[212:215], v[76:79]
    ds_read_b64_tr_b16 a[250:251], v170 offset:9216
    v_mul_u32_u24 v8, 2560, v2
    v_mfma_f32_16x16x32_bf16 v[72:75], a[196:199], a[208:211], v[72:75]
    ds_read_b128 a[232:235], v161 offset:6144
    v_mfma_f32_16x16x32_bf16 v[68:71], a[196:199], a[204:207], v[68:71]
    buffer_load_dwordx4 v154, s[8:11], s48 offen offset:2048 lds
    v_mfma_f32_16x16x32_bf16 v[64:67], a[196:199], a[200:203], v[64:67]
    buffer_load_dwordx4 v155, s[8:11], s48 offen offset:3072 lds
    s_waitcnt vmcnt(9) lgkmcnt(0)
    s_barrier
    v_mfma_f32_16x16x32_bf16 v[16:19], a[220:223], a[236:239], v[16:19]
    ds_read_b64_tr_b16 a[200:201], v162 offset:36864
    s_add_u32 m0, s49, 73728
    s_mov_b32 s47, 512
    buffer_load_dwordx4 v148, s[4:7], s47 offen offset:0 lds
    v_lshl_add_u32 v8, v1, 4, v8
    v_mfma_f32_16x16x32_bf16 v[20:23], a[220:223], a[240:243], v[20:23]
    ds_read_b64_tr_b16 a[202:203], v162 offset:37888
    v_add_u32_e64 v180, s3, v8
    v_mfma_f32_16x16x32_bf16 v[36:39], a[224:227], a[240:243], v[36:39]
    ds_read_b128 a[184:187], v158 offset:36864
    v_mfma_f32_16x16x32_bf16 v[32:35], a[224:227], a[236:239], v[32:35]
    ds_read_b64_tr_b16 a[204:205], v163 offset:36864
    buffer_load_dwordx4 v149, s[4:7], s47 offen offset:1024 lds
    v_add_u32 v181, 40960, v180
    v_mfma_f32_16x16x32_bf16 v[48:51], a[228:231], a[236:239], v[48:51]
    ds_read_b64_tr_b16 a[206:207], v163 offset:37888
    v_mfma_f32_16x16x32_bf16 v[52:55], a[228:231], a[240:243], v[52:55]
    ds_read_b128 a[188:191], v158 offset:38912
    s_lshl_b32 s68, s39, 3
    v_mfma_f32_16x16x32_bf16 v[56:59], a[228:231], a[244:247], v[56:59]
    ds_read_b64_tr_b16 a[208:209], v164 offset:36864
    buffer_load_dwordx4 v150, s[4:7], s47 offen offset:2048 lds
    v_mfma_f32_16x16x32_bf16 v[40:43], a[224:227], a[244:247], v[40:43]
    ds_read_b64_tr_b16 a[210:211], v164 offset:37888
    s_lshr_b32 s3, s40, 2
    v_mfma_f32_16x16x32_bf16 v[24:27], a[220:223], a[244:247], v[24:27]
    ds_read_b128 a[192:195], v158 offset:40960
    s_add_u32 s68, s68, s3
    v_mfma_f32_16x16x32_bf16 v[28:31], a[220:223], a[248:251], v[28:31]
    ds_read_b64_tr_b16 a[212:213], v165 offset:36864
    buffer_load_dwordx4 v151, s[4:7], s47 offen offset:3072 lds
    v_mfma_f32_16x16x32_bf16 v[44:47], a[224:227], a[248:251], v[44:47]
    ds_read_b64_tr_b16 a[214:215], v165 offset:37888
    s_and_b32 s69, s40, 3
    v_mfma_f32_16x16x32_bf16 v[60:63], a[228:231], a[248:251], v[60:63]
    ds_read_b128 a[196:199], v158 offset:43008
    v_mfma_f32_16x16x32_bf16 v[76:79], a[232:235], a[248:251], v[76:79]
    buffer_load_dword v255, v197, s[8:11], 0 offen
    v_mul_u32_u24_e64 v8, 49, v0
    v_mfma_f32_16x16x32_bf16 v[72:75], a[232:235], a[244:247], v[72:75]
    v_mfma_f32_16x16x32_bf16 v[68:71], a[232:235], a[240:243], v[68:71]
    v_lshrrev_b32 v8, 10, v8
    v_mfma_f32_16x16x32_bf16 v[64:67], a[232:235], a[236:239], v[64:67]
    s_waitcnt lgkmcnt(9)
    v_mfma_f32_16x16x32_bf16 v[16:19], a[184:187], a[200:203], v[16:19]
    ds_read_b64_tr_b16 a[236:237], v162 offset:45056
    v_mul_u32_u24 v9, 21, v8
    s_waitcnt lgkmcnt(8)
    v_mfma_f32_16x16x32_bf16 v[20:23], a[184:187], a[204:207], v[20:23]
    ds_read_b64_tr_b16 a[238:239], v162 offset:46080
    v_sub_u32 v9, v0, v9
    s_waitcnt lgkmcnt(8)
    v_mfma_f32_16x16x32_bf16 v[36:39], a[188:191], a[204:207], v[36:39]
    ds_read_b128 a[220:223], v159 offset:36864
    v_min_u32_e64 v9, 19, v9
    v_mfma_f32_16x16x32_bf16 v[32:35], a[188:191], a[200:203], v[32:35]
    ds_read_b64_tr_b16 a[240:241], v163 offset:45056
    s_add_u32 m0, s50, 73728
    s_mov_b32 s48, 983040
    s_waitcnt lgkmcnt(7)
    v_mfma_f32_16x16x32_bf16 v[48:51], a[192:195], a[200:203], v[48:51]
    buffer_load_dwordx4 v152, s[8:11], s48 offen offset:0 lds
    v_mfma_f32_16x16x32_bf16 v[52:55], a[192:195], a[204:207], v[52:55]
    ds_read_b64_tr_b16 a[242:243], v163 offset:46080
    v_lshrrev_b32 v10, 2, v9
    v_mfma_f32_16x16x32_bf16 v[56:59], a[192:195], a[208:211], v[56:59]
    ds_read_b128 a[224:227], v159 offset:38912
    v_and_b32 v9, 3, v9
    v_mfma_f32_16x16x32_bf16 v[40:43], a[188:191], a[208:211], v[40:43]
    ds_read_b64_tr_b16 a[244:245], v164 offset:45056
    v_sub_u32 v11, 4, v10
    v_mfma_f32_16x16x32_bf16 v[24:27], a[184:187], a[208:211], v[24:27]
    ds_read_b64_tr_b16 a[246:247], v164 offset:46080
    s_waitcnt lgkmcnt(9)
    v_mfma_f32_16x16x32_bf16 v[28:31], a[184:187], a[212:215], v[28:31]
    buffer_load_dwordx4 v153, s[8:11], s48 offen offset:1024 lds
    s_nop 0
    v_mfma_f32_16x16x32_bf16 v[44:47], a[188:191], a[212:215], v[44:47]
    ds_read_b128 a[228:231], v159 offset:40960
    v_cmp_eq_u32 vcc, 1, s42
    v_mfma_f32_16x16x32_bf16 v[60:63], a[192:195], a[212:215], v[60:63]
    ds_read_b64_tr_b16 a[248:249], v165 offset:45056
    v_lshlrev_b32 v9, 4, v9
    s_waitcnt lgkmcnt(10)
    v_mfma_f32_16x16x32_bf16 v[76:79], a[196:199], a[212:215], v[76:79]
    ds_read_b64_tr_b16 a[250:251], v165 offset:46080
    v_mul_u32_u24 v8, 1280, v8
    v_mfma_f32_16x16x32_bf16 v[72:75], a[196:199], a[208:211], v[72:75]
    ds_read_b128 a[232:235], v159 offset:43008
    v_mfma_f32_16x16x32_bf16 v[68:71], a[196:199], a[204:207], v[68:71]
    buffer_load_dwordx4 v154, s[8:11], s48 offen offset:2048 lds
    v_mfma_f32_16x16x32_bf16 v[64:67], a[196:199], a[200:203], v[64:67]
    buffer_load_dwordx4 v155, s[8:11], s48 offen offset:3072 lds
    s_waitcnt vmcnt(9) lgkmcnt(0)
    s_barrier
    v_mfma_f32_16x16x32_bf16 v[16:19], a[220:223], a[236:239], v[16:19]
    ds_read_b64_tr_b16 a[200:201], v162 offset:0
    v_cndmask_b32 v10, v10, v11, vcc
    v_mfma_f32_16x16x32_bf16 v[20:23], a[220:223], a[240:243], v[20:23]
    s_nop 0
    ds_read_b64_tr_b16 a[202:203], v162 offset:1024
    v_lshl_add_u32 v9, v10, 6, v9
    v_mfma_f32_16x16x32_bf16 v[36:39], a[224:227], a[240:243], v[36:39]
    ds_read_b128 a[184:187], v158 offset:0
    s_add_u32 m0, s49, 36864
    s_mov_b32 s47, 640
    s_mul_i32 s3, s38, 204800
    v_mfma_f32_16x16x32_bf16 v[32:35], a[224:227], a[236:239], v[32:35]
    buffer_load_dwordx4 v148, s[4:7], s47 offen offset:0 lds
    v_mfma_f32_16x16x32_bf16 v[48:51], a[228:231], a[236:239], v[48:51]
    ds_read_b64_tr_b16 a[204:205], v163 offset:0
    v_mfma_f32_16x16x32_bf16 v[52:55], a[228:231], a[240:243], v[52:55]
    ds_read_b64_tr_b16 a[206:207], v163 offset:1024
    s_mul_i32 s55, s69, 320
    v_mfma_f32_16x16x32_bf16 v[56:59], a[228:231], a[244:247], v[56:59]
    buffer_load_dwordx4 v149, s[4:7], s47 offen offset:1024 lds
    v_mfma_f32_16x16x32_bf16 v[40:43], a[224:227], a[244:247], v[40:43]
    ds_read_b128 a[188:191], v158 offset:2048
    s_add_u32 s3, s3, s55
    v_mfma_f32_16x16x32_bf16 v[24:27], a[220:223], a[244:247], v[24:27]
    s_nop 0
    ds_read_b64_tr_b16 a[208:209], v164 offset:0
    v_add3_u32 v174, v8, v9, s3
    v_mfma_f32_16x16x32_bf16 v[28:31], a[220:223], a[248:251], v[28:31]
    buffer_load_dwordx4 v150, s[4:7], s47 offen offset:2048 lds
    v_mfma_f32_16x16x32_bf16 v[44:47], a[224:227], a[248:251], v[44:47]
    ds_read_b64_tr_b16 a[210:211], v164 offset:1024
    v_mfma_f32_16x16x32_bf16 v[60:63], a[228:231], a[248:251], v[60:63]
    ds_read_b128 a[192:195], v158 offset:4096
    v_add_u32 v175, 2832, v174
    v_mfma_f32_16x16x32_bf16 v[76:79], a[232:235], a[248:251], v[76:79]
    buffer_load_dwordx4 v151, s[4:7], s47 offen offset:3072 lds
    v_mfma_f32_16x16x32_bf16 v[72:75], a[232:235], a[244:247], v[72:75]
    ds_read_b64_tr_b16 a[212:213], v165 offset:0
    v_add_u32 v176, 5664, v174
    v_mfma_f32_16x16x32_bf16 v[68:71], a[232:235], a[240:243], v[68:71]
    ds_read_b64_tr_b16 a[214:215], v165 offset:1024
    v_add_u32 v177, 8496, v174
    v_mfma_f32_16x16x32_bf16 v[64:67], a[232:235], a[236:239], v[64:67]
    ds_read_b128 a[196:199], v158 offset:6144
    s_waitcnt lgkmcnt(9)
    v_mfma_f32_16x16x32_bf16 v[16:19], a[184:187], a[200:203], v[16:19]
    ds_read_b64_tr_b16 a[236:237], v162 offset:8192
    v_cmp_gt_u32 vcc, 21, v0
    s_waitcnt lgkmcnt(8)
    v_mfma_f32_16x16x32_bf16 v[20:23], a[184:187], a[204:207], v[20:23]
    ds_read_b64_tr_b16 a[238:239], v162 offset:9216
    v_mov_b32 v9, 1073741824
    s_waitcnt lgkmcnt(8)
    v_mfma_f32_16x16x32_bf16 v[36:39], a[188:191], a[204:207], v[36:39]
    ds_read_b128 a[220:223], v159 offset:0
    v_lshlrev_b32 v8, 5, v6
    v_mfma_f32_16x16x32_bf16 v[32:35], a[188:191], a[200:203], v[32:35]
    ds_read_b64_tr_b16 a[240:241], v163 offset:8192
    s_add_u32 m0, s50, 36864
    s_mov_b32 s48, 1228800
    s_waitcnt lgkmcnt(7)
    v_mfma_f32_16x16x32_bf16 v[48:51], a[192:195], a[200:203], v[48:51]
    buffer_load_dwordx4 v152, s[8:11], s48 offen offset:0 lds
    v_mfma_f32_16x16x32_bf16 v[52:55], a[192:195], a[204:207], v[52:55]
    ds_read_b64_tr_b16 a[242:243], v163 offset:9216
    v_cndmask_b32 v178, v9, v175, vcc
    v_mfma_f32_16x16x32_bf16 v[56:59], a[192:195], a[208:211], v[56:59]
    ds_read_b128 a[224:227], v159 offset:2048
    v_lshl_add_u32 v8, v5, 3, v8
    v_mfma_f32_16x16x32_bf16 v[40:43], a[188:191], a[208:211], v[40:43]
    ds_read_b64_tr_b16 a[244:245], v164 offset:8192
    s_mul_i32 s55, s38, 14144
    v_mfma_f32_16x16x32_bf16 v[24:27], a[184:187], a[208:211], v[24:27]
    ds_read_b64_tr_b16 a[246:247], v164 offset:9216
    s_waitcnt lgkmcnt(9)
    v_mfma_f32_16x16x32_bf16 v[28:31], a[184:187], a[212:215], v[28:31]
    buffer_load_dwordx4 v153, s[8:11], s48 offen offset:1024 lds
    s_nop 0
    v_mfma_f32_16x16x32_bf16 v[44:47], a[188:191], a[212:215], v[44:47]
    ds_read_b128 a[228:231], v159 offset:4096
    s_add_u32 s55, s55, 50688
    v_mfma_f32_16x16x32_bf16 v[60:63], a[192:195], a[212:215], v[60:63]
    ds_read_b64_tr_b16 a[248:249], v165 offset:8192
    v_add_u32 v8, s55, v8
    s_waitcnt lgkmcnt(10)
    v_mfma_f32_16x16x32_bf16 v[76:79], a[196:199], a[212:215], v[76:79]
    ds_read_b64_tr_b16 a[250:251], v165 offset:9216
    v_lshl_add_u32 v9, v4, 2, v3
    v_mfma_f32_16x16x32_bf16 v[72:75], a[196:199], a[208:211], v[72:75]
    ds_read_b128 a[232:235], v159 offset:6144
    v_mfma_f32_16x16x32_bf16 v[68:71], a[196:199], a[204:207], v[68:71]
    buffer_load_dwordx4 v154, s[8:11], s48 offen offset:2048 lds
    v_mfma_f32_16x16x32_bf16 v[64:67], a[196:199], a[200:203], v[64:67]
    buffer_load_dwordx4 v155, s[8:11], s48 offen offset:3072 lds
    s_waitcnt vmcnt(8) lgkmcnt(0)
    s_barrier
    v_mfma_f32_16x16x32_bf16 v[16:19], a[220:223], a[236:239], v[16:19]
    ds_read_b64_tr_b16 a[200:201], v167 offset:0
    v_mul_u32_u24 v9, 336, v9
    v_mfma_f32_16x16x32_bf16 v[20:23], a[220:223], a[240:243], v[20:23]
    ds_read_b64_tr_b16 a[202:203], v167 offset:1024
    v_add_u32 v236, v8, v9
    v_mfma_f32_16x16x32_bf16 v[36:39], a[224:227], a[240:243], v[36:39]
    ds_read_b128 a[184:187], v160 offset:0
    s_add_u32 m0, s49, 0
    s_mov_b32 s47, 768
    v_lshrrev_b32_e64 v9, 1, v4
    v_mfma_f32_16x16x32_bf16 v[32:35], a[224:227], a[236:239], v[32:35]
    buffer_load_dwordx4 v148, s[4:7], s47 offen offset:0 lds
    v_mfma_f32_16x16x32_bf16 v[48:51], a[228:231], a[236:239], v[48:51]
    ds_read_b64_tr_b16 a[204:205], v168 offset:0
    v_mfma_f32_16x16x32_bf16 v[52:55], a[228:231], a[240:243], v[52:55]
    ds_read_b64_tr_b16 a[206:207], v168 offset:1024
    v_mul_u32_u24_e64 v9, 20, v9
    v_mfma_f32_16x16x32_bf16 v[56:59], a[228:231], a[244:247], v[56:59]
    buffer_load_dwordx4 v149, s[4:7], s47 offen offset:1024 lds
    v_mfma_f32_16x16x32_bf16 v[40:43], a[224:227], a[244:247], v[40:43]
    ds_read_b128 a[188:191], v160 offset:2048
    v_and_b32_e64 v10, 1, v4
    v_mfma_f32_16x16x32_bf16 v[24:27], a[220:223], a[244:247], v[24:27]
    ds_read_b64_tr_b16 a[208:209], v169 offset:0
    v_lshl_add_u32 v10, v3, 1, v10
    v_mfma_f32_16x16x32_bf16 v[28:31], a[220:223], a[248:251], v[28:31]
    buffer_load_dwordx4 v150, s[4:7], s47 offen offset:2048 lds
    v_mfma_f32_16x16x32_bf16 v[44:47], a[224:227], a[248:251], v[44:47]
    ds_read_b64_tr_b16 a[210:211], v169 offset:1024
    v_mfma_f32_16x16x32_bf16 v[60:63], a[228:231], a[248:251], v[60:63]
    ds_read_b128 a[192:195], v160 offset:4096
    v_add3_u32 v9, v9, v10, 16
    v_mfma_f32_16x16x32_bf16 v[76:79], a[232:235], a[248:251], v[76:79]
    buffer_load_dwordx4 v151, s[4:7], s47 offen offset:3072 lds
    v_mfma_f32_16x16x32_bf16 v[72:75], a[232:235], a[244:247], v[72:75]
    ds_read_b64_tr_b16 a[212:213], v170 offset:0
    v_mul_u32_u24 v9, 336, v9
    v_mfma_f32_16x16x32_bf16 v[68:71], a[232:235], a[240:243], v[68:71]
    ds_read_b64_tr_b16 a[214:215], v170 offset:1024
    v_add_u32_e64 v237, v8, v9
    v_mfma_f32_16x16x32_bf16 v[64:67], a[232:235], a[236:239], v[64:67]
    ds_read_b128 a[196:199], v160 offset:6144
    s_waitcnt lgkmcnt(9)
    v_mfma_f32_16x16x32_bf16 v[16:19], a[184:187], a[200:203], v[16:19]
    ds_read_b64_tr_b16 a[236:237], v167 offset:8192
    s_waitcnt lgkmcnt(8)
    v_mfma_f32_16x16x32_bf16 v[20:23], a[184:187], a[204:207], v[20:23]
    ds_read_b64_tr_b16 a[238:239], v167 offset:9216
    s_waitcnt lgkmcnt(8)
    v_mfma_f32_16x16x32_bf16 v[36:39], a[188:191], a[204:207], v[36:39]
    ds_read_b128 a[220:223], v161 offset:0
    v_mfma_f32_16x16x32_bf16 v[32:35], a[188:191], a[200:203], v[32:35]
    ds_read_b64_tr_b16 a[240:241], v168 offset:8192
    s_add_u32 m0, s50, 0
    s_mov_b32 s48, 1474560
    s_waitcnt lgkmcnt(7)
    v_mfma_f32_16x16x32_bf16 v[48:51], a[192:195], a[200:203], v[48:51]
    buffer_load_dwordx4 v152, s[8:11], s48 offen offset:0 lds
    s_nop 0
    v_mfma_f32_16x16x32_bf16 v[52:55], a[192:195], a[204:207], v[52:55]
    ds_read_b64_tr_b16 a[242:243], v168 offset:9216
    v_mfma_f32_16x16x32_bf16 v[56:59], a[192:195], a[208:211], v[56:59]
    ds_read_b128 a[224:227], v161 offset:2048
    v_mfma_f32_16x16x32_bf16 v[40:43], a[188:191], a[208:211], v[40:43]
    ds_read_b64_tr_b16 a[244:245], v169 offset:8192
    v_mfma_f32_16x16x32_bf16 v[24:27], a[184:187], a[208:211], v[24:27]
    ds_read_b64_tr_b16 a[246:247], v169 offset:9216
    s_waitcnt lgkmcnt(9)
    v_mfma_f32_16x16x32_bf16 v[28:31], a[184:187], a[212:215], v[28:31]
    buffer_load_dwordx4 v153, s[8:11], s48 offen offset:1024 lds
    v_mfma_f32_16x16x32_bf16 v[44:47], a[188:191], a[212:215], v[44:47]
    ds_read_b128 a[228:231], v161 offset:4096
    v_mfma_f32_16x16x32_bf16 v[60:63], a[192:195], a[212:215], v[60:63]
    ds_read_b64_tr_b16 a[248:249], v170 offset:8192
    s_waitcnt lgkmcnt(10)
    v_mfma_f32_16x16x32_bf16 v[76:79], a[196:199], a[212:215], v[76:79]
    ds_read_b64_tr_b16 a[250:251], v170 offset:9216
    v_mfma_f32_16x16x32_bf16 v[72:75], a[196:199], a[208:211], v[72:75]
    ds_read_b128 a[232:235], v161 offset:6144
    v_mfma_f32_16x16x32_bf16 v[68:71], a[196:199], a[204:207], v[68:71]
    buffer_load_dwordx4 v154, s[8:11], s48 offen offset:2048 lds
    v_mfma_f32_16x16x32_bf16 v[64:67], a[196:199], a[200:203], v[64:67]
    buffer_load_dwordx4 v155, s[8:11], s48 offen offset:3072 lds
    s_waitcnt vmcnt(8) lgkmcnt(0)
    s_barrier
    v_mfma_f32_16x16x32_bf16 v[16:19], a[220:223], a[236:239], v[16:19]
    ds_read_b64_tr_b16 a[200:201], v162 offset:36864
    v_mfma_f32_16x16x32_bf16 v[20:23], a[220:223], a[240:243], v[20:23]
    ds_read_b64_tr_b16 a[202:203], v162 offset:37888
    v_mfma_f32_16x16x32_bf16 v[36:39], a[224:227], a[240:243], v[36:39]
    ds_read_b128 a[184:187], v158 offset:36864
    s_add_u32 m0, s49, 73728
    s_mov_b32 s47, 896
    v_mfma_f32_16x16x32_bf16 v[32:35], a[224:227], a[236:239], v[32:35]
    buffer_load_dwordx4 v148, s[4:7], s47 offen offset:0 lds
    v_mfma_f32_16x16x32_bf16 v[48:51], a[228:231], a[236:239], v[48:51]
    ds_read_b64_tr_b16 a[204:205], v163 offset:36864
    v_mfma_f32_16x16x32_bf16 v[52:55], a[228:231], a[240:243], v[52:55]
    ds_read_b64_tr_b16 a[206:207], v163 offset:37888
    v_mfma_f32_16x16x32_bf16 v[56:59], a[228:231], a[244:247], v[56:59]
    buffer_load_dwordx4 v149, s[4:7], s47 offen offset:1024 lds
    v_mfma_f32_16x16x32_bf16 v[40:43], a[224:227], a[244:247], v[40:43]
    ds_read_b128 a[188:191], v158 offset:38912
    v_mfma_f32_16x16x32_bf16 v[24:27], a[220:223], a[244:247], v[24:27]
    ds_read_b64_tr_b16 a[208:209], v164 offset:36864
    v_mfma_f32_16x16x32_bf16 v[28:31], a[220:223], a[248:251], v[28:31]
    buffer_load_dwordx4 v150, s[4:7], s47 offen offset:2048 lds
    v_mfma_f32_16x16x32_bf16 v[44:47], a[224:227], a[248:251], v[44:47]
    ds_read_b64_tr_b16 a[210:211], v164 offset:37888
    v_mfma_f32_16x16x32_bf16 v[60:63], a[228:231], a[248:251], v[60:63]
    ds_read_b128 a[192:195], v158 offset:40960
    v_mfma_f32_16x16x32_bf16 v[76:79], a[232:235], a[248:251], v[76:79]
    buffer_load_dwordx4 v151, s[4:7], s47 offen offset:3072 lds
    v_mfma_f32_16x16x32_bf16 v[72:75], a[232:235], a[244:247], v[72:75]
    ds_read_b64_tr_b16 a[212:213], v165 offset:36864
    v_mfma_f32_16x16x32_bf16 v[68:71], a[232:235], a[240:243], v[68:71]
    ds_read_b64_tr_b16 a[214:215], v165 offset:37888
    v_mfma_f32_16x16x32_bf16 v[64:67], a[232:235], a[236:239], v[64:67]
    ds_read_b128 a[196:199], v158 offset:43008
    s_waitcnt lgkmcnt(9)
    v_mfma_f32_16x16x32_bf16 v[16:19], a[184:187], a[200:203], v[16:19]
    ds_read_b64_tr_b16 a[236:237], v162 offset:45056
    s_waitcnt lgkmcnt(8)
    v_mfma_f32_16x16x32_bf16 v[20:23], a[184:187], a[204:207], v[20:23]
    ds_read_b64_tr_b16 a[238:239], v162 offset:46080
    s_waitcnt lgkmcnt(8)
    s_nop 0
    v_mfma_f32_16x16x32_bf16 v[36:39], a[188:191], a[204:207], v[36:39]
    ds_read_b128 a[220:223], v159 offset:36864
    v_mfma_f32_16x16x32_bf16 v[32:35], a[188:191], a[200:203], v[32:35]
    ds_read_b64_tr_b16 a[240:241], v163 offset:45056
    s_add_u32 m0, s50, 73728
    s_mov_b32 s48, 1720320
    s_waitcnt lgkmcnt(7)
    v_mfma_f32_16x16x32_bf16 v[48:51], a[192:195], a[200:203], v[48:51]
    s_nop 0
    buffer_load_dwordx4 v152, s[8:11], s48 offen offset:0 lds
    v_mfma_f32_16x16x32_bf16 v[52:55], a[192:195], a[204:207], v[52:55]
    ds_read_b64_tr_b16 a[242:243], v163 offset:46080
    v_mfma_f32_16x16x32_bf16 v[56:59], a[192:195], a[208:211], v[56:59]
    ds_read_b128 a[224:227], v159 offset:38912
    v_mfma_f32_16x16x32_bf16 v[40:43], a[188:191], a[208:211], v[40:43]
    ds_read_b64_tr_b16 a[244:245], v164 offset:45056
    v_mfma_f32_16x16x32_bf16 v[24:27], a[184:187], a[208:211], v[24:27]
    ds_read_b64_tr_b16 a[246:247], v164 offset:46080
    s_waitcnt lgkmcnt(9)
    v_mfma_f32_16x16x32_bf16 v[28:31], a[184:187], a[212:215], v[28:31]
    buffer_load_dwordx4 v153, s[8:11], s48 offen offset:1024 lds
    v_mfma_f32_16x16x32_bf16 v[44:47], a[188:191], a[212:215], v[44:47]
    ds_read_b128 a[228:231], v159 offset:40960
    v_mfma_f32_16x16x32_bf16 v[60:63], a[192:195], a[212:215], v[60:63]
    ds_read_b64_tr_b16 a[248:249], v165 offset:45056
    s_waitcnt lgkmcnt(10)
    v_mfma_f32_16x16x32_bf16 v[76:79], a[196:199], a[212:215], v[76:79]
    ds_read_b64_tr_b16 a[250:251], v165 offset:46080
    v_mfma_f32_16x16x32_bf16 v[72:75], a[196:199], a[208:211], v[72:75]
    ds_read_b128 a[232:235], v159 offset:43008
    v_mfma_f32_16x16x32_bf16 v[68:71], a[196:199], a[204:207], v[68:71]
    buffer_load_dwordx4 v154, s[8:11], s48 offen offset:2048 lds
    v_mfma_f32_16x16x32_bf16 v[64:67], a[196:199], a[200:203], v[64:67]
    buffer_load_dwordx4 v155, s[8:11], s48 offen offset:3072 lds
    s_waitcnt vmcnt(8) lgkmcnt(0)
    s_barrier
    v_mfma_f32_16x16x32_bf16 v[16:19], a[220:223], a[236:239], v[16:19]
    ds_read_b64_tr_b16 a[200:201], v162 offset:0
    v_mfma_f32_16x16x32_bf16 v[20:23], a[220:223], a[240:243], v[20:23]
    ds_read_b64_tr_b16 a[202:203], v162 offset:1024
    v_mfma_f32_16x16x32_bf16 v[36:39], a[224:227], a[240:243], v[36:39]
    ds_read_b128 a[184:187], v158 offset:0
    s_add_u32 m0, s49, 36864
    s_mov_b32 s47, 1024
    v_mfma_f32_16x16x32_bf16 v[32:35], a[224:227], a[236:239], v[32:35]
    buffer_load_dwordx4 v148, s[4:7], s47 offen offset:0 lds
    v_mfma_f32_16x16x32_bf16 v[48:51], a[228:231], a[236:239], v[48:51]
    ds_read_b64_tr_b16 a[204:205], v163 offset:0
    v_mfma_f32_16x16x32_bf16 v[52:55], a[228:231], a[240:243], v[52:55]
    ds_read_b64_tr_b16 a[206:207], v163 offset:1024
    v_mfma_f32_16x16x32_bf16 v[56:59], a[228:231], a[244:247], v[56:59]
    buffer_load_dwordx4 v149, s[4:7], s47 offen offset:1024 lds
    v_mfma_f32_16x16x32_bf16 v[40:43], a[224:227], a[244:247], v[40:43]
    ds_read_b128 a[188:191], v158 offset:2048
    v_mfma_f32_16x16x32_bf16 v[24:27], a[220:223], a[244:247], v[24:27]
    ds_read_b64_tr_b16 a[208:209], v164 offset:0
    v_mfma_f32_16x16x32_bf16 v[28:31], a[220:223], a[248:251], v[28:31]
    buffer_load_dwordx4 v150, s[4:7], s47 offen offset:2048 lds
    v_mfma_f32_16x16x32_bf16 v[44:47], a[224:227], a[248:251], v[44:47]
    ds_read_b64_tr_b16 a[210:211], v164 offset:1024
    v_mfma_f32_16x16x32_bf16 v[60:63], a[228:231], a[248:251], v[60:63]
    ds_read_b128 a[192:195], v158 offset:4096
    v_mfma_f32_16x16x32_bf16 v[76:79], a[232:235], a[248:251], v[76:79]
    buffer_load_dwordx4 v151, s[4:7], s47 offen offset:3072 lds
    v_mfma_f32_16x16x32_bf16 v[72:75], a[232:235], a[244:247], v[72:75]
    ds_read_b64_tr_b16 a[212:213], v165 offset:0
    v_mfma_f32_16x16x32_bf16 v[68:71], a[232:235], a[240:243], v[68:71]
    ds_read_b64_tr_b16 a[214:215], v165 offset:1024
    v_mfma_f32_16x16x32_bf16 v[64:67], a[232:235], a[236:239], v[64:67]
    ds_read_b128 a[196:199], v158 offset:6144
    s_waitcnt lgkmcnt(9)
    v_mfma_f32_16x16x32_bf16 v[16:19], a[184:187], a[200:203], v[16:19]
    ds_read_b64_tr_b16 a[236:237], v162 offset:8192
    ds_read_b64_tr_b16 a[238:239], v162 offset:9216
    global_load_dword v195, v196, s[36:37] offset:128 sc1
    s_waitcnt lgkmcnt(9)
    v_mfma_f32_16x16x32_bf16 v[20:23], a[184:187], a[204:207], v[20:23]
    ds_read_b128 a[220:223], v159 offset:0
    s_waitcnt lgkmcnt(9)
    v_mfma_f32_16x16x32_bf16 v[36:39], a[188:191], a[204:207], v[36:39]
    s_nop 0
    ds_read_b64_tr_b16 a[240:241], v163 offset:8192
    v_mfma_f32_16x16x32_bf16 v[32:35], a[188:191], a[200:203], v[32:35]
    ds_read_b64_tr_b16 a[242:243], v163 offset:9216
    s_add_u32 m0, s50, 36864
    s_mov_b32 s48, 1966080
    buffer_load_dwordx4 v152, s[8:11], s48 offen offset:0 lds
    s_waitcnt lgkmcnt(8)
    v_mfma_f32_16x16x32_bf16 v[48:51], a[192:195], a[200:203], v[48:51]
    s_nop 0
    ds_read_b128 a[224:227], v159 offset:2048
    v_mfma_f32_16x16x32_bf16 v[52:55], a[192:195], a[204:207], v[52:55]
    ds_read_b64_tr_b16 a[244:245], v164 offset:8192
    ds_read_b64_tr_b16 a[246:247], v164 offset:9216
    v_mfma_f32_16x16x32_bf16 v[56:59], a[192:195], a[208:211], v[56:59]
    ds_read_b128 a[228:231], v159 offset:4096
    buffer_load_dwordx4 v153, s[8:11], s48 offen offset:1024 lds
    v_mfma_f32_16x16x32_bf16 v[40:43], a[188:191], a[208:211], v[40:43]
    ds_read_b64_tr_b16 a[248:249], v165 offset:8192
    v_mfma_f32_16x16x32_bf16 v[24:27], a[184:187], a[208:211], v[24:27]
    ds_read_b64_tr_b16 a[250:251], v165 offset:9216
    s_waitcnt lgkmcnt(12)
    s_nop 0
    v_mfma_f32_16x16x32_bf16 v[28:31], a[184:187], a[212:215], v[28:31]
    ds_read_b128 a[232:235], v159 offset:6144
    buffer_load_dwordx4 v154, s[8:11], s48 offen offset:2048 lds
    v_mfma_f32_16x16x32_bf16 v[44:47], a[188:191], a[212:215], v[44:47]
    v_mfma_f32_16x16x32_bf16 v[60:63], a[192:195], a[212:215], v[60:63]
    s_waitcnt lgkmcnt(12)
    v_mfma_f32_16x16x32_bf16 v[76:79], a[196:199], a[212:215], v[76:79]
    buffer_load_dwordx4 v155, s[8:11], s48 offen offset:3072 lds
    v_mfma_f32_16x16x32_bf16 v[72:75], a[196:199], a[208:211], v[72:75]
    v_mfma_f32_16x16x32_bf16 v[68:71], a[196:199], a[204:207], v[68:71]
    v_mfma_f32_16x16x32_bf16 v[64:67], a[196:199], a[200:203], v[64:67]
    s_waitcnt vmcnt(9) lgkmcnt(0)
    s_barrier
    s_nop 0
    v_mfma_f32_16x16x32_bf16 v[16:19], a[220:223], a[236:239], v[16:19]
    ds_read_b64_tr_b16 a[200:201], v167 offset:0
    v_mfma_f32_16x16x32_bf16 v[20:23], a[220:223], a[240:243], v[20:23]
    ds_read_b64_tr_b16 a[202:203], v167 offset:1024
    v_mfma_f32_16x16x32_bf16 v[36:39], a[224:227], a[240:243], v[36:39]
    ds_read_b128 a[184:187], v160 offset:0
    s_add_u32 m0, s49, 0
    s_mov_b32 s47, 1152
    s_nop 0
    v_mfma_f32_16x16x32_bf16 v[32:35], a[224:227], a[236:239], v[32:35]
    buffer_load_dwordx4 v148, s[4:7], s47 offen offset:0 lds
    v_mfma_f32_16x16x32_bf16 v[48:51], a[228:231], a[236:239], v[48:51]
    ds_read_b64_tr_b16 a[204:205], v168 offset:0
    v_mfma_f32_16x16x32_bf16 v[52:55], a[228:231], a[240:243], v[52:55]
    ds_read_b64_tr_b16 a[206:207], v168 offset:1024
    v_mfma_f32_16x16x32_bf16 v[56:59], a[228:231], a[244:247], v[56:59]
    buffer_load_dwordx4 v149, s[4:7], s47 offen offset:1024 lds
    v_mfma_f32_16x16x32_bf16 v[40:43], a[224:227], a[244:247], v[40:43]
    ds_read_b128 a[188:191], v160 offset:2048
    v_mfma_f32_16x16x32_bf16 v[24:27], a[220:223], a[244:247], v[24:27]
    ds_read_b64_tr_b16 a[208:209], v169 offset:0
L_pg6:
    s_cbranch_execz L_ret
    v_mfma_f32_16x16x32_bf16 v[28:31], a[220:223], a[248:251], v[28:31]
    buffer_load_dwordx4 v150, s[4:7], s47 offen offset:2048 lds
    v_mfma_f32_16x16x32_bf16 v[44:47], a[224:227], a[248:251], v[44:47]
    s_nop 0
    ds_read_b64_tr_b16 a[210:211], v169 offset:1024
    v_mfma_f32_16x16x32_bf16 v[60:63], a[228:231], a[248:251], v[60:63]
    ds_read_b128 a[192:195], v160 offset:4096
    v_mfma_f32_16x16x32_bf16 v[76:79], a[232:235], a[248:251], v[76:79]
    buffer_load_dwordx4 v151, s[4:7], s47 offen offset:3072 lds
    v_mfma_f32_16x16x32_bf16 v[72:75], a[232:235], a[244:247], v[72:75]
    ds_read_b64_tr_b16 a[212:213], v170 offset:0
    v_mfma_f32_16x16x32_bf16 v[68:71], a[232:235], a[240:243], v[68:71]
    ds_read_b64_tr_b16 a[214:215], v170 offset:1024
    v_mfma_f32_16x16x32_bf16 v[64:67], a[232:235], a[236:239], v[64:67]
    ds_read_b128 a[196:199], v160 offset:6144
    s_waitcnt lgkmcnt(9)
    v_mfma_f32_16x16x32_bf16 v[16:19], a[184:187], a[200:203], v[16:19]
    ds_read_b64_tr_b16 a[236:237], v167 offset:8192
    ds_read_b64_tr_b16 a[238:239], v167 offset:9216
    s_add_u32 m0, s50, 0
    s_mov_b32 s48, 2211840
    buffer_load_dwordx4 v152, s[8:11], s48 offen offset:0 lds
    s_waitcnt lgkmcnt(9)
    v_mfma_f32_16x16x32_bf16 v[20:23], a[184:187], a[204:207], v[20:23]
    ds_read_b128 a[220:223], v161 offset:0
    s_waitcnt lgkmcnt(9)
    v_mfma_f32_16x16x32_bf16 v[36:39], a[188:191], a[204:207], v[36:39]
    ds_read_b64_tr_b16 a[240:241], v168 offset:8192
    v_mfma_f32_16x16x32_bf16 v[32:35], a[188:191], a[200:203], v[32:35]
    ds_read_b64_tr_b16 a[242:243], v168 offset:9216
    buffer_load_dwordx4 v153, s[8:11], s48 offen offset:1024 lds
    s_waitcnt lgkmcnt(8)
    v_mfma_f32_16x16x32_bf16 v[48:51], a[192:195], a[200:203], v[48:51]
    ds_read_b128 a[224:227], v161 offset:2048
    s_nop 0
    v_mfma_f32_16x16x32_bf16 v[52:55], a[192:195], a[204:207], v[52:55]
    ds_read_b64_tr_b16 a[244:245], v169 offset:8192
    ds_read_b64_tr_b16 a[246:247], v169 offset:9216
    v_mfma_f32_16x16x32_bf16 v[56:59], a[192:195], a[208:211], v[56:59]
    ds_read_b128 a[228:231], v161 offset:4096
    buffer_load_dwordx4 v154, s[8:11], s48 offen offset:2048 lds
    v_mfma_f32_16x16x32_bf16 v[40:43], a[188:191], a[208:211], v[40:43]
    ds_read_b64_tr_b16 a[248:249], v170 offset:8192
    v_mfma_f32_16x16x32_bf16 v[24:27], a[184:187], a[208:211], v[24:27]
    ds_read_b64_tr_b16 a[250:251], v170 offset:9216
    s_waitcnt lgkmcnt(12)
    v_mfma_f32_16x16x32_bf16 v[28:31], a[184:187], a[212:215], v[28:31]
    ds_read_b128 a[232:235], v161 offset:6144
    buffer_load_dwordx4 v155, s[8:11], s48 offen offset:3072 lds
    v_mfma_f32_16x16x32_bf16 v[44:47], a[188:191], a[212:215], v[44:47]
    v_mfma_f32_16x16x32_bf16 v[60:63], a[192:195], a[212:215], v[60:63]
    s_waitcnt lgkmcnt(12)
    v_mfma_f32_16x16x32_bf16 v[76:79], a[196:199], a[212:215], v[76:79]
    s_lshl_b32 s0, s40, 2
    s_add_u32 s0, s0, s38
    s_lshl_b32 s0, s0, 7
    s_min_u32 s0, s0, L_end-L_phaseB
    v_mov_b32 v15, s0
    s_getpc_b64 s[0:1]
L_pc_31:
    s_add_u32 s0, s0, L_phaseB-L_pc_31
    s_addc_u32 s1, s1, 0
    global_load_dword v255, v15, s[0:1]
    s_waitcnt vmcnt(13)
    v_cmp_gt_u32 vcc, 1, v195
    v_mfma_f32_16x16x32_bf16 v[72:75], a[196:199], a[208:211], v[72:75]
    v_mfma_f32_16x16x32_bf16 v[68:71], a[196:199], a[204:207], v[68:71]
    s_cbranch_vccz L_ok_32
    s_mov_b32 s43, 0
L_spin_33:
    s_sleep 4
    global_load_dword v195, v196, s[36:37] offset:128 sc1
    s_add_u32 s43, s43, 1
    s_cmp_ge_u32 s43, 20000
    s_waitcnt vmcnt(0)
    s_cbranch_scc1 L_ok_32
    v_cmp_gt_u32 vcc, 1, v195
    s_nop 1
    s_cbranch_vccnz L_spin_33
L_ok_32:
    v_mfma_f32_16x16x32_bf16 v[64:67], a[196:199], a[200:203], v[64:67]
    s_waitcnt vmcnt(9) lgkmcnt(0)
    s_barrier
    v_mfma_f32_16x16x32_bf16 v[16:19], a[220:223], a[236:239], v[16:19]
    s_nop 0
    ds_read_b64_tr_b16 a[200:201], v162 offset:36864
    buffer_load_dwordx2 v[198:199], v186, s[28:31], 0 offen sc1
    v_mfma_f32_16x16x32_bf16 v[20:23], a[220:223], a[240:243], v[20:23]
    ds_read_b64_tr_b16 a[202:203], v162 offset:37888
    v_mfma_f32_16x16x32_bf16 v[36:39], a[224:227], a[240:243], v[36:39]
    ds_read_b128 a[184:187], v158 offset:36864
    buffer_load_dword v128, v187, s[28:31], 0 offen offset:0 sc1
    v_mfma_f32_16x16x32_bf16 v[32:35], a[224:227], a[236:239], v[32:35]
    ds_read_b64_tr_b16 a[204:205], v163 offset:36864
    v_mfma_f32_16x16x32_bf16 v[48:51], a[228:231], a[236:239], v[48:51]
    ds_read_b64_tr_b16 a[206:207], v163 offset:37888
    buffer_load_dword v130, v187, s[28:31], 0 offen offset:64 sc1
    v_mfma_f32_16x16x32_bf16 v[52:55], a[228:231], a[240:243], v[52:55]
    ds_read_b128 a[188:191], v158 offset:38912
    v_mfma_f32_16x16x32_bf16 v[56:59], a[228:231], a[244:247], v[56:59]
    ds_read_b64_tr_b16 a[208:209], v164 offset:36864
    buffer_load_dword v132, v187, s[28:31], 0 offen offset:128 sc1
    v_mfma_f32_16x16x32_bf16 v[40:43], a[224:227], a[244:247], v[40:43]
    ds_read_b64_tr_b16 a[210:211], v164 offset:37888
    v_mfma_f32_16x16x32_bf16 v[24:27], a[220:223], a[244:247], v[24:27]
    ds_read_b128 a[192:195], v158 offset:40960
    buffer_load_dword v134, v187, s[28:31], 0 offen offset:192 sc1
    v_mfma_f32_16x16x32_bf16 v[28:31], a[220:223], a[248:251], v[28:31]
    ds_read_b64_tr_b16 a[212:213], v165 offset:36864
    v_mfma_f32_16x16x32_bf16 v[44:47], a[224:227], a[248:251], v[44:47]
    ds_read_b64_tr_b16 a[214:215], v165 offset:37888
    s_add_u32 m0, s55, 56576
    s_mov_b32 s47, 0
    s_nop 0
    buffer_load_dwordx4 v174, s[12:15], s47 offen offset:0 lds
    v_mfma_f32_16x16x32_bf16 v[60:63], a[228:231], a[248:251], v[60:63]
    ds_read_b128 a[196:199], v158 offset:43008
    v_mfma_f32_16x16x32_bf16 v[76:79], a[232:235], a[248:251], v[76:79]
    buffer_load_dwordx4 v175, s[12:15], s47 offen offset:1008 lds
    v_mfma_f32_16x16x32_bf16 v[72:75], a[232:235], a[244:247], v[72:75]
    v_mfma_f32_16x16x32_bf16 v[68:71], a[232:235], a[240:243], v[68:71]
    buffer_load_dwordx4 v176, s[12:15], s47 offen offset:2016 lds
    v_mfma_f32_16x16x32_bf16 v[64:67], a[232:235], a[236:239], v[64:67]
    s_waitcnt lgkmcnt(9)
    v_mfma_f32_16x16x32_bf16 v[16:19], a[184:187], a[200:203], v[16:19]
    ds_read_b64_tr_b16 a[236:237], v162 offset:45056
    s_waitcnt lgkmcnt(8)
    v_mfma_f32_16x16x32_bf16 v[20:23], a[184:187], a[204:207], v[20:23]
    ds_read_b64_tr_b16 a[238:239], v162 offset:46080
    s_waitcnt lgkmcnt(8)
    v_mfma_f32_16x16x32_bf16 v[36:39], a[188:191], a[204:207], v[36:39]
    ds_read_b128 a[220:223], v159 offset:36864
    v_mfma_f32_16x16x32_bf16 v[32:35], a[188:191], a[200:203], v[32:35]
    ds_read_b64_tr_b16 a[240:241], v163 offset:45056
    s_waitcnt lgkmcnt(7)
    v_mfma_f32_16x16x32_bf16 v[48:51], a[192:195], a[200:203], v[48:51]
    buffer_load_dwordx4 v177, s[12:15], s47 offen offset:3024 lds
    v_mfma_f32_16x16x32_bf16 v[52:55], a[192:195], a[204:207], v[52:55]
    ds_read_b64_tr_b16 a[242:243], v163 offset:46080
    v_mfma_f32_16x16x32_bf16 v[56:59], a[192:195], a[208:211], v[56:59]
    ds_read_b128 a[224:227], v159 offset:38912
    v_mfma_f32_16x16x32_bf16 v[40:43], a[188:191], a[208:211], v[40:43]
    ds_read_b64_tr_b16 a[244:245], v164 offset:45056
    v_mfma_f32_16x16x32_bf16 v[24:27], a[184:187], a[208:211], v[24:27]
    ds_read_b64_tr_b16 a[246:247], v164 offset:46080
    s_add_u32 m0, s55, 60608
    s_mov_b32 s47, 15360
    s_waitcnt lgkmcnt(9)
    s_nop 0
    v_mfma_f32_16x16x32_bf16 v[28:31], a[184:187], a[212:215], v[28:31]
    buffer_load_dwordx4 v174, s[12:15], s47 offen offset:0 lds
    v_mfma_f32_16x16x32_bf16 v[44:47], a[188:191], a[212:215], v[44:47]
    ds_read_b128 a[228:231], v159 offset:40960
    v_mfma_f32_16x16x32_bf16 v[60:63], a[192:195], a[212:215], v[60:63]
    ds_read_b64_tr_b16 a[248:249], v165 offset:45056
    s_waitcnt lgkmcnt(10)
    v_mfma_f32_16x16x32_bf16 v[76:79], a[196:199], a[212:215], v[76:79]
    s_nop 0
    ds_read_b64_tr_b16 a[250:251], v165 offset:46080
    v_mfma_f32_16x16x32_bf16 v[72:75], a[196:199], a[208:211], v[72:75]
    ds_read_b128 a[232:235], v159 offset:43008
    v_mfma_f32_16x16x32_bf16 v[68:71], a[196:199], a[204:207], v[68:71]
    buffer_load_dwordx4 v175, s[12:15], s47 offen offset:1008 lds
    v_mfma_f32_16x16x32_bf16 v[64:67], a[196:199], a[200:203], v[64:67]
    buffer_load_dwordx4 v176, s[12:15], s47 offen offset:2016 lds
    s_waitcnt vmcnt(13) lgkmcnt(0)
    s_barrier
    v_mfma_f32_16x16x32_bf16 v[16:19], a[220:223], a[236:239], v[16:19]
    ds_read_b64_tr_b16 a[200:201], v162 offset:0
    buffer_load_dwordx4 v177, s[12:15], s47 offen offset:3024 lds
    v_mfma_f32_16x16x32_bf16 v[20:23], a[220:223], a[240:243], v[20:23]
    ds_read_b64_tr_b16 a[202:203], v162 offset:1024
    v_mfma_f32_16x16x32_bf16 v[36:39], a[224:227], a[240:243], v[36:39]
    ds_read_b128 a[184:187], v158 offset:0
    v_mfma_f32_16x16x32_bf16 v[32:35], a[224:227], a[236:239], v[32:35]
    ds_read_b64_tr_b16 a[204:205], v163 offset:0
    v_mfma_f32_16x16x32_bf16 v[48:51], a[228:231], a[236:239], v[48:51]
    ds_read_b64_tr_b16 a[206:207], v163 offset:1024
    s_add_u32 m0, s55, 64640
    s_mov_b32 s47, 30720
    buffer_load_dwordx4 v174, s[12:15], s47 offen offset:0 lds
    v_mfma_f32_16x16x32_bf16 v[52:55], a[228:231], a[240:243], v[52:55]
    ds_read_b128 a[188:191], v158 offset:2048
    v_mfma_f32_16x16x32_bf16 v[56:59], a[228:231], a[244:247], v[56:59]
    ds_read_b64_tr_b16 a[208:209], v164 offset:0
    v_mfma_f32_16x16x32_bf16 v[40:43], a[224:227], a[244:247], v[40:43]
    ds_read_b64_tr_b16 a[210:211], v164 offset:1024
    v_mfma_f32_16x16x32_bf16 v[24:27], a[220:223], a[244:247], v[24:27]
    ds_read_b128 a[192:195], v158 offset:4096
    buffer_load_dwordx4 v175, s[12:15], s47 offen offset:1008 lds
    v_mfma_f32_16x16x32_bf16 v[28:31], a[220:223], a[248:251], v[28:31]
    ds_read_b64_tr_b16 a[212:213], v165 offset:0
    v_mfma_f32_16x16x32_bf16 v[44:47], a[224:227], a[248:251], v[44:47]
    ds_read_b64_tr_b16 a[214:215], v165 offset:1024
    v_mfma_f32_16x16x32_bf16 v[60:63], a[228:231], a[248:251], v[60:63]
    ds_read_b128 a[196:199], v158 offset:6144
    v_mfma_f32_16x16x32_bf16 v[76:79], a[232:235], a[248:251], v[76:79]
    buffer_load_dwordx4 v176, s[12:15], s47 offen offset:2016 lds
    v_mfma_f32_16x16x32_bf16 v[72:75], a[232:235], a[244:247], v[72:75]
    v_mfma_f32_16x16x32_bf16 v[68:71], a[232:235], a[240:243], v[68:71]
    v_mfma_f32_16x16x32_bf16 v[64:67], a[232:235], a[236:239], v[64:67]
    s_waitcnt lgkmcnt(9)
    v_mfma_f32_16x16x32_bf16 v[16:19], a[184:187], a[200:203], v[16:19]
    ds_read_b64_tr_b16 a[236:237], v162 offset:8192
    ds_read_b64_tr_b16 a[238:239], v162 offset:9216
    buffer_load_dwordx4 v177, s[12:15], s47 offen offset:3024 lds
    s_waitcnt lgkmcnt(9)
    v_mfma_f32_16x16x32_bf16 v[20:23], a[184:187], a[204:207], v[20:23]
    ds_read_b128 a[220:223], v159 offset:0
    s_waitcnt lgkmcnt(9)
    v_mfma_f32_16x16x32_bf16 v[36:39], a[188:191], a[204:207], v[36:39]
    ds_read_b64_tr_b16 a[240:241], v163 offset:8192
    v_mfma_f32_16x16x32_bf16 v[32:35], a[188:191], a[200:203], v[32:35]
    ds_read_b64_tr_b16 a[242:243], v163 offset:9216
    s_waitcnt lgkmcnt(8)
    v_mfma_f32_16x16x32_bf16 v[48:51], a[192:195], a[200:203], v[48:51]
    ds_read_b128 a[224:227], v159 offset:2048
    v_mfma_f32_16x16x32_bf16 v[52:55], a[192:195], a[204:207], v[52:55]
    ds_read_b64_tr_b16 a[244:245], v164 offset:8192
    ds_read_b64_tr_b16 a[246:247], v164 offset:9216
    s_add_u32 m0, s55, 68672
    s_mov_b32 s47, 46080
    buffer_load_dwordx4 v174, s[12:15], s47 offen offset:0 lds
    v_mfma_f32_16x16x32_bf16 v[56:59], a[192:195], a[208:211], v[56:59]
    ds_read_b128 a[228:231], v159 offset:4096
    s_waitcnt vmcnt(16)
    v_min3_u32 v195, v198, v199, v128
    v_mfma_f32_16x16x32_bf16 v[40:43], a[188:191], a[208:211], v[40:43]
    ds_read_b64_tr_b16 a[248:249], v165 offset:8192
    s_waitcnt vmcnt(14)
    v_min3_u32 v195, v195, v130, v132
    v_mfma_f32_16x16x32_bf16 v[24:27], a[184:187], a[208:211], v[24:27]
    ds_read_b64_tr_b16 a[250:251], v165 offset:9216
    s_waitcnt vmcnt(13)
    v_min3_u32 v195, v195, v134, v134
    s_waitcnt lgkmcnt(12)
    v_mfma_f32_16x16x32_bf16 v[28:31], a[184:187], a[212:215], v[28:31]
    ds_read_b128 a[232:235], v159 offset:6144
    v_cmp_gt_u32 vcc, 1, v195
    v_mfma_f32_16x16x32_bf16 v[44:47], a[188:191], a[212:215], v[44:47]
    buffer_load_dwordx4 v178, s[12:15], s47 offen offset:1008 lds
    s_cbranch_vccz L_ok_34
    s_mov_b32 s43, 0
L_spin_35:
    s_sleep 4
    buffer_load_dwordx2 v[198:199], v186, s[28:31], 0 offen sc1
    buffer_load_dword v128, v187, s[28:31], 0 offen offset:0 sc1
    buffer_load_dword v130, v187, s[28:31], 0 offen offset:64 sc1
    buffer_load_dword v132, v187, s[28:31], 0 offen offset:128 sc1
    buffer_load_dword v134, v187, s[28:31], 0 offen offset:192 sc1
    s_add_u32 s43, s43, 1
    s_cmp_ge_u32 s43, 20000
    s_waitcnt vmcnt(0)
    s_cbranch_scc1 L_ok_34
    v_min3_u32 v195, v198, v199, v128
    v_min3_u32 v195, v195, v130, v132
    v_min3_u32 v195, v195, v134, v134
    v_cmp_gt_u32 vcc, 1, v195
    s_nop 1
    s_cbranch_vccnz L_spin_35
L_ok_34:
    v_mfma_f32_16x16x32_bf16 v[60:63], a[192:195], a[212:215], v[60:63]
    s_waitcnt lgkmcnt(12)
    v_mfma_f32_16x16x32_bf16 v[76:79], a[196:199], a[212:215], v[76:79]
    v_mfma_f32_16x16x32_bf16 v[72:75], a[196:199], a[208:211], v[72:75]
    v_mfma_f32_16x16x32_bf16 v[68:71], a[196:199], a[204:207], v[68:71]
    v_mfma_f32_16x16x32_bf16 v[64:67], a[196:199], a[200:203], v[64:67]
    s_waitcnt lgkmcnt(0)
    s_barrier
    v_mfma_f32_16x16x32_bf16 v[16:19], a[220:223], a[236:239], v[16:19]
    ds_write_b64 v172, v[198:199]
    ds_read_b128 v[96:99], v173 offset:0
    ds_read_b128 v[112:115], v173 offset:64
    s_add_u32 m0, s55, 0
    s_mov_b32 s47, 51200
    buffer_load_dwordx4 v174, s[12:15], s47 offen offset:0 lds
    v_mfma_f32_16x16x32_bf16 v[20:23], a[220:223], a[240:243], v[20:23]
    ds_read_b128 v[100:103], v173 offset:128
    ds_read_b128 v[116:119], v173 offset:192
    v_mfma_f32_16x16x32_bf16 v[24:27], a[220:223], a[244:247], v[24:27]
    ds_read_b128 v[104:107], v173 offset:256
    ds_read_b128 v[120:123], v173 offset:320
    v_mfma_f32_16x16x32_bf16 v[28:31], a[220:223], a[248:251], v[28:31]
    ds_read_b128 v[108:111], v173 offset:384
    ds_read_b128 v[124:127], v173 offset:448
    v_mfma_f32_16x16x32_bf16 v[32:35], a[224:227], a[236:239], v[32:35]
    s_waitcnt vmcnt(1)
    ds_read_b64_tr_b16 a[0:1], v236 offset:56576
    s_nop 0
    buffer_load_dwordx4 v175, s[12:15], s47 offen offset:1008 lds
    v_mfma_f32_16x16x32_bf16 v[36:39], a[224:227], a[240:243], v[36:39]
    ds_read_b64_tr_b16 a[2:3], v236 offset:57248
    ds_read_b64_tr_b16 a[4:5], v236 offset:56640
    ds_read_b64_tr_b16 a[6:7], v236 offset:57312
    v_mfma_f32_16x16x32_bf16 v[40:43], a[224:227], a[244:247], v[40:43]
    ds_read_b64_tr_b16 a[8:9], v236 offset:56704
    ds_read_b64_tr_b16 a[10:11], v236 offset:57376
    v_mfma_f32_16x16x32_bf16 v[44:47], a[224:227], a[248:251], v[44:47]
    ds_read_b64_tr_b16 a[12:13], v236 offset:56768
    ds_read_b64_tr_b16 a[14:15], v236 offset:57440
    v_mfma_f32_16x16x32_bf16 v[48:51], a[228:231], a[236:239], v[48:51]
    ds_read_b64_tr_b16 a[16:17], v236 offset:56832
    ds_read_b64_tr_b16 a[18:19], v236 offset:57504
    buffer_load_dwordx4 v176, s[12:15], s47 offen offset:2016 lds
    v_mfma_f32_16x16x32_bf16 v[52:55], a[228:231], a[240:243], v[52:55]
    ds_read_b64_tr_b16 a[20:21], v236 offset:63296
    ds_read_b64_tr_b16 a[22:23], v236 offset:63968
    v_mfma_f32_16x16x32_bf16 v[56:59], a[228:231], a[244:247], v[56:59]
    ds_read_b64_tr_b16 a[24:25], v236 offset:63360
    ds_read_b64_tr_b16 a[26:27], v236 offset:64032
    ds_read_b64_tr_b16 a[28:29], v236 offset:63424
    v_mfma_f32_16x16x32_bf16 v[60:63], a[228:231], a[248:251], v[60:63]
    ds_read_b64_tr_b16 a[30:31], v236 offset:64096
    ds_read_b64_tr_b16 a[32:33], v236 offset:63488
    v_mfma_f32_16x16x32_bf16 v[64:67], a[232:235], a[236:239], v[64:67]
    ds_read_b64_tr_b16 a[34:35], v236 offset:64160
    ds_read_b64_tr_b16 a[36:37], v236 offset:63552
    buffer_load_dwordx4 v177, s[12:15], s47 offen offset:3024 lds
    v_mfma_f32_16x16x32_bf16 v[68:71], a[232:235], a[240:243], v[68:71]
    ds_read_b64_tr_b16 a[38:39], v236 offset:64224
    ds_read_b64_tr_b16 a[160:161], v237 offset:56576
    v_mfma_f32_16x16x32_bf16 v[72:75], a[232:235], a[244:247], v[72:75]
    ds_read_b64_tr_b16 a[164:165], v237 offset:56640
    ds_read_b64_tr_b16 a[168:169], v237 offset:56704
    v_mfma_f32_16x16x32_bf16 v[76:79], a[232:235], a[248:251], v[76:79]
    ds_read_b64_tr_b16 a[172:173], v237 offset:56768
    ds_read_b64_tr_b16 a[176:177], v237 offset:56832
    s_waitcnt lgkmcnt(14)
    v_pk_fma_f32 v[16:17], v[96:97], v[128:129], v[16:17] op_sel_hi:[1,0,1]
    s_nop 0
    v_pk_fma_f32 v[18:19], v[98:99], v[128:129], v[18:19] op_sel_hi:[1,0,1]
    v_pk_fma_f32 v[32:33], v[100:101], v[128:129], v[32:33] op_sel_hi:[1,0,1]
    v_pk_fma_f32 v[34:35], v[102:103], v[128:129], v[34:35] op_sel_hi:[1,0,1]
    v_pk_fma_f32 v[16:17], v[16:17], v[112:113], v[138:139]
    v_pk_fma_f32 v[18:19], v[18:19], v[114:115], v[138:139]
    v_pk_fma_f32 v[32:33], v[32:33], v[116:117], v[138:139]
    v_pk_fma_f32 v[34:35], v[34:35], v[118:119], v[138:139]
    v_pk_fma_f32 v[200:201], v[16:17], s[62:63], v[140:141]
    v_pk_fma_f32 v[202:203], v[18:19], s[62:63], v[140:141]
    v_pk_fma_f32 v[204:205], v[32:33], s[62:63], v[140:141]
    v_pk_fma_f32 v[206:207], v[34:35], s[62:63], v[140:141]
    v_exp_f32 v200, v200 clamp
    v_exp_f32 v201, v201 clamp
    v_exp_f32 v202, v202 clamp
    v_exp_f32 v203, v203 clamp
    v_exp_f32 v204, v204 clamp
    v_exp_f32 v205, v205 clamp
    v_exp_f32 v206, v206 clamp
    v_exp_f32 v207, v207 clamp
    v_max_f32_e64 v16, v138, v16
    s_add_u32 m0, s55, 4032
    s_mov_b32 s47, 66560
    buffer_load_dwordx4 v174, s[12:15], s47 offen offset:0 lds
    v_max_f32 v17, v138, v17
    v_max_f32 v18, v138, v18
    v_max_f32 v19, v138, v19
    v_max_f32 v32, v138, v32
    v_max_f32 v33, v138, v33
    v_max_f32 v34, v138, v34
    v_max_f32_e64 v35, v138, v35
    v_pk_add_f32 v[16:17], v[16:17], v[200:201]
    v_pk_add_f32 v[18:19], v[18:19], v[202:203]
    v_pk_add_f32 v[32:33], v[32:33], v[204:205]
    v_pk_add_f32 v[34:35], v[34:35], v[206:207]
    v_cvt_pk_bf16_f32 v212, v16, v17
    v_cvt_pk_bf16_f32 v213, v18, v19
    v_cvt_pk_bf16_f32 v214, v32, v33
    v_cvt_pk_bf16_f32 v215, v34, v35
    buffer_store_dwordx4 v[212:215], v180, s[28:31], s64 offen sc1
    v_pk_fma_f32 v[20:21], v[96:97], v[130:131], v[20:21] op_sel_hi:[1,0,1]
    buffer_load_dwordx4 v175, s[12:15], s47 offen offset:1008 lds
    v_pk_fma_f32 v[22:23], v[98:99], v[130:131], v[22:23] op_sel_hi:[1,0,1]
    v_pk_fma_f32 v[36:37], v[100:101], v[130:131], v[36:37] op_sel_hi:[1,0,1]
    v_pk_fma_f32 v[38:39], v[102:103], v[130:131], v[38:39] op_sel_hi:[1,0,1]
    v_pk_fma_f32 v[20:21], v[20:21], v[112:113], v[138:139]
    v_pk_fma_f32 v[22:23], v[22:23], v[114:115], v[138:139]
    v_pk_fma_f32 v[36:37], v[36:37], v[116:117], v[138:139]
    v_pk_fma_f32 v[38:39], v[38:39], v[118:119], v[138:139]
    v_pk_fma_f32 v[200:201], v[20:21], s[62:63], v[140:141]
    v_pk_fma_f32 v[202:203], v[22:23], s[62:63], v[140:141]
    v_pk_fma_f32 v[204:205], v[36:37], s[62:63], v[140:141]
    v_pk_fma_f32 v[206:207], v[38:39], s[62:63], v[140:141]
    v_exp_f32 v200, v200 clamp
    v_exp_f32 v201, v201 clamp
    v_exp_f32 v202, v202 clamp
    v_exp_f32 v203, v203 clamp
    v_exp_f32 v204, v204 clamp
    v_exp_f32 v205, v205 clamp
    v_exp_f32 v206, v206 clamp
    buffer_load_dwordx4 v176, s[12:15], s47 offen offset:2016 lds
    v_exp_f32 v207, v207 clamp
    v_max_f32 v20, v138, v20
    v_max_f32 v21, v138, v21
    v_max_f32 v22, v138, v22
    v_max_f32 v23, v138, v23
    v_max_f32 v36, v138, v36
    v_max_f32 v37, v138, v37
    v_max_f32 v38, v138, v38
    v_max_f32 v39, v138, v39
    v_pk_add_f32 v[20:21], v[20:21], v[200:201]
    v_pk_add_f32 v[22:23], v[22:23], v[202:203]
    v_pk_add_f32 v[36:37], v[36:37], v[204:205]
    v_pk_add_f32 v[38:39], v[38:39], v[206:207]
    v_cvt_pk_bf16_f32 v216, v20, v21
    v_cvt_pk_bf16_f32 v217, v22, v23
    v_cvt_pk_bf16_f32 v218, v36, v37
    v_cvt_pk_bf16_f32 v219, v38, v39
    buffer_load_dwordx4 v177, s[12:15], s47 offen offset:3024 lds
    buffer_store_dwordx4 v[216:219], v180, s[28:31], s65 offen sc1
    v_pk_fma_f32 v[24:25], v[96:97], v[132:133], v[24:25] op_sel_hi:[1,0,1]
    v_pk_fma_f32 v[26:27], v[98:99], v[132:133], v[26:27] op_sel_hi:[1,0,1]
    v_pk_fma_f32 v[40:41], v[100:101], v[132:133], v[40:41] op_sel_hi:[1,0,1]
    v_pk_fma_f32 v[42:43], v[102:103], v[132:133], v[42:43] op_sel_hi:[1,0,1]
    v_pk_fma_f32 v[24:25], v[24:25], v[112:113], v[138:139]
    v_pk_fma_f32 v[26:27], v[26:27], v[114:115], v[138:139]
    v_pk_fma_f32 v[40:41], v[40:41], v[116:117], v[138:139]
    v_pk_fma_f32 v[42:43], v[42:43], v[118:119], v[138:139]
    v_pk_fma_f32 v[200:201], v[24:25], s[62:63], v[140:141]
    v_pk_fma_f32 v[202:203], v[26:27], s[62:63], v[140:141]
    v_pk_fma_f32 v[204:205], v[40:41], s[62:63], v[140:141]
    v_pk_fma_f32 v[206:207], v[42:43], s[62:63], v[140:141]
    v_exp_f32 v200, v200 clamp
    v_exp_f32 v201, v201 clamp
    v_exp_f32 v202, v202 clamp
    v_exp_f32 v203, v203 clamp
    v_exp_f32 v204, v204 clamp
    s_add_u32 m0, s55, 8064
    s_mov_b32 s47, 81920
    buffer_load_dwordx4 v174, s[12:15], s47 offen offset:0 lds
    v_exp_f32 v205, v205 clamp
    v_exp_f32 v206, v206 clamp
    v_exp_f32 v207, v207 clamp
    v_max_f32 v24, v138, v24
    v_max_f32 v25, v138, v25
    v_max_f32 v26, v138, v26
    v_max_f32 v27, v138, v27
    v_max_f32 v40, v138, v40
    v_max_f32 v41, v138, v41
    v_max_f32 v42, v138, v42
    v_max_f32 v43, v138, v43
    v_pk_add_f32 v[24:25], v[24:25], v[200:201]
    v_pk_add_f32 v[26:27], v[26:27], v[202:203]
    v_pk_add_f32 v[40:41], v[40:41], v[204:205]
    v_pk_add_f32 v[42:43], v[42:43], v[206:207]
    v_cvt_pk_bf16_f32 v220, v24, v25
    v_cvt_pk_bf16_f32 v221, v26, v27
    buffer_load_dwordx4 v175, s[12:15], s47 offen offset:1008 lds
    v_cvt_pk_bf16_f32 v222, v40, v41
    v_cvt_pk_bf16_f32 v223, v42, v43
    buffer_store_dwordx4 v[220:223], v180, s[28:31], s66 offen sc1
    v_pk_fma_f32 v[28:29], v[96:97], v[134:135], v[28:29] op_sel_hi:[1,0,1]
    v_pk_fma_f32 v[30:31], v[98:99], v[134:135], v[30:31] op_sel_hi:[1,0,1]
    v_pk_fma_f32 v[44:45], v[100:101], v[134:135], v[44:45] op_sel_hi:[1,0,1]
    v_pk_fma_f32 v[46:47], v[102:103], v[134:135], v[46:47] op_sel_hi:[1,0,1]
    v_pk_fma_f32 v[28:29], v[28:29], v[112:113], v[138:139]
    v_pk_fma_f32 v[30:31], v[30:31], v[114:115], v[138:139]
    v_pk_fma_f32 v[44:45], v[44:45], v[116:117], v[138:139]
    v_pk_fma_f32 v[46:47], v[46:47], v[118:119], v[138:139]
    v_pk_fma_f32 v[200:201], v[28:29], s[62:63], v[140:141]
    v_pk_fma_f32 v[202:203], v[30:31], s[62:63], v[140:141]
    v_pk_fma_f32 v[204:205], v[44:45], s[62:63], v[140:141]
    v_pk_fma_f32 v[206:207], v[46:47], s[62:63], v[140:141]
    v_exp_f32 v200, v200 clamp
    v_exp_f32 v201, v201 clamp
    v_exp_f32 v202, v202 clamp
    buffer_load_dwordx4 v176, s[12:15], s47 offen offset:2016 lds
    v_exp_f32 v203, v203 clamp
    v_exp_f32 v204, v204 clamp
    v_exp_f32 v205, v205 clamp
    v_exp_f32 v206, v206 clamp
    v_exp_f32 v207, v207 clamp
    v_max_f32 v28, v138, v28
    v_max_f32 v29, v138, v29
    v_max_f32 v30, v138, v30
    v_max_f32 v31, v138, v31
    v_max_f32 v44, v138, v44
    v_max_f32 v45, v138, v45
    v_max_f32 v46, v138, v46
    v_max_f32 v47, v138, v47
    v_pk_add_f32 v[28:29], v[28:29], v[200:201]
    v_pk_add_f32 v[30:31], v[30:31], v[202:203]
    v_pk_add_f32 v[44:45], v[44:45], v[204:205]
    v_pk_add_f32 v[46:47], v[46:47], v[206:207]
    v_cvt_pk_bf16_f32 v224, v28, v29
    buffer_load_dwordx4 v177, s[12:15], s47 offen offset:3024 lds
    v_cvt_pk_bf16_f32 v225, v30, v31
    v_cvt_pk_bf16_f32 v226, v44, v45
    v_cvt_pk_bf16_f32 v227, v46, v47
    buffer_store_dwordx4 v[224:227], v180, s[28:31], s67 offen sc1
    v_pk_fma_f32 v[48:49], v[104:105], v[128:129], v[48:49] op_sel_hi:[1,0,1]
    v_pk_fma_f32 v[50:51], v[106:107], v[128:129], v[50:51] op_sel_hi:[1,0,1]
    v_pk_fma_f32 v[64:65], v[108:109], v[128:129], v[64:65] op_sel_hi:[1,0,1]
    v_pk_fma_f32 v[66:67], v[110:111], v[128:129], v[66:67] op_sel_hi:[1,0,1]
    v_pk_fma_f32 v[48:49], v[48:49], v[120:121], v[138:139]
    v_pk_fma_f32 v[50:51], v[50:51], v[122:123], v[138:139]
    v_pk_fma_f32 v[64:65], v[64:65], v[124:125], v[138:139]
    v_pk_fma_f32 v[66:67], v[66:67], v[126:127], v[138:139]
    v_pk_fma_f32 v[200:201], v[48:49], s[62:63], v[140:141]
    v_pk_fma_f32 v[202:203], v[50:51], s[62:63], v[140:141]
    v_pk_fma_f32 v[204:205], v[64:65], s[62:63], v[140:141]
    v_pk_fma_f32 v[206:207], v[66:67], s[62:63], v[140:141]
    v_exp_f32 v200, v200 clamp
    s_add_u32 m0, s55, 12096
    s_mov_b32 s47, 97280
    buffer_load_dwordx4 v174, s[12:15], s47 offen offset:0 lds
    v_exp_f32 v201, v201 clamp
    v_exp_f32 v202, v202 clamp
    v_exp_f32 v203, v203 clamp
    v_exp_f32 v204, v204 clamp
    v_exp_f32 v205, v205 clamp
    v_exp_f32 v206, v206 clamp
    v_exp_f32 v207, v207 clamp
    v_max_f32 v48, v138, v48
    v_max_f32 v49, v138, v49
    v_max_f32 v50, v138, v50
    v_max_f32 v51, v138, v51
    v_max_f32 v64, v138, v64
    v_max_f32 v65, v138, v65
    v_max_f32 v66, v138, v66
    v_max_f32 v67, v138, v67
    v_pk_add_f32 v[48:49], v[48:49], v[200:201]
    v_pk_add_f32 v[50:51], v[50:51], v[202:203]
    v_pk_add_f32 v[64:65], v[64:65], v[204:205]
    buffer_load_dwordx4 v178, s[12:15], s47 offen offset:1008 lds
    v_pk_add_f32 v[66:67], v[66:67], v[206:207]
    v_cvt_pk_bf16_f32 v212, v48, v49
    v_cvt_pk_bf16_f32 v213, v50, v51
    v_cvt_pk_bf16_f32 v214, v64, v65
    v_cvt_pk_bf16_f32 v215, v66, v67
    buffer_store_dwordx4 v[212:215], v181, s[28:31], s64 offen sc1
    v_pk_fma_f32 v[52:53], v[104:105], v[130:131], v[52:53] op_sel_hi:[1,0,1]
    v_pk_fma_f32 v[54:55], v[106:107], v[130:131], v[54:55] op_sel_hi:[1,0,1]
    v_pk_fma_f32 v[68:69], v[108:109], v[130:131], v[68:69] op_sel_hi:[1,0,1]
    v_pk_fma_f32 v[70:71], v[110:111], v[130:131], v[70:71] op_sel_hi:[1,0,1]
    v_pk_fma_f32 v[52:53], v[52:53], v[120:121], v[138:139]
    v_pk_fma_f32 v[54:55], v[54:55], v[122:123], v[138:139]
    v_pk_fma_f32 v[68:69], v[68:69], v[124:125], v[138:139]
    v_pk_fma_f32 v[70:71], v[70:71], v[126:127], v[138:139]
    v_pk_fma_f32 v[200:201], v[52:53], s[62:63], v[140:141]
    v_pk_fma_f32 v[202:203], v[54:55], s[62:63], v[140:141]
    v_pk_fma_f32 v[204:205], v[68:69], s[62:63], v[140:141]
    s_waitcnt lgkmcnt(0)
    s_add_u32 m0, s55, 56576
    s_mov_b32 s47, 102400
    buffer_load_dwordx4 v174, s[12:15], s47 offen offset:0 lds
    s_nop 0
    v_pk_fma_f32 v[206:207], v[70:71], s[62:63], v[140:141]
    v_exp_f32 v200, v200 clamp
    v_exp_f32 v201, v201 clamp
    v_exp_f32 v202, v202 clamp
    v_exp_f32 v203, v203 clamp
    v_exp_f32 v204, v204 clamp
    v_exp_f32 v205, v205 clamp
    v_exp_f32 v206, v206 clamp
    v_exp_f32 v207, v207 clamp
    v_max_f32 v52, v138, v52
    v_max_f32 v53, v138, v53
    v_max_f32 v54, v138, v54
    v_max_f32 v55, v138, v55
    v_max_f32 v68, v138, v68
    v_max_f32 v69, v138, v69
    v_max_f32 v70, v138, v70
    v_max_f32 v71, v138, v71
    v_pk_add_f32 v[52:53], v[52:53], v[200:201]
    buffer_load_dwordx4 v175, s[12:15], s47 offen offset:1008 lds
    v_pk_add_f32 v[54:55], v[54:55], v[202:203]
    v_pk_add_f32 v[68:69], v[68:69], v[204:205]
    v_pk_add_f32 v[70:71], v[70:71], v[206:207]
    v_cvt_pk_bf16_f32 v216, v52, v53
    v_cvt_pk_bf16_f32 v217, v54, v55
    v_cvt_pk_bf16_f32 v218, v68, v69
    v_cvt_pk_bf16_f32 v219, v70, v71
    buffer_store_dwordx4 v[216:219], v181, s[28:31], s65 offen sc1
    v_pk_fma_f32 v[56:57], v[104:105], v[132:133], v[56:57] op_sel_hi:[1,0,1]
L_pg7:
    s_cbranch_execz L_ret
    v_pk_fma_f32 v[58:59], v[106:107], v[132:133], v[58:59] op_sel_hi:[1,0,1]
    v_pk_fma_f32 v[72:73], v[108:109], v[132:133], v[72:73] op_sel_hi:[1,0,1]
    v_pk_fma_f32 v[74:75], v[110:111], v[132:133], v[74:75] op_sel_hi:[1,0,1]
    s_nop 0
    v_pk_fma_f32 v[56:57], v[56:57], v[120:121], v[138:139]
    v_pk_fma_f32 v[58:59], v[58:59], v[122:123], v[138:139]
    v_pk_fma_f32 v[72:73], v[72:73], v[124:125], v[138:139]
    v_pk_fma_f32 v[74:75], v[74:75], v[126:127], v[138:139]
    v_pk_fma_f32 v[200:201], v[56:57], s[62:63], v[140:141]
    buffer_load_dwordx4 v176, s[12:15], s47 offen offset:2016 lds
    v_pk_fma_f32 v[202:203], v[58:59], s[62:63], v[140:141]
    v_pk_fma_f32 v[204:205], v[72:73], s[62:63], v[140:141]
    v_pk_fma_f32 v[206:207], v[74:75], s[62:63], v[140:141]
    v_exp_f32 v200, v200 clamp
    v_exp_f32 v201, v201 clamp
    v_exp_f32 v202, v202 clamp
    v_exp_f32 v203, v203 clamp
    v_exp_f32 v204, v204 clamp
    v_exp_f32 v205, v205 clamp
    v_exp_f32 v206, v206 clamp
    v_exp_f32 v207, v207 clamp
    v_max_f32 v56, v138, v56
    v_max_f32 v57, v138, v57
    v_max_f32 v58, v138, v58
    v_max_f32 v59, v138, v59
    v_max_f32 v72, v138, v72
    v_max_f32 v73, v138, v73
    v_max_f32 v74, v138, v74
    buffer_load_dwordx4 v177, s[12:15], s47 offen offset:3024 lds
    v_max_f32 v75, v138, v75
    v_pk_add_f32 v[56:57], v[56:57], v[200:201]
    v_pk_add_f32 v[58:59], v[58:59], v[202:203]
    v_pk_add_f32 v[72:73], v[72:73], v[204:205]
    v_pk_add_f32 v[74:75], v[74:75], v[206:207]
    v_cvt_pk_bf16_f32 v220, v56, v57
    v_cvt_pk_bf16_f32 v221, v58, v59
    v_cvt_pk_bf16_f32 v222, v72, v73
    v_cvt_pk_bf16_f32 v223, v74, v75
    buffer_store_dwordx4 v[220:223], v181, s[28:31], s66 offen sc1
    v_pk_fma_f32 v[60:61], v[104:105], v[134:135], v[60:61] op_sel_hi:[1,0,1]
    v_pk_fma_f32 v[62:63], v[106:107], v[134:135], v[62:63] op_sel_hi:[1,0,1]
    v_pk_fma_f32 v[76:77], v[108:109], v[134:135], v[76:77] op_sel_hi:[1,0,1]
    v_pk_fma_f32 v[78:79], v[110:111], v[134:135], v[78:79] op_sel_hi:[1,0,1]
    v_pk_fma_f32 v[60:61], v[60:61], v[120:121], v[138:139]
    v_pk_fma_f32 v[62:63], v[62:63], v[122:123], v[138:139]
    v_pk_fma_f32 v[76:77], v[76:77], v[124:125], v[138:139]
    v_pk_fma_f32 v[78:79], v[78:79], v[126:127], v[138:139]
    v_pk_fma_f32 v[200:201], v[60:61], s[62:63], v[140:141]
    v_pk_fma_f32 v[202:203], v[62:63], s[62:63], v[140:141]
    v_pk_fma_f32 v[204:205], v[76:77], s[62:63], v[140:141]
    v_pk_fma_f32 v[206:207], v[78:79], s[62:63], v[140:141]
    v_exp_f32 v200, v200 clamp
    v_exp_f32 v201, v201 clamp
    v_exp_f32 v202, v202 clamp
    v_exp_f32 v203, v203 clamp
    v_exp_f32 v204, v204 clamp
    v_exp_f32 v205, v205 clamp
    v_exp_f32 v206, v206 clamp
    v_exp_f32 v207, v207 clamp
    v_max_f32 v60, v138, v60
    v_max_f32 v61, v138, v61
    v_max_f32 v62, v138, v62
    v_max_f32 v63, v138, v63
    v_max_f32 v76, v138, v76
    v_max_f32 v77, v138, v77
    v_max_f32 v78, v138, v78
    v_max_f32 v79, v138, v79
    v_pk_add_f32 v[60:61], v[60:61], v[200:201]
    v_pk_add_f32 v[62:63], v[62:63], v[202:203]
    v_pk_add_f32 v[76:77], v[76:77], v[204:205]
    v_pk_add_f32 v[78:79], v[78:79], v[206:207]
    v_cvt_pk_bf16_f32 v224, v60, v61
    v_cvt_pk_bf16_f32 v225, v62, v63
    v_cvt_pk_bf16_f32 v226, v76, v77
    v_cvt_pk_bf16_f32 v227, v78, v79
    buffer_store_dwordx4 v[224:227], v181, s[28:31], s67 offen sc1
    s_waitcnt vmcnt(8)
    s_add_u32 m0, s55, 60608
    s_mov_b32 s47, 117760
    buffer_load_dwordx4 v174, s[12:15], s47 offen offset:0 lds
    s_nop 0
    ds_read_b64_tr_b16 a[40:41], v236 offset:0
    ds_read_b64_tr_b16 a[42:43], v236 offset:672
    ds_read_b64_tr_b16 a[44:45], v236 offset:64
    ds_read_b64_tr_b16 a[46:47], v236 offset:736
    ds_read_b64_tr_b16 a[48:49], v236 offset:128
    ds_read_b64_tr_b16 a[50:51], v236 offset:800
    ds_read_b64_tr_b16 a[52:53], v236 offset:192
    ds_read_b64_tr_b16 a[54:55], v236 offset:864
    ds_read_b64_tr_b16 a[56:57], v236 offset:256
    ds_read_b64_tr_b16 a[58:59], v236 offset:928
    ds_read_b64_tr_b16 a[60:61], v236 offset:6720
    ds_read_b64_tr_b16 a[62:63], v236 offset:7392
    ds_read_b64_tr_b16 a[64:65], v236 offset:6784
    ds_read_b64_tr_b16 a[66:67], v236 offset:7456
    ds_read_b64_tr_b16 a[68:69], v236 offset:6848
    ds_read_b64_tr_b16 a[70:71], v236 offset:7520
    ds_read_b64_tr_b16 a[72:73], v236 offset:6912
    ds_read_b64_tr_b16 a[74:75], v236 offset:7584
    ds_read_b64_tr_b16 a[76:77], v236 offset:6976
    ds_read_b64_tr_b16 a[78:79], v236 offset:7648
    ds_read_b64_tr_b16 a[162:163], v237 offset:0
    ds_read_b64_tr_b16 a[166:167], v237 offset:64
    ds_read_b64_tr_b16 a[170:171], v237 offset:128
    ds_read_b64_tr_b16 a[174:175], v237 offset:192
    ds_read_b64_tr_b16 a[178:179], v237 offset:256
    s_lshr_b32 s3, s68, 2
    s_mul_i32 s3, s3, 5
    s_add_u32 s3, s3, s38
    s_lshl_b32 s3, s3, 7
    buffer_load_dwordx4 v175, s[12:15], s47 offen offset:1008 lds
    s_add_u32 s44, s3, 16384
    v_and_b32 v8, 1, v0
    v_lshlrev_b32 v243, 7, v8
    v_and_b32 v8, 31, v0
    s_lshl_b32 s3, s68, 1
    s_add_u32 s45, s3, s41
    s_lshl_b32 s3, s45, 4
    v_lshrrev_b32 v9, 2, v0
    v_add_u32 v9, s3, v9
    v_mul_u32_u24 v9, 1280, v9
    v_lshl_add_u32 v112, v5, 4, v9
    s_mul_i32 s50, s69, 320
    s_lshl_b32 s3, s42, 8
    s_add_u32 s9, s50, s3
    s_lshl_b32 s3, s42, 7
    s_add_u32 s10, s50, s3
    s_add_u32 s10, s10, 64
    s_lshl_b32 s3, s42, 28
    s_add_u32 s11, s50, s3
    s_add_u32 s11, s11, 128
    v_lshlrev_b32 v11, 3, v3
    v_add_u32 v12, v11, v4
    v_lshlrev_b32 v12, 6, v12
    v_lshl_add_u32 v12, v6, 5, v12
    v_lshl_add_u32 v12, v5, 3, v12
    v_add_u32 v235, s55, v12
    v_sub_u32 v11, v8, v11
    v_and_b32 v12, 1, v11
    v_lshlrev_b32 v12, 4, v12
    v_lshlrev_b32_e64 v12, v12, v253
    buffer_load_dwordx4 v176, s[12:15], s47 offen offset:2016 lds
    v_mul_u32_u24 v12, 0x3f80, v12
    v_lshrrev_b32 v11, 1, v11
    v_mov_b32 v10, 1073741824
    v_cmp_eq_u32 vcc, 0, v11
    v_cmp_eq_u32 s[60:61], 1, v11
    v_mov_b32 v226, 0
    v_cndmask_b32 v13, 0, v12, vcc
    v_cndmask_b32 v14, 0, v12, s[60:61]
    v_accvgpr_write_b32 a252, v13
    v_accvgpr_write_b32 a253, v14
    v_cmp_eq_u32 vcc, 2, v11
    v_cmp_eq_u32 s[60:61], 3, v11
    v_mov_b32 v227, 0
    v_cndmask_b32 v13, 0, v12, vcc
    v_cndmask_b32 v14, 0, v12, s[60:61]
    v_accvgpr_write_b32 a254, v13
    v_accvgpr_write_b32 a255, v14
    v_lshlrev_b32 v11, 4, v8
    v_lshl_add_u32 v12, v3, 9, v11
    v_add_u32 v11, 1024, v11
    v_cmp_eq_u32 vcc, 2, v5
    v_bfe_u32 v13, v8, 2, 1
    v_and_b32 v14, 1, v8
    v_lshl_add_u32 v13, v13, 1, v14
    v_cndmask_b32 v13, v13, 4, vcc
    v_cmp_eq_u32 vcc, 3, v5
    v_lshlrev_b32 v13, 7, v13
    v_add_u32 v13, 1280, v13
    v_cndmask_b32 v13, v13, v10, vcc
    buffer_load_dwordx4 v177, s[12:15], s47 offen offset:3024 lds
    v_cmp_le_u32 vcc, 24, v8
    s_lshl_b32 s3, s68, 2
    s_add_u32 s52, s3, s69
    v_cndmask_b32 v13, v13, v10, vcc
    v_cmp_gt_u32 vcc, 16, v8
    v_lshl_add_u32 v14, v3, 5, v13
    v_add_u32_e64 v13, 64, v13
    v_cndmask_b32 v238, v14, v12, vcc
    v_add_u32 v12, 256, v12
    v_add_u32_e64 v14, 16, v14
    v_cndmask_b32 v239, v14, v12, vcc
    v_cndmask_b32 v11, v13, v11, vcc
    v_cmp_eq_u32 vcc, 0, v3
    s_add_u32 s3, s3, s38
    s_mul_i32 s3, s3, 10240
    v_cndmask_b32 v240, v10, v11, vcc
    v_cndmask_b32 v241, v11, v10, vcc
    s_add_u32 s54, s3, 1048576
    s_mul_i32 s8, s38, 10240
    s_lshl_b32 s52, s52, 7
    s_add_u32 s52, s52, 32768
    s_mul_i32 s62, s41, 5
    s_lshl_b32 s3, s42, 2
    s_sub_u32 s63, 5, s62
    s_add_u32 s62, s62, s3
    s_add_u32 s63, s63, s3
    s_mul_i32 s62, s62, 6144
    s_mul_i32 s63, s63, 6144
    s_add_u32 s62, s62, 98304
    s_waitcnt vmcnt(4)
    s_barrier
    buffer_store_dword v253, v252, s[28:31], s46 offen sc1
    s_add_u32 s63, s63, 98304
    s_add_u32 m0, s55, 64640
    s_mov_b32 s47, 133120
    buffer_load_dwordx4 v174, s[12:15], s47 offen offset:0 lds
    s_mul_i32 s0, s42, -12288
    s_add_u32 s0, s0, 6144
    s_lshl_b32 s1, s42, 11
    s_mul_i32 s50, s69, 5
    buffer_load_dwordx4 v175, s[12:15], s47 offen offset:1008 lds
    s_lshl_b32 s50, s50, 7
    s_add_u32 s50, s50, s45
    s_lshl_b32 s50, s50, 10
    s_add_u32 s50, s50, 5242880
    buffer_load_dwordx4 v176, s[12:15], s47 offen offset:2016 lds
    s_lshl_b32 s3, s42, 19
    s_add_u32 s48, s50, s3
    s_lshl_b32 s3, s42, 18
    s_add_u32 s49, s50, s3
    buffer_load_dwordx4 v177, s[12:15], s47 offen offset:3024 lds
    s_add_u32 s49, s49, 131072
    s_lshl_b32 s3, s42, 30
    s_add_u32 s50, s50, s3
    s_add_u32 s50, s50, 262144
    s_add_u32 m0, s55, 68672
    s_mov_b32 s47, 148480
    buffer_load_dwordx4 v174, s[12:15], s47 offen offset:0 lds
    s_sub_u32 s60, 0, s42
    s_mov_b32 s61, s60
    v_and_b32 v8, 1, v0
    v_lshl_add_u32 v8, v4, 1, v8
    buffer_load_dwordx4 v178, s[12:15], s47 offen offset:1008 lds
    v_lshlrev_b32 v8, 2, v8
    v_lshl_add_u32 v8, v2, 5, v8
    v_cndmask_b32 v15, v8, v10, s[58:59]
    s_lshl_b32 s51, s45, 10
    s_waitcnt lgkmcnt(0)
    s_add_u32 m0, s55, 0
    s_mov_b32 s47, 153600
    buffer_load_dwordx4 v174, s[12:15], s47 offen offset:0 lds
    s_add_u32 s51, s51, 196608
    s_lshl_b32 s3, s69, 1
    s_add_u32 s3, s3, s42
    s_lshl_b32 s3, s3, 7
    buffer_load_dwordx4 v175, s[12:15], s47 offen offset:1008 lds
    s_add_u32 s53, s51, s3
    v_mul_u32_u24 v11, 2560, v5
    v_xor_b32 v12, s41, v6
    v_lshl_add_u32 v11, v12, 3, v11
    buffer_load_dwordx4 v176, s[12:15], s47 offen offset:2016 lds
    v_lshl_add_u32 v11, v4, 4, v11
    v_add_u32 v11, s8, v11
    v_lshl_add_u32 v12, v3, 7, v11
    v_mul_u32_u24 v13, 640, v3
    buffer_load_dwordx4 v177, s[12:15], s47 offen offset:3024 lds
    v_add_u32 v13, v13, v11
    s_mul_i32 s67, s40, 52
    s_lshr_b32 s67, s67, 8
    s_mul_i32 s3, s67, 5
    s_add_u32 m0, s55, 4032
    s_mov_b32 s47, 168960
    buffer_load_dwordx4 v174, s[12:15], s47 offen offset:0 lds
    s_sub_u32 s66, s40, s3
    s_and_b32 s3, s39, 1
    s_mul_i32 s3, s3, 5
    s_add_u32 s66, s66, s3
    buffer_load_dwordx4 v175, s[12:15], s47 offen offset:1008 lds
    s_lshr_b32 s3, s39, 1
    s_mul_i32 s3, s3, 6
    s_add_u32 s67, s67, s3
    s_mul_i32 s64, s38, 24576
    buffer_load_dwordx4 v176, s[12:15], s47 offen offset:2016 lds
    s_and_b32 s65, s38, 2
    v_lshlrev_b32 v9, 1, v2
    v_and_b32 v8, 7, v0
    v_xor_b32 v8, v8, v9
    buffer_load_dwordx4 v177, s[12:15], s47 offen offset:3024 lds
    v_lshrrev_b32 v9, 3, v0
    v_mul_u32_u24 v9, 3072, v9
    v_lshl_add_u32 v8, v8, 4, v9
    s_mul_i32 s3, s38, 12288
    s_add_u32 m0, s55, 8064
    s_mov_b32 s47, 184320
    buffer_load_dwordx4 v174, s[12:15], s47 offen offset:0 lds
    s_add_u32 s3, s3, s67
    s_lshl_b32 s3, s3, 7
    v_add_u32_e64 v244, s3, v8
    v_add_u32 v245, 23552, v244
    buffer_load_dwordx4 v175, s[12:15], s47 offen offset:1008 lds
    v_add_u32 v246, 47104, v244
    v_add_u32 v247, 70656, v244
    v_lshl_add_u32 v8, v6, 2, v4
    v_lshrrev_b32_e64 v9, 1, v8
    buffer_load_dwordx4 v176, s[12:15], s47 offen offset:2016 lds
    v_lshl_add_u32 v8, v3, 4, v8
    v_lshlrev_b32 v8, 7, v8
    v_lshl_add_u32 v8, v5, 3, v8
    v_xor_b32 v9, s65, v9
    buffer_load_dword v242, v243, s[28:31], s44 offen sc1
    v_lshl_add_u32 v8, v9, 5, v8
    v_add_u32 v248, s64, v8
    v_xor_b32 v249, 32, v248
    v_xor_b32_e64 v250, 64, v248
    buffer_load_dwordx4 v177, s[12:15], s47 offen offset:3024 lds
    v_xor_b32 v251, 96, v248
    s_waitcnt vmcnt(13)
    ds_read_b64_tr_b16 a[80:81], v236 offset:56576
    s_nop 0
    ds_read_b64_tr_b16 a[82:83], v236 offset:57248
    s_add_u32 m0, s55, 12096
    s_mov_b32 s47, 199680
    buffer_load_dwordx4 v174, s[12:15], s47 offen offset:0 lds
    ds_read_b64_tr_b16 a[84:85], v236 offset:56640
    ds_read_b64_tr_b16 a[86:87], v236 offset:57312
    ds_read_b64_tr_b16 a[88:89], v236 offset:56704
    ds_read_b64_tr_b16 a[90:91], v236 offset:57376
    buffer_load_dwordx4 v178, s[12:15], s47 offen offset:1008 lds
    ds_read_b64_tr_b16 a[92:93], v236 offset:56768
    ds_read_b64_tr_b16 a[94:95], v236 offset:57440
    ds_read_b64_tr_b16 a[96:97], v236 offset:56832
    ds_read_b64_tr_b16 a[98:99], v236 offset:57504
    ds_read_b64_tr_b16 a[100:101], v236 offset:63296
    ds_read_b64_tr_b16 a[102:103], v236 offset:63968
    ds_read_b64_tr_b16 a[104:105], v236 offset:63360
    ds_read_b64_tr_b16 a[106:107], v236 offset:64032
    ds_read_b64_tr_b16 a[108:109], v236 offset:63424
    ds_read_b64_tr_b16 a[110:111], v236 offset:64096
    ds_read_b64_tr_b16 a[112:113], v236 offset:63488
    ds_read_b64_tr_b16 a[114:115], v236 offset:64160
    ds_read_b64_tr_b16 a[116:117], v236 offset:63552
    ds_read_b64_tr_b16 a[118:119], v236 offset:64224
    ds_read_b64_tr_b16 a[180:181], v237 offset:56576
    ds_read_b64_tr_b16 a[184:185], v237 offset:56640
    ds_read_b64_tr_b16 a[188:189], v237 offset:56704
    ds_read_b64_tr_b16 a[192:193], v237 offset:56768
    ds_read_b64_tr_b16 a[196:197], v237 offset:56832
    s_waitcnt lgkmcnt(0)
    s_add_u32 m0, s55, 56576
    s_nop 0
    buffer_load_dwordx4 v112, s[4:7], s9 offen lds
    s_add_u32 m0, s55, 57600
    s_nop 0
    buffer_load_dwordx4 v112, s[4:7], s10 offen lds
    s_add_u32 m0, s55, 58624
    s_nop 0
    buffer_load_dwordx4 v112, s[4:7], s11 offen lds
    s_waitcnt vmcnt(6)
    v_cmp_gt_u32 vcc, 1, v242
    s_nop 0
    s_cbranch_vccz L_ok_36
    s_mov_b32 s43, 0
L_spin_37:
    s_sleep 4
    buffer_load_dword v242, v243, s[28:31], s44 offen sc1
    s_add_u32 s43, s43, 1
    s_cmp_ge_u32 s43, 20000
    s_waitcnt vmcnt(0)
    s_cbranch_scc1 L_ok_36
    v_cmp_gt_u32 vcc, 1, v242
    s_nop 1
    s_cbranch_vccnz L_spin_37
L_ok_36:
    s_add_u32 m0, s8, 0
    s_nop 0
    buffer_load_dwordx4 v7, s[28:31], s54 offen offset:0 sc1 lds
    buffer_load_dwordx4 v7, s[28:31], s54 offen offset:1024 sc1 lds
    buffer_load_dwordx4 v7, s[28:31], s54 offen offset:2048 sc1 lds
    buffer_load_dwordx4 v7, s[28:31], s54 offen offset:3072 sc1 lds
    s_add_u32 s54, s54, 4096
    s_add_u32 m0, s8, 4096
    s_nop 0
    s_nop 0
    buffer_load_dwordx4 v7, s[28:31], s54 offen offset:0 sc1 lds
    buffer_load_dwordx4 v7, s[28:31], s54 offen offset:1024 sc1 lds
    buffer_load_dwordx4 v7, s[28:31], s54 offen offset:2048 sc1 lds
    buffer_load_dwordx4 v7, s[28:31], s54 offen offset:3072 sc1 lds
    s_add_u32 s54, s54, 4096
    s_add_u32 m0, s8, 8192
    s_nop 0
    buffer_load_dwordx4 v7, s[28:31], s54 offen offset:0 sc1 lds
    s_lshl_b32 s44, s38, 12
    v_and_b32 v8, 31, v0
    v_lshlrev_b32_e64 v243, 7, v8
    s_lshl_b32 s46, s38, 14
    s_add_u32 s46, s46, 131072
    buffer_load_dword v242, v243, s[28:31], s44 offen sc1
    buffer_load_dwordx4 v7, s[28:31], s54 offen offset:1024 sc1 lds
L_phaseB:
L_pg8:
    s_cbranch_execz L_ret
    s_lshl_b32 s3, s40, 2
    s_add_u32 s3, s3, s38
    s_mul_i32 s3, s3, 8
    s_and_b32 s43, s39, 1
    s_xor_b32 s43, s43, 0
    s_mul_i32 s43, s43, 1024
    s_add_u32 s3, s3, s43
    s_mul_i32 s3, s3, 3072
    s_lshr_b32 s43, s39, 1
    s_mul_i32 s43, s43, 768
    s_add_u32 s3, s3, s43
    v_and_b32 v8, 7, v0
    v_min_u32 v8, 5, v8
    v_lshrrev_b32 v9, 3, v0
    v_min_u32_e64 v9, 7, v9
    v_med3_u32 v10, v9, 0, 7
    v_mul_u32_u24 v9, 3072, v9
    v_mul_u32_u24 v10, 3072, v10
    v_lshl_add_u32 v8, v8, 7, v10
    v_add_u32 v8, s3, v8
    s_and_b32 s43, s39, 1
    s_mul_i32 s43, s43, -6291456
    s_add_u32 s3, s3, s43
    s_add_u32 s3, s3, 3146240
    s_and_b32 s3, s3, 0xfffffc00
    s_add_u32 s3, s3, 384
    v_and_b32 v10, 7, v0
    v_cmp_le_u32 vcc, 6, v10
    v_add_u32 v9, s3, v9
    s_nop 0
    v_cndmask_b32 v8, v8, v9, vcc
    v_mov_b32 v14, v8
    s_waitcnt vmcnt(11)
    ds_read_b64_tr_b16 a[240:241], v235 offset:56576
    ds_read_b64_tr_b16 a[242:243], v235 offset:56832
    ds_read_b64_tr_b16 a[244:245], v235 offset:57600
    ds_read_b64_tr_b16 a[246:247], v235 offset:57856
    ds_read_b64_tr_b16 a[248:249], v235 offset:58624
    ds_read_b64_tr_b16 a[250:251], v235 offset:58880
    ds_read_b64_tr_b16 a[120:121], v236 offset:0
    ds_read_b64_tr_b16 a[122:123], v236 offset:672
    ds_read_b64_tr_b16 a[124:125], v236 offset:64
    ds_read_b64_tr_b16 a[126:127], v236 offset:736
    ds_read_b64_tr_b16 a[128:129], v236 offset:128
    ds_read_b64_tr_b16 a[130:131], v236 offset:800
    ds_read_b64_tr_b16 a[132:133], v236 offset:192
    ds_read_b64_tr_b16 a[134:135], v236 offset:864
    ds_read_b64_tr_b16 a[136:137], v236 offset:256
    ds_read_b64_tr_b16 a[138:139], v236 offset:928
    ds_read_b64_tr_b16 a[140:141], v236 offset:6720
    ds_read_b64_tr_b16 a[142:143], v236 offset:7392
    ds_read_b64_tr_b16 a[144:145], v236 offset:6784
    ds_read_b64_tr_b16 a[146:147], v236 offset:7456
    ds_read_b64_tr_b16 a[148:149], v236 offset:6848
    ds_read_b64_tr_b16 a[150:151], v236 offset:7520
    ds_read_b64_tr_b16 a[152:153], v236 offset:6912
    ds_read_b64_tr_b16 a[154:155], v236 offset:7584
    ds_read_b64_tr_b16 a[156:157], v236 offset:6976
    ds_read_b64_tr_b16 a[158:159], v236 offset:7648
    ds_read_b64_tr_b16 a[182:183], v237 offset:0
    ds_read_b64_tr_b16 a[186:187], v237 offset:64
    ds_read_b64_tr_b16 a[190:191], v237 offset:128
    ds_read_b64_tr_b16 a[194:195], v237 offset:192
    ds_read_b64_tr_b16 a[198:199], v237 offset:256
    s_waitcnt lgkmcnt(14)
    v_mfma_f32_32x32x16_bf16 v[16:31], a[252:255], a[240:243], 0
    v_mfma_f32_32x32x16_bf16 v[32:47], a[252:255], a[244:247], 0
    v_mfma_f32_32x32x16_bf16 v[48:63], a[252:255], a[248:251], 0
    s_waitcnt vmcnt(1)
    v_cmp_gt_u32 vcc, 1, v242
    s_nop 0
    s_cbranch_vccz L_ok_38
    s_mov_b32 s43, 0
L_spin_39:
    s_sleep 4
    buffer_load_dword v242, v243, s[28:31], s44 offen sc1
    s_add_u32 s43, s43, 1
    s_cmp_ge_u32 s43, 20000
    s_waitcnt vmcnt(0)
    s_cbranch_scc1 L_ok_38
    v_cmp_gt_u32 vcc, 1, v242
    s_nop 1
    s_cbranch_vccnz L_spin_39
L_ok_38:
    buffer_load_dwordx4 v[96:99], v238, s[28:31], s46 offen offset:0 sc1
    buffer_load_dwordx4 v[100:103], v239, s[28:31], s46 offen offset:0 sc1
    buffer_load_dwordx4 v[104:107], v240, s[28:31], s46 offen offset:0 sc1
    s_waitcnt vmcnt(3)
    ds_read_b64_tr_b16 a[200:201], v12 offset:0
    buffer_load_dwordx4 v[108:111], v238, s[28:31], s46 offen offset:2048 sc1
    ds_read_b64_tr_b16 a[202:203], v12 offset:64
    ds_read_b64_tr_b16 a[232:233], v13 offset:256
    buffer_load_dwordx4 v[112:115], v239, s[28:31], s46 offen offset:2048 sc1
    ds_read_b64_tr_b16 a[234:235], v13 offset:576
    buffer_load_dwordx4 v[116:119], v240, s[28:31], s46 offen offset:2048 sc1
    ds_read_b64_tr_b16 a[204:205], v12 offset:320
    ds_read_b64_tr_b16 a[206:207], v12 offset:384
    s_add_u32 s46, s46, 4096
    buffer_load_dwordx4 v[120:123], v238, s[28:31], s46 offen offset:0 sc1
    ds_read_b64_tr_b16 a[208:209], v12 offset:640
    ds_read_b64_tr_b16 a[210:211], v12 offset:704
    buffer_load_dwordx4 v[124:127], v239, s[28:31], s46 offen offset:0 sc1
    ds_read_b64_tr_b16 a[212:213], v12 offset:960
    buffer_load_dwordx4 v[128:131], v241, s[28:31], s46 offen offset:0 sc1
    ds_read_b64_tr_b16 a[214:215], v12 offset:1024
    ds_read_b64_tr_b16 a[216:217], v12 offset:1280
    buffer_load_dwordx4 v[132:135], v238, s[28:31], s46 offen offset:2048 sc1
    ds_read_b64_tr_b16 a[218:219], v12 offset:1344
    buffer_load_dwordx4 v[136:139], v239, s[28:31], s46 offen offset:2048 sc1
    ds_read_b64_tr_b16 a[220:221], v12 offset:1600
    ds_read_b64_tr_b16 a[222:223], v12 offset:1664
    buffer_load_dwordx4 v[140:143], v241, s[28:31], s46 offen offset:2048 sc1
    ds_read_b64_tr_b16 a[224:225], v12 offset:1920
    ds_read_b64_tr_b16 a[226:227], v12 offset:1984
    s_add_u32 s46, s46, 4096
    buffer_load_dwordx4 v[144:147], v238, s[28:31], s46 offen offset:0 sc1
    ds_read_b64_tr_b16 a[228:229], v12 offset:2240
    buffer_load_dwordx4 v[148:151], v239, s[28:31], s46 offen offset:0 sc1
    ds_read_b64_tr_b16 a[230:231], v12 offset:2304
    ds_read_b64_tr_b16 a[236:237], v13 offset:1536
    buffer_load_dwordx4 v[152:155], v240, s[28:31], s46 offen offset:0 sc1
    ds_read_b64_tr_b16 a[238:239], v13 offset:1856
    s_waitcnt vmcnt(14)
    v_cvt_pk_bf16_f32 v96, v96, v97
    v_cvt_pk_bf16_f32 v97, v98, v99
    s_waitcnt vmcnt(13)
    v_cvt_pk_bf16_f32 v98, v100, v101
    v_cvt_pk_bf16_f32 v99, v102, v103
    s_waitcnt vmcnt(12)
    v_cvt_pk_bf16_f32 v224, v104, v105
    v_cvt_pk_bf16_f32 v225, v106, v107
    s_waitcnt lgkmcnt(14)
    v_mfma_f32_32x32x16_bf16 v[192:207], v[96:99], a[200:203], 0
    v_mfma_f32_32x32x16_bf16 v[192:207], v[224:227], a[232:235], v[192:207]
    buffer_load_dwordx4 v[156:159], v238, s[28:31], s46 offen offset:2048 sc1
    s_waitcnt vmcnt(12)
    v_cvt_pk_bf16_f32 v108, v108, v109
    v_cvt_pk_bf16_f32 v109, v110, v111
    s_waitcnt vmcnt(11)
    v_cvt_pk_bf16_f32 v110, v112, v113
    v_cvt_pk_bf16_f32 v111, v114, v115
    s_waitcnt vmcnt(10)
    v_cvt_pk_bf16_f32 v228, v116, v117
    v_cvt_pk_bf16_f32 v229, v118, v119
    v_mfma_f32_32x32x16_bf16 v[208:223], v[108:111], a[204:207], 0
    s_nop 0
    v_mfma_f32_32x32x16_bf16 v[208:223], v[226:229], a[232:235], v[208:223]
    buffer_load_dwordx4 v[160:163], v239, s[28:31], s46 offen offset:2048 sc1
    v_add_f32 v202, 0x358637bd, v202
    v_rcp_f32 v202, v202
    s_nop 0
    v_mul_f32 v192, v192, v202
    v_mul_f32 v193, v193, v202
    v_mul_f32 v194, v194, v202
    v_mul_f32 v195, v195, v202
    v_mul_f32 v196, v196, v202
    v_mul_f32 v197, v197, v202
    v_mul_f32_e64 v198, v198, v202
    buffer_load_dwordx4 v[164:167], v240, s[28:31], s46 offen offset:2048 sc1
    v_mul_f32 v199, v199, v202
    v_mul_f32 v200, v200, v202
    v_mul_f32_e64 v201, v201, v202
    v_cvt_pk_bf16_f32 v100, v192, v193
    v_cvt_pk_bf16_f32 v101, v194, v195
    v_cvt_pk_bf16_f32 v102, v196, v197
    v_cvt_pk_bf16_f32 v103, v198, v199
    v_cvt_pk_bf16_f32 v230, v200, v201
    s_nop 0
    v_mfma_f32_32x32x16_bf16 v[64:79], v[100:103], a[12:15], 0
    s_waitcnt vmcnt(9)
    v_cvt_pk_bf16_f32 v224, v128, v129
    v_cvt_pk_bf16_f32 v120, v120, v121
    v_cvt_pk_bf16_f32 v121, v122, v123
    v_cvt_pk_bf16_f32 v122, v124, v125
    v_mfma_f32_32x32x16_bf16 v[80:95], v[100:103], a[16:19], 0
    v_add_f32 v218, 0x358637bd, v218
    v_rcp_f32 v218, v218
    v_cvt_pk_bf16_f32 v123, v126, v127
    v_cvt_pk_bf16_f32 v225, v130, v131
    s_waitcnt lgkmcnt(12)
    v_mfma_f32_32x32x16_bf16 v[192:207], v[120:123], a[208:211], 0
    v_mul_f32 v208, v208, v218
    v_mul_f32 v209, v209, v218
    v_mul_f32 v210, v210, v218
    v_mul_f32 v211, v211, v218
    s_add_u32 s46, s46, 4096
    buffer_load_dwordx4 v[168:171], v238, s[28:31], s46 offen offset:0 sc1
    v_mfma_f32_32x32x16_bf16 v[192:207], v[224:227], a[232:235], v[192:207]
    v_mul_f32 v212, v212, v218
    v_mul_f32 v213, v213, v218
    v_mul_f32 v214, v214, v218
    v_mul_f32 v215, v215, v218
    buffer_load_dwordx4 v[172:175], v239, s[28:31], s46 offen offset:0 sc1
    v_mfma_f32_32x32x16_bf16 v[48:63], v[100:103], a[8:11], v[48:63]
    v_mul_f32 v216, v216, v218
    v_mul_f32 v217, v217, v218
    v_cvt_pk_bf16_f32 v112, v208, v209
    v_cvt_pk_bf16_f32 v113, v210, v211
    buffer_load_dwordx4 v[176:179], v241, s[28:31], s46 offen offset:0 sc1
    v_mfma_f32_32x32x16_bf16 v[32:47], v[100:103], a[4:7], v[32:47]
    v_cvt_pk_bf16_f32 v114, v212, v213
    v_cvt_pk_bf16_f32 v115, v214, v215
    v_cvt_pk_bf16_f32 v231, v216, v217
    v_mfma_f32_32x32x16_bf16 v[16:31], v[100:103], a[0:3], v[16:31]
    s_waitcnt vmcnt(9)
    v_cvt_pk_bf16_f32 v228, v140, v141
    s_nop 0
    v_cvt_pk_bf16_f32 v132, v132, v133
    v_cvt_pk_bf16_f32 v133, v134, v135
    v_cvt_pk_bf16_f32 v134, v136, v137
    v_mfma_f32_32x32x16_bf16 v[64:79], v[112:115], a[32:35], v[64:79]
    v_add_f32 v202, 0x358637bd, v202
    v_rcp_f32 v202, v202
    v_cvt_pk_bf16_f32 v135, v138, v139
    v_cvt_pk_bf16_f32 v229, v142, v143
    s_waitcnt lgkmcnt(10)
    v_mfma_f32_32x32x16_bf16 v[208:223], v[132:135], a[212:215], 0
    v_mul_f32 v192, v192, v202
    v_mul_f32 v193, v193, v202
    v_mul_f32 v194, v194, v202
    v_mul_f32 v195, v195, v202
    buffer_load_dwordx4 v[180:183], v238, s[28:31], s46 offen offset:2048 sc1
    v_mfma_f32_32x32x16_bf16 v[208:223], v[226:229], a[232:235], v[208:223]
    v_mul_f32 v196, v196, v202
    v_mul_f32 v197, v197, v202
    v_mul_f32 v198, v198, v202
    v_mul_f32 v199, v199, v202
    buffer_load_dwordx4 v[184:187], v239, s[28:31], s46 offen offset:2048 sc1
    v_mfma_f32_32x32x16_bf16 v[80:95], v[112:115], a[36:39], v[80:95]
    v_mul_f32 v200, v200, v202
    v_mul_f32 v201, v201, v202
    v_cvt_pk_bf16_f32 v124, v192, v193
    v_cvt_pk_bf16_f32 v125, v194, v195
    buffer_load_dwordx4 v[188:191], v241, s[28:31], s46 offen offset:2048 sc1
    v_mfma_f32_32x32x16_bf16 v[48:63], v[112:115], a[28:31], v[48:63]
    v_cvt_pk_bf16_f32 v126, v196, v197
    v_cvt_pk_bf16_f32 v127, v198, v199
    v_cvt_pk_bf16_f32 v232, v200, v201
    v_mfma_f32_32x32x16_bf16 v[32:47], v[112:115], a[24:27], v[32:47]
    s_waitcnt vmcnt(9)
    v_cvt_pk_bf16_f32 v224, v152, v153
    s_nop 0
    v_cvt_pk_bf16_f32 v144, v144, v145
L_pg9:
    s_cbranch_execz L_ret
    v_cvt_pk_bf16_f32 v145, v146, v147
    v_cvt_pk_bf16_f32 v146, v148, v149
    v_mfma_f32_32x32x16_bf16 v[16:31], v[112:115], a[20:23], v[16:31]
    v_add_f32 v218, 0x358637bd, v218
    v_rcp_f32 v218, v218
    v_cvt_pk_bf16_f32 v147, v150, v151
    v_cvt_pk_bf16_f32 v225, v154, v155
    s_waitcnt lgkmcnt(8)
    v_mfma_f32_32x32x16_bf16 v[192:207], v[144:147], a[216:219], 0
    v_mul_f32 v208, v208, v218
    v_mul_f32 v209, v209, v218
    v_mul_f32 v210, v210, v218
    v_mul_f32 v211, v211, v218
    s_waitcnt lgkmcnt(0)
    v_mfma_f32_32x32x16_bf16 v[192:207], v[224:227], a[236:239], v[192:207]
    v_mul_f32 v212, v212, v218
    v_mul_f32 v213, v213, v218
    v_mul_f32 v214, v214, v218
    v_mul_f32 v215, v215, v218
    v_mfma_f32_32x32x16_bf16 v[64:79], v[124:127], a[52:55], v[64:79]
    v_mul_f32 v216, v216, v218
    v_mul_f32 v217, v217, v218
    v_cvt_pk_bf16_f32 v136, v208, v209
    v_cvt_pk_bf16_f32 v137, v210, v211
    v_mfma_f32_32x32x16_bf16 v[80:95], v[124:127], a[56:59], v[80:95]
    v_cvt_pk_bf16_f32 v138, v212, v213
    v_cvt_pk_bf16_f32 v139, v214, v215
    v_cvt_pk_bf16_f32 v233, v216, v217
    s_barrier
    buffer_load_dword v255, v14, s[16:19], 0 offen
    v_mfma_f32_32x32x16_bf16 v[48:63], v[124:127], a[48:51], v[48:63]
    s_waitcnt vmcnt(7)
    v_cvt_pk_bf16_f32 v228, v164, v165
    v_cvt_pk_bf16_f32 v156, v156, v157
    v_cvt_pk_bf16_f32 v157, v158, v159
    v_cvt_pk_bf16_f32 v158, v160, v161
    v_mfma_f32_32x32x16_bf16 v[32:47], v[124:127], a[44:47], v[32:47]
    v_add_f32 v202, 0x358637bd, v202
    v_rcp_f32 v202, v202
    v_cvt_pk_bf16_f32 v159, v162, v163
    v_cvt_pk_bf16_f32 v229, v166, v167
    s_nop 0
    v_mfma_f32_32x32x16_bf16 v[208:223], v[156:159], a[220:223], 0
    v_mul_f32 v192, v192, v202
    v_mul_f32 v193, v193, v202
    v_mul_f32 v194, v194, v202
    v_mul_f32 v195, v195, v202
    v_mfma_f32_32x32x16_bf16 v[208:223], v[226:229], a[236:239], v[208:223]
    v_mul_f32 v196, v196, v202
    v_mul_f32 v197, v197, v202
    v_mul_f32 v198, v198, v202
    v_mul_f32 v199, v199, v202
    v_mfma_f32_32x32x16_bf16 v[16:31], v[124:127], a[40:43], v[16:31]
    v_mul_f32 v200, v200, v202
    v_mul_f32 v201, v201, v202
    v_cvt_pk_bf16_f32 v148, v192, v193
    v_cvt_pk_bf16_f32 v149, v194, v195
    v_mfma_f32_32x32x16_bf16 v[64:79], v[136:139], a[72:75], v[64:79]
    v_cvt_pk_bf16_f32 v150, v196, v197
    v_cvt_pk_bf16_f32 v151, v198, v199
    v_cvt_pk_bf16_f32 v234, v200, v201
    v_mfma_f32_32x32x16_bf16 v[80:95], v[136:139], a[76:79], v[80:95]
    s_waitcnt vmcnt(4)
    v_cvt_pk_bf16_f32 v224, v176, v177
    s_nop 0
    v_cvt_pk_bf16_f32 v168, v168, v169
    v_cvt_pk_bf16_f32 v169, v170, v171
    v_cvt_pk_bf16_f32 v170, v172, v173
    v_mfma_f32_32x32x16_bf16 v[48:63], v[136:139], a[68:71], v[48:63]
    v_add_f32 v218, 0x358637bd, v218
    v_rcp_f32 v218, v218
    v_cvt_pk_bf16_f32 v171, v174, v175
    v_cvt_pk_bf16_f32 v225, v178, v179
    s_nop 0
    v_mfma_f32_32x32x16_bf16 v[192:207], v[168:171], a[224:227], 0
    v_mul_f32 v208, v208, v218
    v_mul_f32 v209, v209, v218
    v_mul_f32 v210, v210, v218
    v_mul_f32 v211, v211, v218
    v_mfma_f32_32x32x16_bf16 v[192:207], v[224:227], a[236:239], v[192:207]
    v_mul_f32 v212, v212, v218
    v_mul_f32 v213, v213, v218
    v_mul_f32 v214, v214, v218
    v_mul_f32 v215, v215, v218
    v_mfma_f32_32x32x16_bf16 v[32:47], v[136:139], a[64:67], v[32:47]
    v_mul_f32 v216, v216, v218
    v_mul_f32 v217, v217, v218
    v_cvt_pk_bf16_f32 v160, v208, v209
    v_cvt_pk_bf16_f32 v161, v210, v211
    v_mfma_f32_32x32x16_bf16 v[64:79], v[230:233], a[172:175], v[64:79]
    v_cvt_pk_bf16_f32 v162, v212, v213
    v_cvt_pk_bf16_f32 v163, v214, v215
    v_cvt_pk_bf16_f32 v235, v216, v217
    v_mfma_f32_32x32x16_bf16 v[80:95], v[230:233], a[176:179], v[80:95]
    s_waitcnt vmcnt(1)
    s_nop 0
    v_cvt_pk_bf16_f32 v228, v188, v189
    v_cvt_pk_bf16_f32 v180, v180, v181
    v_cvt_pk_bf16_f32 v181, v182, v183
    v_cvt_pk_bf16_f32 v182, v184, v185
    v_mfma_f32_32x32x16_bf16 v[48:63], v[230:233], a[168:171], v[48:63]
    v_add_f32 v202, 0x358637bd, v202
    v_rcp_f32_e64 v202, v202
    v_cvt_pk_bf16_f32 v183, v186, v187
    v_cvt_pk_bf16_f32 v229, v190, v191
    s_nop 0
    v_mfma_f32_32x32x16_bf16 v[208:223], v[180:183], a[228:231], 0
    v_mul_f32 v192, v192, v202
    v_mul_f32 v193, v193, v202
    v_mul_f32 v194, v194, v202
    v_mfma_f32_32x32x16_bf16 v[208:223], v[226:229], a[236:239], v[208:223]
    v_mul_f32 v195, v195, v202
    v_mul_f32 v196, v196, v202
    v_mul_f32 v197, v197, v202
    v_mfma_f32_32x32x16_bf16 v[32:47], v[230:233], a[164:167], v[32:47]
    v_mul_f32 v198, v198, v202
    v_mul_f32 v199, v199, v202
    v_mul_f32 v200, v200, v202
    v_mfma_f32_32x32x16_bf16 v[16:31], v[230:233], a[160:163], v[16:31]
    v_mul_f32_e64 v201, v201, v202
    v_cvt_pk_bf16_f32 v172, v192, v193
    v_cvt_pk_bf16_f32 v173, v194, v195
    v_mfma_f32_32x32x16_bf16 v[64:79], v[148:151], a[92:95], v[64:79]
    v_cvt_pk_bf16_f32 v174, v196, v197
    v_cvt_pk_bf16_f32 v175, v198, v199
    v_cvt_pk_bf16_f32 v236, v200, v201
    v_mfma_f32_32x32x16_bf16 v[80:95], v[148:151], a[96:99], v[80:95]
    v_add_f32 v218, 0x358637bd, v218
    v_rcp_f32 v218, v218
    s_nop 0
    v_mul_f32 v208, v208, v218
    v_mul_f32 v209, v209, v218
    v_mul_f32 v210, v210, v218
    v_mul_f32 v211, v211, v218
    v_mfma_f32_32x32x16_bf16 v[48:63], v[148:151], a[88:91], v[48:63]
    v_mul_f32 v212, v212, v218
    v_mul_f32 v213, v213, v218
    v_mul_f32 v214, v214, v218
    v_mul_f32 v215, v215, v218
    v_mul_f32 v216, v216, v218
    v_mul_f32 v217, v217, v218
    v_mfma_f32_32x32x16_bf16 v[64:79], v[160:163], a[112:115], v[64:79]
    v_cvt_pk_bf16_f32 v184, v208, v209
    v_cvt_pk_bf16_f32 v185, v210, v211
    v_cvt_pk_bf16_f32 v186, v212, v213
    v_cvt_pk_bf16_f32 v187, v214, v215
    v_cvt_pk_bf16_f32 v237, v216, v217
    v_mfma_f32_32x32x16_bf16 v[80:95], v[160:163], a[116:119], v[80:95]
    v_add_u32 v8, s63, v7
    v_add_u32 v13, s62, v7
    v_add_u32 v9, s0, v8
    v_add_u32 v96, s0, v13
    v_add_u32 v10, s0, v9
    v_add_u32 v97, s0, v96
    v_mfma_f32_32x32x16_bf16 v[64:79], v[172:175], a[132:135], v[64:79]
    v_add_u32 v11, s0, v10
    v_add_u32 v98, s0, v97
    v_add_u32 v12, s0, v11
    v_add_u32 v99, s0, v98
    v_add_u32_e64 v10, s1, v10
    v_mfma_f32_32x32x16_bf16 v[64:79], v[184:187], a[152:155], v[64:79]
    s_add_u32 m0, s64, 0
    s_mov_b32 s65, 0
    buffer_load_dwordx4 v244, s[16:19], s65 offen offset:0 lds
    v_mfma_f32_32x32x16_bf16 v[64:79], v[234:237], a[192:195], v[64:79]
    v_mfma_f32_32x32x16_bf16 v[80:95], v[172:175], a[136:139], v[80:95]
    v_mfma_f32_32x32x16_bf16 v[80:95], v[184:187], a[156:159], v[80:95]
    v_mfma_f32_32x32x16_bf16 v[80:95], v[234:237], a[196:199], v[80:95]
    ds_write_b128 v11, v[72:75] offset:4096
    v_mfma_f32_32x32x16_bf16 v[48:63], v[160:163], a[108:111], v[48:63]
    ds_write_b128 v11, v[76:79] offset:5120
    buffer_load_dwordx4 v245, s[16:19], s65 offen offset:1024 lds
    v_mfma_f32_32x32x16_bf16 v[48:63], v[172:175], a[128:131], v[48:63]
    ds_write_b128 v98, v[64:67] offset:0
    v_mfma_f32_32x32x16_bf16 v[48:63], v[184:187], a[148:151], v[48:63]
    v_mfma_f32_32x32x16_bf16 v[48:63], v[234:237], a[188:191], v[48:63]
    ds_write_b128 v98, v[68:71] offset:1024
    v_mfma_f32_32x32x16_bf16 v[32:47], v[148:151], a[84:87], v[32:47]
    ds_write_b128 v12, v[88:91] offset:4096
    v_mfma_f32_32x32x16_bf16 v[32:47], v[160:163], a[104:107], v[32:47]
    buffer_load_dwordx4 v246, s[16:19], s65 offen offset:2048 lds
    v_mfma_f32_32x32x16_bf16 v[32:47], v[172:175], a[124:127], v[32:47]
    ds_write_b128 v12, v[92:95] offset:5120
    v_mfma_f32_32x32x16_bf16 v[32:47], v[184:187], a[144:147], v[32:47]
    ds_write_b128 v99, v[80:83] offset:0
    v_mfma_f32_32x32x16_bf16 v[32:47], v[234:237], a[184:187], v[32:47]
    v_mfma_f32_32x32x16_bf16 v[16:31], v[136:139], a[60:63], v[16:31]
    ds_write_b128 v99, v[84:87] offset:1024
    v_mfma_f32_32x32x16_bf16 v[16:31], v[148:151], a[80:83], v[16:31]
    ds_write_b128 v10, v[56:59] offset:2048
    buffer_load_dwordx4 v247, s[16:19], s65 offen offset:3072 lds
    v_mfma_f32_32x32x16_bf16 v[16:31], v[160:163], a[100:103], v[16:31]
    v_mfma_f32_32x32x16_bf16 v[16:31], v[172:175], a[120:123], v[16:31]
    ds_write_b128 v10, v[60:63] offset:3072
    v_mfma_f32_32x32x16_bf16 v[16:31], v[184:187], a[140:143], v[16:31]
    s_mov_b64 exec, s[60:61]
    ds_write_b128 v97, v[48:51] offset:0
    ds_write_b128 v97, v[52:55] offset:1024
    s_mov_b64 exec, -1
    v_mfma_f32_32x32x16_bf16 v[16:31], v[234:237], a[180:183], v[16:31]
    ds_write_b128 v9, v[40:43] offset:2048
    ds_write_b128 v9, v[44:47] offset:3072
    s_nop 9
    ds_write_b128 v8, v[24:27] offset:2048
    ds_write_b128 v8, v[28:31] offset:3072
    s_waitcnt lgkmcnt(0)
    s_barrier
    s_nop 0
    ds_read_b128 v[112:115], v13 offset:0
    ds_read_b128 v[116:119], v13 offset:1024
    ds_read_b128 v[120:123], v13 offset:2048
    ds_read_b128 v[124:127], v13 offset:3072
    ds_read_b128 v[128:131], v13 offset:4096
    ds_read_b128 v[132:135], v13 offset:5120
    ds_read_b128 v[136:139], v96 offset:0
    ds_read_b128 v[140:143], v96 offset:1024
    ds_read_b128 v[144:147], v96 offset:2048
    ds_read_b128 v[148:151], v96 offset:3072
    ds_read_b128 v[152:155], v96 offset:4096
    ds_read_b128 v[156:159], v96 offset:5120
    ds_read_b128 v[160:163], v97 offset:0
    ds_read_b128 v[164:167], v97 offset:1024
    ds_read_b128 v[168:171], v97 offset:2048
    ds_read_b128 v[172:175], v97 offset:3072
    ds_read_b128 v[176:179], v97 offset:4096
    ds_read_b128 v[180:183], v97 offset:5120
    s_waitcnt lgkmcnt(14)
    v_pk_add_f32 v[22:23], v[22:23], v[118:119]
    s_nop 0
    s_add_u32 m0, s64, 4096
    s_mov_b32 s65, 98304
    buffer_load_dwordx4 v244, s[16:19], s65 offen offset:0 lds
    v_pk_add_f32 v[20:21], v[20:21], v[116:117]
    v_pk_add_f32 v[18:19], v[18:19], v[114:115]
    v_pk_add_f32 v[16:17], v[16:17], v[112:113]
    v_pk_add_f32 v[22:23], v[22:23], v[126:127]
    v_pk_add_f32 v[20:21], v[20:21], v[124:125]
    v_pk_add_f32 v[18:19], v[18:19], v[122:123]
    buffer_load_dwordx4 v245, s[16:19], s65 offen offset:1024 lds
    v_pk_add_f32 v[16:17], v[16:17], v[120:121]
    s_waitcnt lgkmcnt(12)
    s_nop 0
    v_pk_add_f32 v[22:23], v[22:23], v[134:135]
    v_pk_add_f32 v[20:21], v[20:21], v[132:133]
    v_pk_add_f32 v[18:19], v[18:19], v[130:131]
    v_pk_add_f32 v[16:17], v[16:17], v[128:129]
    v_pk_mul_f32 v[200:201], v[16:17], v[16:17]
    buffer_load_dwordx4 v246, s[16:19], s65 offen offset:2048 lds
    v_pk_mul_f32 v[202:203], v[18:19], v[18:19]
    v_pk_mul_f32 v[204:205], v[20:21], v[20:21]
    v_pk_mul_f32 v[206:207], v[22:23], v[22:23]
    s_waitcnt lgkmcnt(6)
    v_pk_add_f32 v[38:39], v[38:39], v[158:159]
    v_pk_add_f32 v[36:37], v[36:37], v[156:157]
    s_nop 0
    v_pk_add_f32 v[34:35], v[34:35], v[154:155]
    buffer_load_dwordx4 v247, s[16:19], s65 offen offset:3072 lds
    v_pk_add_f32 v[32:33], v[32:33], v[152:153]
    v_pk_add_f32 v[38:39], v[38:39], v[150:151]
    v_pk_add_f32 v[36:37], v[36:37], v[148:149]
    v_pk_add_f32 v[34:35], v[34:35], v[146:147]
    v_pk_add_f32 v[32:33], v[32:33], v[144:145]
    v_pk_add_f32 v[38:39], v[38:39], v[142:143]
    s_add_u32 m0, s64, 8192
    s_mov_b32 s65, 196608
    buffer_load_dwordx4 v244, s[16:19], s65 offen offset:0 lds
    v_pk_add_f32 v[36:37], v[36:37], v[140:141]
    v_pk_add_f32 v[34:35], v[34:35], v[138:139]
    v_pk_add_f32 v[32:33], v[32:33], v[136:137]
    v_pk_fma_f32 v[200:201], v[32:33], v[32:33], v[200:201]
    v_pk_add_f32 v[192:193], v[32:33], v[16:17]
    v_pk_fma_f32 v[202:203], v[34:35], v[34:35], v[202:203]
    buffer_load_dwordx4 v245, s[16:19], s65 offen offset:1024 lds
    v_pk_add_f32 v[194:195], v[34:35], v[18:19]
    v_pk_fma_f32 v[204:205], v[36:37], v[36:37], v[204:205]
    v_pk_add_f32 v[196:197], v[36:37], v[20:21]
    v_pk_fma_f32 v[206:207], v[38:39], v[38:39], v[206:207]
    v_pk_add_f32 v[198:199], v[38:39], v[22:23]
    s_cmp_eq_u32 s42, 1
    s_cbranch_scc1 L_od_40
    s_waitcnt lgkmcnt(0)
    v_pk_add_f32 v[54:55], v[54:55], v[182:183]
    v_pk_add_f32 v[52:53], v[52:53], v[180:181]
    v_pk_add_f32 v[50:51], v[50:51], v[178:179]
    s_nop 0
    v_pk_add_f32 v[48:49], v[48:49], v[176:177]
    v_pk_add_f32 v[54:55], v[54:55], v[174:175]
    v_pk_add_f32 v[52:53], v[52:53], v[172:173]
    v_pk_add_f32 v[50:51], v[50:51], v[170:171]
    v_pk_add_f32 v[48:49], v[48:49], v[168:169]
    v_pk_add_f32 v[54:55], v[54:55], v[166:167]
    v_pk_add_f32 v[52:53], v[52:53], v[164:165]
    v_pk_add_f32 v[50:51], v[50:51], v[162:163]
    v_pk_add_f32 v[48:49], v[48:49], v[160:161]
    v_pk_fma_f32 v[200:201], v[48:49], v[48:49], v[200:201]
    v_pk_add_f32 v[192:193], v[48:49], v[192:193]
    v_pk_fma_f32 v[202:203], v[50:51], v[50:51], v[202:203]
    v_pk_add_f32 v[194:195], v[50:51], v[194:195]
    v_pk_fma_f32 v[204:205], v[52:53], v[52:53], v[204:205]
    v_pk_add_f32 v[196:197], v[52:53], v[196:197]
    v_pk_fma_f32 v[206:207], v[54:55], v[54:55], v[206:207]
    v_pk_add_f32 v[198:199], v[54:55], v[198:199]
L_od_40:
    v_permlane16_swap_b32 v192, v200
    v_permlane16_swap_b32 v193, v201
    v_permlane16_swap_b32 v194, v202
    v_permlane16_swap_b32 v195, v203
    v_permlane16_swap_b32 v196, v204
    v_permlane16_swap_b32 v197, v205
    v_permlane16_swap_b32 v198, v206
    v_permlane16_swap_b32 v199, v207
    v_pk_add_f32 v[192:193], v[192:193], v[200:201]
    v_pk_add_f32 v[194:195], v[194:195], v[202:203]
    v_pk_add_f32 v[196:197], v[196:197], v[204:205]
    v_pk_add_f32 v[198:199], v[198:199], v[206:207]
    v_add_f32_dpp v200, v192, v192 row_ror:8 row_mask:0xf bank_mask:0xf
    v_add_f32_dpp v201, v193, v193 row_ror:8 row_mask:0xf bank_mask:0xf
    v_add_f32_dpp v202, v194, v194 row_ror:8 row_mask:0xf bank_mask:0xf
    v_add_f32_dpp v203, v195, v195 row_ror:8 row_mask:0xf bank_mask:0xf
    v_add_f32_dpp v200, v196, v196 row_ror:8 row_mask:0xf bank_mask:0xc
    v_add_f32_dpp v201, v197, v197 row_ror:8 row_mask:0xf bank_mask:0xc
    v_add_f32_dpp v202, v198, v198 row_ror:8 row_mask:0xf bank_mask:0xc
    v_add_f32_dpp v203, v199, v199 row_ror:8 row_mask:0xf bank_mask:0xc
    v_add_f32_dpp v192, v200, v200 row_half_mirror row_mask:0xf bank_mask:0xf
    v_add_f32_dpp v193, v201, v201 row_half_mirror row_mask:0xf bank_mask:0xf
    s_nop 0
    v_add_f32_dpp v192, v202, v202 row_half_mirror row_mask:0xf bank_mask:0xa
    v_add_f32_dpp v193, v203, v203 row_half_mirror row_mask:0xf bank_mask:0xa
    s_nop 0
    v_add_f32_dpp v194, v192, v192 quad_perm:[1,0,3,2] row_mask:0xf bank_mask:0xf
    v_add_f32_dpp v195, v193, v193 quad_perm:[1,0,3,2] row_mask:0xf bank_mask:0xf
    s_nop 0
    v_add_f32_dpp v192, v194, v194 quad_perm:[2,3,0,1] row_mask:0xf bank_mask:0xf
    v_add_f32_dpp v193, v195, v195 quad_perm:[2,3,0,1] row_mask:0xf bank_mask:0xf
    v_cndmask_b32 v192, v192, v193, s[56:57]
    v_or_b32 v192, 1, v192
    s_add_u32 s3, s53, 131072
    buffer_store_dword v192, v15, s[28:31], s3 offen
    v_cvt_pk_bf16_f32 v24, v16, v17
    v_cvt_pk_bf16_f32 v25, v18, v19
    v_cvt_pk_bf16_f32 v26, v20, v21
    v_cvt_pk_bf16_f32 v27, v22, v23
    v_cvt_pk_bf16_f32 v40, v32, v33
    v_cvt_pk_bf16_f32 v41, v34, v35
    v_cvt_pk_bf16_f32 v42, v36, v37
    v_cvt_pk_bf16_f32 v43, v38, v39
    v_cvt_pk_bf16_f32 v56, v48, v49
    v_cvt_pk_bf16_f32 v57, v50, v51
    v_cvt_pk_bf16_f32 v58, v52, v53
    v_cvt_pk_bf16_f32 v59, v54, v55
    buffer_load_dwordx4 v246, s[16:19], s65 offen offset:2048 lds
    buffer_load_dwordx4 v247, s[16:19], s65 offen offset:3072 lds
    s_add_u32 m0, s64, 12288
    s_mov_b32 s65, 294912
    buffer_load_dwordx4 v244, s[16:19], s65 offen offset:0 lds
    s_and_b32 s3, s39, 1
    s_lshl_b32 s3, s3, 2
    s_and_b32 s68, s40, 3
    s_add_u32 s68, s68, s3
    s_lshr_b32 s3, s39, 1
    s_lshr_b32 s69, s40, 2
    s_xor_b32 s3, s3, s69
    s_and_b32 s3, s3, 3
    s_lshl_b32 s3, s3, 3
    s_add_u32 s69, s69, s3
    s_lshl_b32 s3, s38, 7
    s_add_u32 s3, s3, 159744
    v_and_b32 v8, 7, v0
    v_lshl_add_u32 v8, v8, 2, v2
    v_lshl_add_u32 v104, v8, 2, s3
    v_lshl_add_u32 v105, v3, 6, s3
    v_and_b32_e64 v12, 1, v4
    v_bfe_u32 v13, v0, 3, 2
    v_lshl_add_u32 v13, v12, 2, v13
    v_lshl_add_u32 v13, v3, 3, v13
    s_waitcnt vmcnt(3)
    s_add_u32 s54, s51, 131072
    buffer_load_dwordx4 v[196:199], v7, s[28:31], s54 offen sc1
    s_nop 0
    buffer_store_dword v192, v15, s[28:31], s53 offen sc1
    buffer_store_dwordx4 v[24:27], v7, s[28:31], s48 offen sc1
    buffer_store_dwordx4 v[40:43], v7, s[28:31], s49 offen sc1
    buffer_store_dwordx4 v[56:59], v7, s[28:31], s50 offen sc1
    v_lshl_add_u32 v13, v13, 2, v5
    buffer_load_dwordx4 v245, s[16:19], s65 offen offset:1024 lds
    v_lshlrev_b32_e64 v13, 4, v13
    v_add_u32 v106, 4194304, v13
    v_add_u32 v107, 4194304, v7
    s_lshl_b32 s3, s38, 13
    s_add_u32 s13, s3, 32768
    s_lshl_b32 s3, s66, 1
    v_add_u32 v8, s3, v6
    v_mul_u32_u24 v8, 52, v8
    buffer_load_dwordx4 v246, s[16:19], s65 offen offset:2048 lds
    v_lshrrev_b32 v8, 8, v8
    v_lshl_add_u32 v8, v1, 2, v8
    v_lshlrev_b32 v243, 7, v8
    s_lshl_b32 s3, s66, 3
    s_add_u32 s3, s3, s38
    s_lshl_b32 s3, s3, 7
    s_add_u32 s3, s3, s42
    s_lshl_b32 s3, s3, 8
    s_add_u32 s3, s3, 9437184
    buffer_load_dwordx4 v247, s[16:19], s65 offen offset:3072 lds
    v_lshlrev_b32 v8, 4, v1
    v_lshl_add_u32 v8, v2, 9, v8
    v_add_u32_e64 v204, s3, v8
    v_xor_b32 v205, 256, v204
    s_mul_i32 s3, s38, 6144
    s_add_u32 s3, s3, 98304
    v_add_u32 v200, s3, v7
    s_xor_b32 s3, s38, 1
    s_mul_i32 s3, s3, 6144
    s_add_u32 m0, s64, 16384
    s_mov_b32 s65, 393216
    buffer_load_dwordx4 v244, s[16:19], s65 offen offset:0 lds
    s_add_u32 s3, s3, 98304
    v_add_u32 v201, s3, v7
    s_xor_b32 s3, s38, 2
    s_mul_i32 s3, s3, 6144
    s_add_u32 s3, s3, 100352
    v_add_u32 v202, s3, v7
    s_xor_b32 s3, s38, 3
    s_mul_i32 s3, s3, 6144
    s_add_u32 s3, s3, 102400
    buffer_load_dwordx4 v245, s[16:19], s65 offen offset:1024 lds
    v_add_u32 v203, s3, v7
    s_lshl_b32 s8, s66, 2
    s_add_u32 s8, s8, s42
    s_mul_i32 s8, s8, 24
    s_add_u32 s8, s8, s67
    s_lshl_b32 s8, s8, 1
    s_add_u32 s8, s8, s41
    s_lshl_b32 s8, s8, 10
    s_add_u32 s8, s8, 13631488
    buffer_load_dwordx4 v246, s[16:19], s65 offen offset:2048 lds
    s_add_u32 s14, s8, 98304
    s_mov_b32 s9, 0xbdd2d3e8
    v_mov_b32 v206, 0xc0135761
    s_mul_i32 s11, s66, 24
    s_add_u32 s11, s11, s67
    s_lshl_b32 s11, s11, 7
    s_add_u32 s10, s11, 65536
    s_add_u32 s11, s11, 98304
    s_waitcnt vmcnt(10)
    v_min3_u32 v193, v196, v197, v198
    v_min_u32 v193, v193, v199
    v_cmp_gt_u32 vcc, 1, v193
    s_nop 0
    s_cbranch_vccz L_ok_41
    s_mov_b32 s43, 0
L_spin_42:
    s_sleep 1
    buffer_load_dwordx4 v[196:199], v7, s[28:31], s54 offen sc1
    buffer_load_dwordx4 v[112:115], v7, s[28:31], s51 offen sc1
    s_add_u32 s43, s43, 1
    s_cmp_ge_u32 s43, 20000
    s_waitcnt vmcnt(0)
    s_cbranch_scc1 L_ok_41
    v_or_b32 v196, v196, v112
    v_or_b32 v197, v197, v113
    v_or_b32 v198, v198, v114
    v_or_b32 v199, v199, v115
    v_min3_u32 v193, v196, v197, v198
    v_min_u32 v193, v193, v199
    v_cmp_gt_u32 vcc, 1, v193
    s_nop 1
    s_cbranch_vccnz L_spin_42
L_ok_41:
    v_permlane16_swap_b32 v196, v197
    v_permlane16_swap_b32 v198, v199
    v_add_f32 v196, v196, v197
    v_add_f32_e64 v198, v198, v199
    v_mov_b32 v14, 0x3f800054
    s_mov_b32 s3, 0x2edbe6ff
    v_permlane32_swap_b32 v196, v198
    v_add_f32 v196, v196, v198
    s_nop 1
    v_add_f32_dpp v196, v196, v196 row_ror:8 row_mask:0xf bank_mask:0xf
    s_nop 1
    v_mov_b32_dpp v197, v196 quad_perm:[0,1,0,1] row_mask:0xf bank_mask:0xf
    v_mov_b32_dpp v198, v196 quad_perm:[2,3,2,3] row_mask:0xf bank_mask:0xf
    v_mul_f32 v197, 0xbacccccd, v197
    v_mul_f32 v198, 0x3acccccd, v198
    v_fma_f32 v198, -v197, v197, v198
    v_max_f32 v198, 0, v198
    v_fma_f32 v198, v198, v14, s3
    v_rsq_f32 v198, v198
    s_nop 0
    v_mul_f32 v197, v197, v198
    v_cndmask_b32 v196, v197, v198, s[58:59]
    ds_write_b32 v104, v196
    ds_read_b128 v[112:115], v105 offset:0
    ds_read_b128 v[116:119], v105 offset:16
    ds_read_b128 v[120:123], v105 offset:32
    ds_read_b128 v[124:127], v105 offset:48
    buffer_load_dwordx4 v247, s[16:19], s65 offen offset:3072 lds
    ds_read_b64_tr_b16 a[0:1], v248 offset:0
    ds_read_b64_tr_b16 a[2:3], v248 offset:1024
    ds_read_b64_tr_b16 a[4:5], v249 offset:0
    ds_read_b64_tr_b16 a[6:7], v249 offset:1024
    ds_read_b64_tr_b16 a[8:9], v250 offset:0
    ds_read_b64_tr_b16 a[10:11], v250 offset:1024
    ds_read_b64_tr_b16 a[12:13], v251 offset:0
    ds_read_b64_tr_b16 a[14:15], v251 offset:1024
    s_add_u32 m0, s64, 20480
    s_mov_b32 s65, 491520
    buffer_load_dwordx4 v244, s[16:19], s65 offen offset:0 lds
    buffer_load_dwordx4 v245, s[16:19], s65 offen offset:1024 lds
    buffer_load_dwordx4 v246, s[16:19], s65 offen offset:2048 lds
    buffer_load_dwordx4 v247, s[16:19], s65 offen offset:3072 lds
    ds_read_b64_tr_b16 a[16:17], v248 offset:4096
    ds_read_b64_tr_b16 a[18:19], v248 offset:5120
    ds_read_b64_tr_b16 a[20:21], v249 offset:4096
    ds_read_b64_tr_b16 a[22:23], v249 offset:5120
    ds_read_b64_tr_b16 a[24:25], v250 offset:4096
    ds_read_b64_tr_b16 a[26:27], v250 offset:5120
    ds_read_b64_tr_b16 a[28:29], v251 offset:4096
    ds_read_b64_tr_b16 a[30:31], v251 offset:5120
    s_waitcnt lgkmcnt(8)
    s_add_u32 m0, s64, 0
    s_mov_b32 s65, 589824
    buffer_load_dwordx4 v244, s[16:19], s65 offen offset:0 lds
    v_pk_fma_f32 v[16:17], v[16:17], v[120:121], v[112:113]
    v_pk_fma_f32 v[18:19], v[18:19], v[122:123], v[114:115]
    v_pk_fma_f32 v[20:21], v[20:21], v[124:125], v[116:117]
    v_pk_fma_f32 v[22:23], v[22:23], v[126:127], v[118:119]
    v_cvt_pk_bf16_f32 v128, v16, v17
    v_cvt_pk_bf16_f32 v129, v18, v19
    v_cvt_pk_bf16_f32 v130, v20, v21
    v_cvt_pk_bf16_f32 v131, v22, v23
    buffer_store_dwordx4 v[128:131], v106, s[28:31], s48 offen sc1
    v_pk_fma_f32 v[32:33], v[32:33], v[120:121], v[112:113]
    v_pk_fma_f32 v[34:35], v[34:35], v[122:123], v[114:115]
    v_pk_fma_f32 v[36:37], v[36:37], v[124:125], v[116:117]
    v_pk_fma_f32 v[38:39], v[38:39], v[126:127], v[118:119]
    v_cvt_pk_bf16_f32 v132, v32, v33
    v_cvt_pk_bf16_f32 v133, v34, v35
    v_cvt_pk_bf16_f32 v134, v36, v37
    v_cvt_pk_bf16_f32 v135, v38, v39
    buffer_store_dwordx4 v[132:135], v106, s[28:31], s49 offen sc1
    v_pk_fma_f32 v[48:49], v[48:49], v[120:121], v[112:113]
    v_pk_fma_f32 v[50:51], v[50:51], v[122:123], v[114:115]
    v_pk_fma_f32 v[52:53], v[52:53], v[124:125], v[116:117]
    v_pk_fma_f32 v[54:55], v[54:55], v[126:127], v[118:119]
    v_cvt_pk_bf16_f32 v136, v48, v49
    v_cvt_pk_bf16_f32 v137, v50, v51
    v_cvt_pk_bf16_f32 v138, v52, v53
    v_cvt_pk_bf16_f32 v139, v54, v55
    buffer_store_dwordx4 v[136:139], v107, s[28:31], s50 offen sc1
    s_lshl_b32 s3, s67, 1
    s_add_u32 s3, s3, s41
    s_lshl_b32 s3, s3, 6
    s_min_u32 s3, s3, 3008
    v_lshl_add_u32 v8, v2, 3, s3
    global_load_dwordx2 v[10:11], v8, s[32:33]
    global_load_dwordx2 v[12:13], v8, s[32:33] offset:32
    s_lshl_b32 s3, s69, 2
    s_add_u32 s3, s3, s38
    s_lshl_b32 s3, s3, 5
    v_lshl_add_u32 v8, v1, 1, s3
    global_load_ushort v207, v8, s[34:35]
    buffer_load_dwordx4 v245, s[16:19], s65 offen offset:1024 lds
    buffer_load_dwordx4 v246, s[16:19], s65 offen offset:2048 lds
    buffer_load_dwordx4 v247, s[16:19], s65 offen offset:3072 lds
    ds_read_b64_tr_b16 a[32:33], v248 offset:8192
    ds_read_b64_tr_b16 a[34:35], v248 offset:9216
    ds_read_b64_tr_b16 a[36:37], v249 offset:8192
    ds_read_b64_tr_b16 a[38:39], v249 offset:9216
    ds_read_b64_tr_b16 a[40:41], v250 offset:8192
    ds_read_b64_tr_b16 a[42:43], v250 offset:9216
    ds_read_b64_tr_b16 a[44:45], v251 offset:8192
    ds_read_b64_tr_b16 a[46:47], v251 offset:9216
    s_waitcnt lgkmcnt(8)
    s_nop 0
    s_add_u32 m0, s64, 4096
    s_mov_b32 s65, 688128
    buffer_load_dwordx4 v244, s[16:19], s65 offen offset:0 lds
    buffer_load_dwordx4 v245, s[16:19], s65 offen offset:1024 lds
    buffer_load_dwordx4 v246, s[16:19], s65 offen offset:2048 lds
    buffer_load_dwordx4 v247, s[16:19], s65 offen offset:3072 lds
    s_waitcnt vmcnt(22)
    ds_read_b64_tr_b16 a[48:49], v248 offset:12288
    s_nop 0
    ds_read_b64_tr_b16 a[50:51], v248 offset:13312
    ds_read_b64_tr_b16 a[52:53], v249 offset:12288
    ds_read_b64_tr_b16 a[54:55], v249 offset:13312
    ds_read_b64_tr_b16 a[56:57], v250 offset:12288
    ds_read_b64_tr_b16 a[58:59], v250 offset:13312
    ds_read_b64_tr_b16 a[60:61], v251 offset:12288
    ds_read_b64_tr_b16 a[62:63], v251 offset:13312
    s_waitcnt lgkmcnt(8)
    s_nop 0
    s_add_u32 m0, s64, 8192
    s_mov_b32 s65, 786432
    buffer_load_dwordx4 v244, s[16:19], s65 offen offset:0 lds
    buffer_load_dwordx4 v245, s[16:19], s65 offen offset:1024 lds
    buffer_load_dwordx4 v246, s[16:19], s65 offen offset:2048 lds
    buffer_load_dwordx4 v247, s[16:19], s65 offen offset:3072 lds
    s_waitcnt vmcnt(22)
    ds_read_b64_tr_b16 a[64:65], v248 offset:16384
    s_nop 0
    ds_read_b64_tr_b16 a[66:67], v248 offset:17408
    ds_read_b64_tr_b16 a[68:69], v249 offset:16384
    ds_read_b64_tr_b16 a[70:71], v249 offset:17408
    ds_read_b64_tr_b16 a[72:73], v250 offset:16384
    ds_read_b64_tr_b16 a[74:75], v250 offset:17408
    ds_read_b64_tr_b16 a[76:77], v251 offset:16384
    ds_read_b64_tr_b16 a[78:79], v251 offset:17408
    s_waitcnt lgkmcnt(8)
    s_nop 0
    s_add_u32 m0, s64, 12288
L_pg10:
    s_cbranch_execz L_ret
    s_mov_b32 s65, 884736
    buffer_load_dwordx4 v244, s[16:19], s65 offen offset:0 lds
    buffer_load_dwordx4 v245, s[16:19], s65 offen offset:1024 lds
    buffer_load_dwordx4 v246, s[16:19], s65 offen offset:2048 lds
    s_waitcnt vmcnt(17)
    s_barrier
    buffer_store_dword v253, v252, s[28:31], s52 offen sc1
    v_lshlrev_b32 v9, 1, v2
    buffer_load_dwordx4 v247, s[16:19], s65 offen offset:3072 lds
    v_and_b32 v8, 7, v0
    ds_read_b64_tr_b16 a[80:81], v248 offset:20480
    v_xor_b32 v8, v8, v9
    v_lshrrev_b32_e64 v9, 3, v0
    ds_read_b64_tr_b16 a[82:83], v248 offset:21504
    v_mul_u32_u24 v9, 4096, v9
    v_lshl_add_u32 v8, v8, 4, v9
    ds_read_b64_tr_b16 a[84:85], v249 offset:20480
    s_mul_i32 s3, s38, 12288
    s_add_u32 s3, s3, s69
    ds_read_b64_tr_b16 a[86:87], v249 offset:21504
    s_lshl_b32 s3, s3, 7
    v_add_u32_e64 v224, s3, v8
    ds_read_b64_tr_b16 a[88:89], v250 offset:20480
    v_add_u32 v225, 31744, v224
    ds_read_b64_tr_b16 a[90:91], v250 offset:21504
    v_add_u32 v226, 63488, v224
    v_add_u32 v227, 95232, v224
    ds_read_b64_tr_b16 a[92:93], v251 offset:20480
    v_lshl_add_u32 v8, v6, 2, v4
    v_lshrrev_b32_e64 v9, 1, v8
    ds_read_b64_tr_b16 a[94:95], v251 offset:21504
    v_lshl_add_u32 v8, v3, 3, v8
    v_lshlrev_b32 v8, 7, v8
    s_waitcnt lgkmcnt(8)
    s_add_u32 m0, s64, 16384
    s_mov_b32 s65, 983040
    buffer_load_dwordx4 v244, s[16:19], s65 offen offset:0 lds
    v_lshl_add_u32 v8, v5, 3, v8
    v_xor_b32_e64 v9, s38, v9
    buffer_load_dwordx4 v245, s[16:19], s65 offen offset:1024 lds
    v_lshl_add_u32 v8, v9, 5, v8
    v_add_u32 v228, s64, v8
    buffer_load_dwordx4 v246, s[16:19], s65 offen offset:2048 lds
    v_xor_b32 v229, 32, v228
    buffer_load_dwordx4 v247, s[16:19], s65 offen offset:3072 lds
    v_xor_b32 v230, 64, v228
    v_xor_b32 v231, 96, v228
    s_waitcnt vmcnt(17)
    ds_read_b64_tr_b16 a[96:97], v248 offset:0
    v_lshlrev_b32 v16, 16, v10
    v_and_b32 v17, 0xffff0000, v10
    ds_read_b64_tr_b16 a[98:99], v248 offset:1024
    v_lshlrev_b32 v48, 16, v10
    v_and_b32 v49, 0xffff0000, v10
    ds_read_b64_tr_b16 a[100:101], v249 offset:0
    v_lshlrev_b32 v18, 16, v11
    v_and_b32 v19, 0xffff0000, v11
    ds_read_b64_tr_b16 a[102:103], v249 offset:1024
    v_lshlrev_b32 v50, 16, v11
    ds_read_b64_tr_b16 a[104:105], v250 offset:0
    v_and_b32 v51, 0xffff0000, v11
    v_lshlrev_b32_e64 v20, 16, v12
    ds_read_b64_tr_b16 a[106:107], v250 offset:1024
    v_and_b32 v21, 0xffff0000, v12
    v_lshlrev_b32 v52, 16, v12
    ds_read_b64_tr_b16 a[108:109], v251 offset:0
    v_and_b32 v53, 0xffff0000, v12
    v_lshlrev_b32 v22, 16, v13
    ds_read_b64_tr_b16 a[110:111], v251 offset:1024
    v_and_b32 v23, 0xffff0000, v13
    v_lshlrev_b32 v54, 16, v13
    s_waitcnt lgkmcnt(8)
    s_add_u32 m0, s64, 20480
    s_mov_b32 s65, 1081344
    buffer_load_dwordx4 v244, s[16:19], s65 offen offset:0 lds
    v_and_b32 v55, 0xffff0000, v13
L_phaseC:
    s_cmp_ge_u32 s40, 30
    s_cbranch_scc1 L_cidle
    buffer_load_dwordx4 v245, s[16:19], s65 offen offset:1024 lds
    buffer_load_dwordx4 v246, s[16:19], s65 offen offset:2048 lds
    buffer_load_dwordx4 v247, s[16:19], s65 offen offset:3072 lds
    s_waitcnt vmcnt(17)
    s_nop 0
    ds_read_b64_tr_b16 a[112:113], v248 offset:4096
    ds_read_b64_tr_b16 a[114:115], v248 offset:5120
    ds_read_b64_tr_b16 a[116:117], v249 offset:4096
    ds_read_b64_tr_b16 a[118:119], v249 offset:5120
    ds_read_b64_tr_b16 a[120:121], v250 offset:4096
    ds_read_b64_tr_b16 a[122:123], v250 offset:5120
    ds_read_b64_tr_b16 a[124:125], v251 offset:4096
    ds_read_b64_tr_b16 a[126:127], v251 offset:5120
    s_waitcnt lgkmcnt(8)
    s_add_u32 m0, s64, 0
    s_mov_b32 s65, 1179648
    buffer_load_dwordx4 v244, s[16:19], s65 offen offset:0 lds
    buffer_load_dwordx4 v245, s[16:19], s65 offen offset:1024 lds
    buffer_load_dwordx4 v246, s[16:19], s65 offen offset:2048 lds
    buffer_load_dwordx4 v247, s[16:19], s65 offen offset:3072 lds
    s_waitcnt vmcnt(17)
    ds_read_b64_tr_b16 a[128:129], v248 offset:8192
    s_nop 0
    ds_read_b64_tr_b16 a[130:131], v248 offset:9216
    ds_read_b64_tr_b16 a[132:133], v249 offset:8192
    ds_read_b64_tr_b16 a[134:135], v249 offset:9216
    ds_read_b64_tr_b16 a[136:137], v250 offset:8192
    ds_read_b64_tr_b16 a[138:139], v250 offset:9216
    ds_read_b64_tr_b16 a[140:141], v251 offset:8192
    ds_read_b64_tr_b16 a[142:143], v251 offset:9216
    s_waitcnt lgkmcnt(8)
    s_nop 0
    s_add_u32 m0, s64, 4096
    s_mov_b32 s65, 1277952
    buffer_load_dwordx4 v244, s[16:19], s65 offen offset:0 lds
    buffer_load_dwordx4 v245, s[16:19], s65 offen offset:1024 lds
    buffer_load_dwordx4 v246, s[16:19], s65 offen offset:2048 lds
    buffer_load_dwordx4 v247, s[16:19], s65 offen offset:3072 lds
    s_waitcnt vmcnt(16)
    ds_read_b64_tr_b16 a[144:145], v248 offset:12288
    s_nop 0
    ds_read_b64_tr_b16 a[146:147], v248 offset:13312
    ds_read_b64_tr_b16 a[148:149], v249 offset:12288
    ds_read_b64_tr_b16 a[150:151], v249 offset:13312
    ds_read_b64_tr_b16 a[152:153], v250 offset:12288
    ds_read_b64_tr_b16 a[154:155], v250 offset:13312
    ds_read_b64_tr_b16 a[156:157], v251 offset:12288
    ds_read_b64_tr_b16 a[158:159], v251 offset:13312
    s_waitcnt lgkmcnt(8)
    s_nop 0
    s_add_u32 m0, s64, 8192
    s_mov_b32 s65, 1376256
    buffer_load_dwordx4 v244, s[16:19], s65 offen offset:0 lds
    buffer_load_dwordx4 v245, s[16:19], s65 offen offset:1024 lds
    buffer_load_dwordx4 v246, s[16:19], s65 offen offset:2048 lds
    buffer_load_dwordx4 v247, s[16:19], s65 offen offset:3072 lds
    s_waitcnt vmcnt(16)
    ds_read_b64_tr_b16 a[160:161], v248 offset:16384
    s_nop 0
    ds_read_b64_tr_b16 a[162:163], v248 offset:17408
    ds_read_b64_tr_b16 a[164:165], v249 offset:16384
    ds_read_b64_tr_b16 a[166:167], v249 offset:17408
    ds_read_b64_tr_b16 a[168:169], v250 offset:16384
    ds_read_b64_tr_b16 a[170:171], v250 offset:17408
    ds_read_b64_tr_b16 a[172:173], v251 offset:16384
    ds_read_b64_tr_b16 a[174:175], v251 offset:17408
    s_waitcnt lgkmcnt(8)
    s_nop 0
    s_add_u32 m0, s64, 12288
    s_mov_b32 s65, 1474560
    buffer_load_dwordx4 v244, s[16:19], s65 offen offset:0 lds
    buffer_load_dwordx4 v245, s[16:19], s65 offen offset:1024 lds
    buffer_load_dwordx4 v246, s[16:19], s65 offen offset:2048 lds
    buffer_load_dwordx4 v247, s[16:19], s65 offen offset:3072 lds
    s_waitcnt vmcnt(16)
    ds_read_b64_tr_b16 a[176:177], v248 offset:20480
    s_nop 0
    ds_read_b64_tr_b16 a[178:179], v248 offset:21504
    ds_read_b64_tr_b16 a[180:181], v249 offset:20480
    ds_read_b64_tr_b16 a[182:183], v249 offset:21504
    ds_read_b64_tr_b16 a[184:185], v250 offset:20480
    ds_read_b64_tr_b16 a[186:187], v250 offset:21504
    ds_read_b64_tr_b16 a[188:189], v251 offset:20480
    ds_read_b64_tr_b16 a[190:191], v251 offset:21504
    s_waitcnt lgkmcnt(8)
    s_add_u32 m0, s64, 16384
    s_mov_b32 s65, 0
    buffer_load_dwordx4 v224, s[20:23], s65 offen offset:0 lds
    buffer_load_dwordx4 v225, s[20:23], s65 offen offset:1024 lds
    buffer_load_dword v242, v243, s[28:31], s13 offen sc1
    buffer_load_dwordx4 v226, s[20:23], s65 offen offset:2048 lds
    buffer_load_dwordx4 v227, s[20:23], s65 offen offset:3072 lds
    s_waitcnt vmcnt(17)
    ds_read_b64_tr_b16 a[192:193], v248 offset:0
    s_nop 0
    ds_read_b64_tr_b16 a[194:195], v248 offset:1024
    ds_read_b64_tr_b16 a[196:197], v249 offset:0
    ds_read_b64_tr_b16 a[198:199], v249 offset:1024
    ds_read_b64_tr_b16 a[200:201], v250 offset:0
    ds_read_b64_tr_b16 a[202:203], v250 offset:1024
    ds_read_b64_tr_b16 a[204:205], v251 offset:0
    ds_read_b64_tr_b16 a[206:207], v251 offset:1024
    s_waitcnt lgkmcnt(8)
    s_nop 0
    s_add_u32 m0, s64, 20480
    s_mov_b32 s65, 131072
    buffer_load_dwordx4 v224, s[20:23], s65 offen offset:0 lds
    buffer_load_dwordx4 v225, s[20:23], s65 offen offset:1024 lds
    buffer_load_dwordx4 v226, s[20:23], s65 offen offset:2048 lds
    buffer_load_dwordx4 v227, s[20:23], s65 offen offset:3072 lds
    s_waitcnt vmcnt(17)
    ds_read_b64_tr_b16 a[208:209], v248 offset:4096
    s_nop 0
    ds_read_b64_tr_b16 a[210:211], v248 offset:5120
    ds_read_b64_tr_b16 a[212:213], v249 offset:4096
    ds_read_b64_tr_b16 a[214:215], v249 offset:5120
    ds_read_b64_tr_b16 a[216:217], v250 offset:4096
    ds_read_b64_tr_b16 a[218:219], v250 offset:5120
    ds_read_b64_tr_b16 a[220:221], v251 offset:4096
    ds_read_b64_tr_b16 a[222:223], v251 offset:5120
    s_waitcnt lgkmcnt(8)
    s_add_u32 m0, s64, 0
    s_mov_b32 s65, 262144
    buffer_load_dwordx4 v224, s[20:23], s65 offen offset:0 lds
    buffer_load_dwordx4 v225, s[20:23], s65 offen offset:1024 lds
    buffer_load_dwordx4 v226, s[20:23], s65 offen offset:2048 lds
    buffer_load_dwordx4 v227, s[20:23], s65 offen offset:3072 lds
    s_waitcnt vmcnt(10)
    v_cmp_gt_u32 vcc, 1, v242
    s_nop 0
    s_cbranch_vccz L_ok_43
    s_mov_b32 s43, 0
L_spin_44:
    s_sleep 4
    buffer_load_dword v242, v243, s[28:31], s13 offen sc1
    s_add_u32 s43, s43, 1
    s_cmp_ge_u32 s43, 20000
    s_waitcnt vmcnt(0)
    s_cbranch_scc1 L_ok_43
    v_cmp_gt_u32 vcc, 1, v242
    s_nop 1
    s_cbranch_vccnz L_spin_44
L_ok_43:
    s_mov_b32 s12, 0
    buffer_load_dwordx4 v[80:83], v205, s[28:31], s12 offen offset:0 sc1
    ds_read_b64_tr_b16 a[224:225], v248 offset:8192
    s_nop 0
    ds_read_b64_tr_b16 a[226:227], v248 offset:9216
    buffer_load_dwordx4 v[84:87], v205, s[28:31], s12 offen offset:2048 sc1
    ds_read_b64_tr_b16 a[228:229], v249 offset:8192
    ds_read_b64_tr_b16 a[230:231], v249 offset:9216
    s_mov_b32 s12, 4096
    buffer_load_dwordx4 v[88:91], v205, s[28:31], s12 offen offset:0 sc1
    ds_read_b64_tr_b16 a[232:233], v250 offset:8192
    buffer_load_dwordx4 v[92:95], v205, s[28:31], s12 offen offset:2048 sc1
    ds_read_b64_tr_b16 a[234:235], v250 offset:9216
    ds_read_b64_tr_b16 a[236:237], v251 offset:8192
    s_mov_b32 s12, 8192
    buffer_load_dwordx4 v[96:99], v205, s[28:31], s12 offen offset:0 sc1
    ds_read_b64_tr_b16 a[238:239], v251 offset:9216
    buffer_load_dwordx4 v[100:103], v205, s[28:31], s12 offen offset:2048 sc1
    ds_read_b64_tr_b16 a[240:241], v248 offset:12288
    ds_read_b64_tr_b16 a[242:243], v248 offset:13312
    s_mov_b32 s12, 12288
    buffer_load_dwordx4 v[104:107], v205, s[28:31], s12 offen offset:0 sc1
    ds_read_b64_tr_b16 a[244:245], v249 offset:12288
    ds_read_b64_tr_b16 a[246:247], v249 offset:13312
    buffer_load_dwordx4 v[108:111], v205, s[28:31], s12 offen offset:2048 sc1
    ds_read_b64_tr_b16 a[248:249], v250 offset:12288
    s_mov_b32 s12, 16384
    buffer_load_dwordx4 v[112:115], v205, s[28:31], s12 offen offset:0 sc1
    ds_read_b64_tr_b16 a[250:251], v250 offset:13312
    ds_read_b64_tr_b16 a[252:253], v251 offset:12288
    buffer_load_dwordx4 v[116:119], v205, s[28:31], s12 offen offset:2048 sc1
    ds_read_b64_tr_b16 a[254:255], v251 offset:13312
    s_waitcnt vmcnt(8)
    v_mfma_f32_16x16x32_bf16 v[40:43], a[24:27], v[84:87], 0
    s_mov_b32 s12, 20480
    v_mfma_f32_16x16x32_bf16 v[40:43], a[8:11], v[80:83], v[40:43]
    buffer_load_dwordx4 v[120:123], v205, s[28:31], s12 offen offset:0 sc1
    v_mfma_f32_16x16x32_bf16 v[44:47], a[12:15], v[80:83], 0
    v_mfma_f32_16x16x32_bf16 v[44:47], a[28:31], v[84:87], v[44:47]
    v_mfma_f32_16x16x32_bf16 v[24:27], a[16:19], v[84:87], 0
    s_and_b32 s49, s68, 1
    s_mul_i32 s3, s68, 5
    v_mfma_f32_16x16x32_bf16 v[24:27], a[0:3], v[80:83], v[24:27]
    buffer_load_dwordx4 v[124:127], v205, s[28:31], s12 offen offset:2048 sc1
    v_mfma_f32_16x16x32_bf16 v[28:31], a[4:7], v[80:83], 0
    s_add_u32 s46, s3, 4
    v_mfma_f32_16x16x32_bf16 v[28:31], a[20:23], v[84:87], v[28:31]
    s_lshl_b32 s50, s49, 2
    s_waitcnt vmcnt(8)
    v_mfma_f32_16x16x32_bf16 v[40:43], a[56:59], v[92:95], v[40:43]
    s_mov_b32 s12, 24576
    s_sub_u32 s46, s46, s50
    s_add_u32 s3, s3, 1
    v_mfma_f32_16x16x32_bf16 v[40:43], a[40:43], v[88:91], v[40:43]
    buffer_load_dwordx4 v[128:131], v205, s[28:31], s12 offen offset:0 sc1
    v_mfma_f32_16x16x32_bf16 v[44:47], a[44:47], v[88:91], v[44:47]
    s_lshr_b32 s3, s3, 1
    v_mfma_f32_16x16x32_bf16 v[44:47], a[60:63], v[92:95], v[44:47]
    s_add_u32 s44, s3, 1
    v_mfma_f32_16x16x32_bf16 v[24:27], a[48:51], v[92:95], v[24:27]
    s_and_b32 s44, s44, 0xfe
    v_mfma_f32_16x16x32_bf16 v[24:27], a[32:35], v[88:91], v[24:27]
    buffer_load_dwordx4 v[132:135], v205, s[28:31], s12 offen offset:2048 sc1
    v_mfma_f32_16x16x32_bf16 v[28:31], a[36:39], v[88:91], v[28:31]
    s_or_b32 s45, s3, 1
    s_mul_i32 s50, s38, 768
    v_mfma_f32_16x16x32_bf16 v[28:31], a[52:55], v[92:95], v[28:31]
    s_mul_i32 s47, s44, 1536
    s_waitcnt vmcnt(8)
    v_mfma_f32_16x16x32_bf16 v[40:43], a[88:91], v[100:103], v[40:43]
    s_mov_b32 s12, 28672
    s_add_u32 s47, s47, s50
    v_mfma_f32_16x16x32_bf16 v[40:43], a[72:75], v[96:99], v[40:43]
    buffer_load_dwordx4 v[136:139], v205, s[28:31], s12 offen offset:0 sc1
    v_mfma_f32_16x16x32_bf16 v[44:47], a[76:79], v[96:99], v[44:47]
    s_add_u32 s47, s47, 65536
    v_mfma_f32_16x16x32_bf16 v[44:47], a[92:95], v[100:103], v[44:47]
    v_min_u32 v8, 5, v0
    v_lshlrev_b32_e64 v243, 7, v8
    v_mfma_f32_16x16x32_bf16 v[24:27], a[80:83], v[100:103], v[24:27]
    s_lshr_b32 s3, s45, 1
    v_mfma_f32_16x16x32_bf16 v[24:27], a[64:67], v[96:99], v[24:27]
    buffer_load_dwordx4 v[140:143], v205, s[28:31], s12 offen offset:2048 sc1
    v_mfma_f32_16x16x32_bf16 v[28:31], a[68:71], v[96:99], v[28:31]
    s_mul_i32 s48, s3, 3072
    v_mfma_f32_16x16x32_bf16 v[28:31], a[84:87], v[100:103], v[28:31]
    s_add_u32 s48, s48, 98304
    s_waitcnt vmcnt(8)
    v_mfma_f32_16x16x32_bf16 v[40:43], a[120:123], v[108:111], v[40:43]
    s_mov_b32 s12, 0
    s_lshr_b32 s3, s46, 2
    s_mul_i32 s3, s3, 3072
    v_mfma_f32_16x16x32_bf16 v[40:43], a[104:107], v[104:107], v[40:43]
    buffer_load_dwordx4 v[144:147], v204, s[28:31], s12 offen offset:0 sc1
    v_mfma_f32_16x16x32_bf16 v[44:47], a[108:111], v[104:107], v[44:47]
    s_and_b32 s62, s46, 2
    v_mfma_f32_16x16x32_bf16 v[44:47], a[124:127], v[108:111], v[44:47]
    s_mul_i32 s62, s62, 16384
    v_mfma_f32_16x16x32_bf16 v[24:27], a[112:115], v[108:111], v[24:27]
    s_add_u32 s3, s3, s62
    v_mfma_f32_16x16x32_bf16 v[24:27], a[96:99], v[104:107], v[24:27]
    buffer_load_dwordx4 v[148:151], v204, s[28:31], s12 offen offset:2048 sc1
    v_mfma_f32_16x16x32_bf16 v[28:31], a[100:103], v[104:107], v[28:31]
    s_add_u32 s3, s3, 65536
    v_mov_b32 v9, s48
    v_mfma_f32_16x16x32_bf16 v[28:31], a[116:119], v[108:111], v[28:31]
    v_mov_b32 v10, s3
    s_waitcnt vmcnt(8)
    v_mfma_f32_16x16x32_bf16 v[40:43], a[152:155], v[116:119], v[40:43]
    s_mov_b32 s12, 4096
    v_lshrrev_b32 v8, 1, v0
    v_mfma_f32_16x16x32_bf16 v[40:43], a[136:139], v[112:115], v[40:43]
    buffer_load_dwordx4 v[152:155], v204, s[28:31], s12 offen offset:0 sc1
    v_mfma_f32_16x16x32_bf16 v[44:47], a[140:143], v[112:115], v[44:47]
    v_min_u32_e64 v8, 5, v8
    v_mfma_f32_16x16x32_bf16 v[44:47], a[156:159], v[116:119], v[44:47]
    v_cndmask_b32 v9, v9, v10, s[56:57]
    v_lshl_add_u32 v239, v8, 7, v9
    v_mfma_f32_16x16x32_bf16 v[24:27], a[144:147], v[116:119], v[24:27]
    s_lshl_b32 s51, s69, 2
    v_mfma_f32_16x16x32_bf16 v[24:27], a[128:131], v[112:115], v[24:27]
    buffer_load_dwordx4 v[156:159], v204, s[28:31], s12 offen offset:2048 sc1
    v_mfma_f32_16x16x32_bf16 v[28:31], a[132:135], v[112:115], v[28:31]
    s_add_u32 s51, s51, s38
    v_mfma_f32_16x16x32_bf16 v[28:31], a[148:151], v[116:119], v[28:31]
    v_lshl_add_u32 v10, v4, 3, v5
    s_waitcnt vmcnt(8)
    v_mfma_f32_16x16x32_bf16 v[40:43], a[184:187], v[124:127], v[40:43]
    s_mov_b32 s12, 8192
    v_lshlrev_b32 v10, 4, v10
    v_lshl_add_u32 v10, v2, 9, v10
    v_mfma_f32_16x16x32_bf16 v[40:43], a[168:171], v[120:123], v[40:43]
    buffer_load_dwordx4 v[80:83], v204, s[28:31], s12 offen offset:0 sc1
    v_mfma_f32_16x16x32_bf16 v[44:47], a[172:175], v[120:123], v[44:47]
    v_lshlrev_b32 v11, 4, v1
    v_mfma_f32_16x16x32_bf16 v[44:47], a[188:191], v[124:127], v[44:47]
    v_cmp_gt_u32 vcc, 2, v2
    v_mfma_f32_16x16x32_bf16 v[24:27], a[176:179], v[124:127], v[24:27]
    v_lshl_add_u32 v11, v2, 9, v11
    v_mfma_f32_16x16x32_bf16 v[24:27], a[160:163], v[120:123], v[24:27]
    buffer_load_dwordx4 v[84:87], v204, s[28:31], s12 offen offset:2048 sc1
    v_mfma_f32_16x16x32_bf16 v[28:31], a[164:167], v[120:123], v[28:31]
    v_mov_b32 v12, 1073741824
    v_cndmask_b32 v216, v12, v10, vcc
    v_mfma_f32_16x16x32_bf16 v[28:31], a[180:183], v[124:127], v[28:31]
    v_cndmask_b32 v217, v12, v11, vcc
    s_waitcnt vmcnt(8) lgkmcnt(14)
    v_mfma_f32_16x16x32_bf16 v[40:43], a[216:219], v[132:135], v[40:43]
    s_mov_b32 s12, 12288
    s_lshl_b32 s48, s51, 10
    v_mfma_f32_16x16x32_bf16 v[40:43], a[200:203], v[128:131], v[40:43]
    buffer_load_dwordx4 v[88:91], v204, s[28:31], s12 offen offset:0 sc1
    v_mfma_f32_16x16x32_bf16 v[44:47], a[204:207], v[128:131], v[44:47]
    s_add_u32 s48, s48, 5242880
    v_mfma_f32_16x16x32_bf16 v[44:47], a[220:223], v[132:135], v[44:47]
    s_lshl_b32 s3, s44, 17
    s_add_u32 s60, s3, s48
    v_mfma_f32_16x16x32_bf16 v[24:27], a[208:211], v[132:135], v[24:27]
    s_lshl_b32 s3, s45, 17
    v_mfma_f32_16x16x32_bf16 v[24:27], a[192:195], v[128:131], v[24:27]
    buffer_load_dwordx4 v[92:95], v204, s[28:31], s12 offen offset:2048 sc1
    v_mfma_f32_16x16x32_bf16 v[28:31], a[196:199], v[128:131], v[28:31]
    s_add_u32 s61, s3, s48
    v_mfma_f32_16x16x32_bf16 v[28:31], a[212:215], v[132:135], v[28:31]
    s_lshr_b32 s3, s46, 1
    s_waitcnt vmcnt(8) lgkmcnt(2)
    v_mfma_f32_16x16x32_bf16 v[40:43], a[248:251], v[140:143], v[40:43]
    s_mov_b32 s12, 16384
    s_lshl_b32 s3, s3, 17
    s_add_u32 s3, s3, s48
    v_mfma_f32_16x16x32_bf16 v[40:43], a[232:235], v[136:139], v[40:43]
    buffer_load_dwordx4 v[96:99], v204, s[28:31], s12 offen offset:0 sc1
    v_mfma_f32_16x16x32_bf16 v[44:47], a[236:239], v[136:139], v[44:47]
    s_lshl_b32 s62, s49, 8
    s_waitcnt lgkmcnt(0)
    v_mfma_f32_16x16x32_bf16 v[44:47], a[252:255], v[140:143], v[44:47]
    s_add_u32 s67, s3, s62
    v_mfma_f32_16x16x32_bf16 v[24:27], a[240:243], v[140:143], v[24:27]
    v_lshlrev_b32_e64 v12, 2, v2
    v_mfma_f32_16x16x32_bf16 v[24:27], a[224:227], v[136:139], v[24:27]
    buffer_load_dwordx4 v[100:103], v204, s[28:31], s12 offen offset:2048 sc1
    v_mfma_f32_16x16x32_bf16 v[28:31], a[228:231], v[136:139], v[28:31]
    v_sub_u32 v12, v1, v12
    v_cndmask_b32 v12, 64, v12, vcc
    v_mfma_f32_16x16x32_bf16 v[28:31], a[244:247], v[140:143], v[28:31]
    v_and_b32 v13, 1, v12
    s_waitcnt vmcnt(8)
    v_mfma_f32_16x16x32_bf16 v[32:35], a[24:27], v[148:151], 0
    s_mov_b32 s12, 20480
    v_lshlrev_b32 v13, 4, v13
    v_mfma_f32_16x16x32_bf16 v[32:35], a[8:11], v[144:147], v[32:35]
    buffer_load_dwordx4 v[104:107], v204, s[28:31], s12 offen offset:0 sc1
    v_mfma_f32_16x16x32_bf16 v[36:39], a[12:15], v[144:147], 0
    v_lshlrev_b32 v13, v13, v253
    v_mfma_f32_16x16x32_bf16 v[36:39], a[28:31], v[148:151], v[36:39]
    v_mul_u32_u24 v13, 0x3f80, v13
    v_lshrrev_b32 v12, 1, v12
    v_mfma_f32_16x16x32_bf16 v[16:19], a[16:19], v[148:151], v[16:19]
    v_cmp_eq_u32 vcc, 0, v12
    ds_write_b128 v201, v[24:27] offset:0
    v_mfma_f32_16x16x32_bf16 v[16:19], a[0:3], v[144:147], v[16:19]
    buffer_load_dwordx4 v[108:111], v204, s[28:31], s12 offen offset:2048 sc1
    v_mfma_f32_16x16x32_bf16 v[20:23], a[4:7], v[144:147], v[20:23]
    v_cmp_eq_u32 s[62:63], 1, v12
    v_mfma_f32_16x16x32_bf16 v[20:23], a[20:23], v[148:151], v[20:23]
    v_lshlrev_b32 v212, 16, v207
    s_waitcnt vmcnt(8)
    v_mfma_f32_16x16x32_bf16 v[32:35], a[56:59], v[156:159], v[32:35]
    s_mov_b32 s12, 24576
    v_lshlrev_b32 v213, 16, v207
    v_cndmask_b32 v208, 0, v13, vcc
    v_mfma_f32_16x16x32_bf16 v[32:35], a[40:43], v[152:155], v[32:35]
    buffer_load_dwordx4 v[112:115], v204, s[28:31], s12 offen offset:0 sc1
    v_mfma_f32_16x16x32_bf16 v[36:39], a[44:47], v[152:155], v[36:39]
    v_cndmask_b32 v209, 0, v13, s[62:63]
    ds_write_b128 v201, v[28:31] offset:1024
    v_mfma_f32_16x16x32_bf16 v[36:39], a[60:63], v[156:159], v[36:39]
    v_cmp_eq_u32 vcc, 4, v12
    v_mfma_f32_16x16x32_bf16 v[16:19], a[48:51], v[156:159], v[16:19]
    v_cmp_eq_u32 s[62:63], 5, v12
    v_mfma_f32_16x16x32_bf16 v[16:19], a[32:35], v[152:155], v[16:19]
    buffer_load_dwordx4 v[116:119], v204, s[28:31], s12 offen offset:2048 sc1
    v_mfma_f32_16x16x32_bf16 v[20:23], a[36:39], v[152:155], v[20:23]
    v_lshlrev_b32 v214, 16, v207
    v_lshlrev_b32 v215, 16, v207
    v_mfma_f32_16x16x32_bf16 v[20:23], a[52:55], v[156:159], v[20:23]
    v_cndmask_b32 v210, 0, v13, vcc
    s_waitcnt vmcnt(8)
    v_mfma_f32_16x16x32_bf16 v[32:35], a[88:91], v[84:87], v[32:35]
    s_mov_b32 s12, 28672
    v_cndmask_b32 v211, 0, v13, s[62:63]
    s_nop 0
    ds_write_b128 v203, v[40:43] offset:0
    v_mfma_f32_16x16x32_bf16 v[32:35], a[72:75], v[80:83], v[32:35]
    buffer_load_dwordx4 v[120:123], v204, s[28:31], s12 offen offset:0 sc1
    v_mfma_f32_16x16x32_bf16 v[36:39], a[76:79], v[80:83], v[36:39]
    s_mul_i32 s48, s38, 12288
    v_mfma_f32_16x16x32_bf16 v[36:39], a[92:95], v[84:87], v[36:39]
    s_add_u32 s48, s48, 13631488
    s_mul_i32 s52, s44, 98304
    v_mfma_f32_16x16x32_bf16 v[16:19], a[80:83], v[84:87], v[16:19]
    s_add_u32 s52, s52, s48
    v_mfma_f32_16x16x32_bf16 v[16:19], a[64:67], v[80:83], v[16:19]
    buffer_load_dwordx4 v[124:127], v204, s[28:31], s12 offen offset:2048 sc1
    s_nop 0
    v_mfma_f32_16x16x32_bf16 v[20:23], a[68:71], v[80:83], v[20:23]
    s_add_u32 s53, s52, 49152
    ds_write_b128 v203, v[44:47] offset:1024
    v_mfma_f32_16x16x32_bf16 v[20:23], a[84:87], v[84:87], v[20:23]
    s_mul_i32 s54, s45, 98304
    s_waitcnt vmcnt(8)
    v_mfma_f32_16x16x32_bf16 v[32:35], a[120:123], v[92:95], v[32:35]
    s_mov_b32 s12, 131072
    s_add_u32 s54, s54, s48
    s_add_u32 s55, s54, 49152
    v_mfma_f32_16x16x32_bf16 v[32:35], a[104:107], v[88:91], v[32:35]
    buffer_load_dwordx4 v[128:131], v205, s[28:31], s12 offen offset:0 sc1
    v_mfma_f32_16x16x32_bf16 v[36:39], a[108:111], v[88:91], v[36:39]
    s_mul_i32 s66, s46, 49152
    v_mfma_f32_16x16x32_bf16 v[36:39], a[124:127], v[92:95], v[36:39]
    s_add_u32 s66, s66, s48
    v_mfma_f32_16x16x32_bf16 v[16:19], a[112:115], v[92:95], v[16:19]
    v_mov_b32 v236, v7
    v_mfma_f32_16x16x32_bf16 v[16:19], a[96:99], v[88:91], v[16:19]
    buffer_load_dwordx4 v[132:135], v205, s[28:31], s12 offen offset:2048 sc1
    v_mfma_f32_16x16x32_bf16 v[20:23], a[100:103], v[88:91], v[20:23]
    v_add_u32 v237, 4096, v7
    v_add_u32 v238, 8192, v7
    v_mfma_f32_16x16x32_bf16 v[20:23], a[116:119], v[92:95], v[20:23]
    s_xor_b32 s3, s38, 1
    s_waitcnt vmcnt(8)
    v_mfma_f32_16x16x32_bf16 v[32:35], a[152:155], v[100:103], v[32:35]
    s_mov_b32 s12, 135168
    s_mul_i32 s3, s3, 15360
    v_mfma_f32_16x16x32_bf16 v[32:35], a[136:139], v[96:99], v[32:35]
    buffer_load_dwordx4 v[136:139], v205, s[28:31], s12 offen offset:0 sc1
    v_mfma_f32_16x16x32_bf16 v[36:39], a[140:143], v[96:99], v[36:39]
    s_add_u32 s3, s3, 98304
    v_mfma_f32_16x16x32_bf16 v[36:39], a[156:159], v[100:103], v[36:39]
    v_add_u32 v9, s3, v7
    s_xor_b32 s3, s38, 2
    v_mfma_f32_16x16x32_bf16 v[16:19], a[144:147], v[100:103], v[16:19]
    s_mul_i32 s3, s3, 15360
    v_mfma_f32_16x16x32_bf16 v[16:19], a[128:131], v[96:99], v[16:19]
    buffer_load_dwordx4 v[140:143], v205, s[28:31], s12 offen offset:2048 sc1
    v_mfma_f32_16x16x32_bf16 v[20:23], a[132:135], v[96:99], v[20:23]
    s_add_u32 s3, s3, 99328
    v_mfma_f32_16x16x32_bf16 v[20:23], a[148:151], v[100:103], v[20:23]
    v_add_u32 v10, s3, v7
    s_waitcnt vmcnt(8)
    v_mfma_f32_16x16x32_bf16 v[32:35], a[184:187], v[108:111], v[32:35]
    s_mov_b32 s12, 139264
    s_xor_b32 s3, s38, 3
    s_mul_i32 s3, s3, 15360
    s_nop 0
    v_mfma_f32_16x16x32_bf16 v[32:35], a[168:171], v[104:107], v[32:35]
    buffer_load_dwordx4 v[144:147], v205, s[28:31], s12 offen offset:0 sc1
    v_mfma_f32_16x16x32_bf16 v[36:39], a[172:175], v[104:107], v[36:39]
    s_add_u32 s3, s3, 100352
    v_mfma_f32_16x16x32_bf16 v[36:39], a[188:191], v[108:111], v[36:39]
    v_add_u32_e64 v11, s3, v7
    v_mfma_f32_16x16x32_bf16 v[16:19], a[176:179], v[108:111], v[16:19]
    s_mul_i32 s3, s38, 15360
    v_mfma_f32_16x16x32_bf16 v[16:19], a[160:163], v[104:107], v[16:19]
    buffer_load_dwordx4 v[148:151], v205, s[28:31], s12 offen offset:2048 sc1
    v_mfma_f32_16x16x32_bf16 v[20:23], a[164:167], v[104:107], v[20:23]
    s_add_u32 s3, s3, 98304
    v_add_u32_e64 v8, s3, v7
    v_mfma_f32_16x16x32_bf16 v[20:23], a[180:183], v[108:111], v[20:23]
    s_lshl_b32 s3, s51, 4
    s_waitcnt vmcnt(8)
    v_mfma_f32_16x16x32_bf16 v[32:35], a[216:219], v[116:119], v[32:35]
    s_mov_b32 s12, 143360
    v_add_u32_e64 v12, s3, v1
    v_mfma_f32_16x16x32_bf16 v[32:35], a[200:203], v[112:115], v[32:35]
    buffer_load_dwordx4 v[152:155], v205, s[28:31], s12 offen offset:0 sc1
    v_mfma_f32_16x16x32_bf16 v[36:39], a[204:207], v[112:115], v[36:39]
    v_mul_u32_u24 v12, 1280, v12
    v_mfma_f32_16x16x32_bf16 v[36:39], a[220:223], v[116:119], v[36:39]
    v_lshl_add_u32 v13, v2, 3, v12
    v_lshl_add_u32 v12, v2, 4, v12
    v_mfma_f32_16x16x32_bf16 v[16:19], a[208:211], v[116:119], v[16:19]
    s_lshl_b32 s44, s44, 6
    v_mfma_f32_16x16x32_bf16 v[16:19], a[192:195], v[112:115], v[16:19]
    buffer_load_dwordx4 v[156:159], v205, s[28:31], s12 offen offset:2048 sc1
    v_mfma_f32_16x16x32_bf16 v[20:23], a[196:199], v[112:115], v[20:23]
    s_lshl_b32 s45, s45, 6
    v_mfma_f32_16x16x32_bf16 v[20:23], a[212:215], v[116:119], v[20:23]
    s_lshl_b32 s46, s46, 5
    s_waitcnt vmcnt(8)
    v_mfma_f32_16x16x32_bf16 v[32:35], a[248:251], v[124:127], v[32:35]
    s_mov_b32 s12, 147456
    v_mfma_f32_16x16x32_bf16 v[32:35], a[232:235], v[120:123], v[32:35]
    buffer_load_dwordx4 v[80:83], v205, s[28:31], s12 offen offset:0 sc1
    v_mfma_f32_16x16x32_bf16 v[36:39], a[236:239], v[120:123], v[36:39]
    v_mfma_f32_16x16x32_bf16 v[36:39], a[252:255], v[124:127], v[36:39]
    v_mfma_f32_16x16x32_bf16 v[16:19], a[240:243], v[124:127], v[16:19]
    v_mfma_f32_16x16x32_bf16 v[16:19], a[224:227], v[120:123], v[16:19]
    buffer_load_dwordx4 v[84:87], v205, s[28:31], s12 offen offset:2048 sc1
    v_mfma_f32_16x16x32_bf16 v[20:23], a[228:231], v[120:123], v[20:23]
    v_mfma_f32_16x16x32_bf16 v[20:23], a[244:247], v[124:127], v[20:23]
    s_waitcnt vmcnt(8)
    s_nop 0
    v_mfma_f32_16x16x32_bf16 v[72:75], a[24:27], v[132:135], 0
    s_mov_b32 s12, 151552
    v_mfma_f32_16x16x32_bf16 v[72:75], a[8:11], v[128:131], v[72:75]
    buffer_load_dwordx4 v[88:91], v205, s[28:31], s12 offen offset:0 sc1
    v_mfma_f32_16x16x32_bf16 v[76:79], a[12:15], v[128:131], 0
    ds_write_b128 v202, v[32:35] offset:0
    v_mfma_f32_16x16x32_bf16 v[76:79], a[28:31], v[132:135], v[76:79]
    v_mfma_f32_16x16x32_bf16 v[56:59], a[16:19], v[132:135], 0
    ds_write_b128 v202, v[36:39] offset:1024
    v_mfma_f32_16x16x32_bf16 v[56:59], a[0:3], v[128:131], v[56:59]
    buffer_load_dwordx4 v[92:95], v205, s[28:31], s12 offen offset:2048 sc1
    v_mfma_f32_16x16x32_bf16 v[60:63], a[4:7], v[128:131], 0
    v_mfma_f32_16x16x32_bf16 v[60:63], a[20:23], v[132:135], v[60:63]
    s_waitcnt vmcnt(8)
    v_mfma_f32_16x16x32_bf16 v[72:75], a[56:59], v[140:143], v[72:75]
    s_mov_b32 s12, 155648
    s_nop 0
    v_mfma_f32_16x16x32_bf16 v[72:75], a[40:43], v[136:139], v[72:75]
    buffer_load_dwordx4 v[96:99], v205, s[28:31], s12 offen offset:0 sc1
    v_mfma_f32_16x16x32_bf16 v[76:79], a[44:47], v[136:139], v[76:79]
    v_mfma_f32_16x16x32_bf16 v[76:79], a[60:63], v[140:143], v[76:79]
    v_mfma_f32_16x16x32_bf16 v[56:59], a[48:51], v[140:143], v[56:59]
    v_mfma_f32_16x16x32_bf16 v[56:59], a[32:35], v[136:139], v[56:59]
    buffer_load_dwordx4 v[100:103], v205, s[28:31], s12 offen offset:2048 sc1
    v_mfma_f32_16x16x32_bf16 v[60:63], a[36:39], v[136:139], v[60:63]
L_pg11:
    s_cbranch_execz L_ret
    v_mfma_f32_16x16x32_bf16 v[60:63], a[52:55], v[140:143], v[60:63]
    s_waitcnt vmcnt(8)
    v_mfma_f32_16x16x32_bf16 v[72:75], a[88:91], v[148:151], v[72:75]
    s_mov_b32 s12, 159744
    v_mfma_f32_16x16x32_bf16 v[72:75], a[72:75], v[144:147], v[72:75]
    buffer_load_dwordx4 v[104:107], v205, s[28:31], s12 offen offset:0 sc1
    v_mfma_f32_16x16x32_bf16 v[76:79], a[76:79], v[144:147], v[76:79]
    v_mfma_f32_16x16x32_bf16 v[76:79], a[92:95], v[148:151], v[76:79]
    v_mfma_f32_16x16x32_bf16 v[56:59], a[80:83], v[148:151], v[56:59]
    v_mfma_f32_16x16x32_bf16 v[56:59], a[64:67], v[144:147], v[56:59]
    buffer_load_dwordx4 v[108:111], v205, s[28:31], s12 offen offset:2048 sc1
    v_mfma_f32_16x16x32_bf16 v[60:63], a[68:71], v[144:147], v[60:63]
    v_mfma_f32_16x16x32_bf16 v[60:63], a[84:87], v[148:151], v[60:63]
    s_waitcnt vmcnt(8)
    v_mfma_f32_16x16x32_bf16 v[72:75], a[120:123], v[156:159], v[72:75]
    s_mov_b32 s12, 131072
    s_nop 0
    v_mfma_f32_16x16x32_bf16 v[72:75], a[104:107], v[152:155], v[72:75]
    buffer_load_dwordx4 v[112:115], v204, s[28:31], s12 offen offset:0 sc1
    v_mfma_f32_16x16x32_bf16 v[76:79], a[108:111], v[152:155], v[76:79]
    v_mfma_f32_16x16x32_bf16 v[76:79], a[124:127], v[156:159], v[76:79]
    v_mfma_f32_16x16x32_bf16 v[56:59], a[112:115], v[156:159], v[56:59]
    v_mfma_f32_16x16x32_bf16 v[56:59], a[96:99], v[152:155], v[56:59]
    buffer_load_dwordx4 v[116:119], v204, s[28:31], s12 offen offset:2048 sc1
    v_mfma_f32_16x16x32_bf16 v[60:63], a[100:103], v[152:155], v[60:63]
    v_mfma_f32_16x16x32_bf16 v[60:63], a[116:119], v[156:159], v[60:63]
    s_waitcnt lgkmcnt(0)
    s_barrier
    s_waitcnt vmcnt(8)
    v_mfma_f32_16x16x32_bf16 v[72:75], a[152:155], v[84:87], v[72:75]
    s_nop 0
    s_mov_b32 s12, 135168
    ds_read_b128 v[160:163], v200 offset:0
    ds_read_b128 v[164:167], v200 offset:1024
    v_mfma_f32_16x16x32_bf16 v[72:75], a[136:139], v[80:83], v[72:75]
    buffer_load_dwordx4 v[120:123], v204, s[28:31], s12 offen offset:0 sc1
    v_mfma_f32_16x16x32_bf16 v[76:79], a[140:143], v[80:83], v[76:79]
    ds_read_b128 v[168:171], v200 offset:2048
    v_mfma_f32_16x16x32_bf16 v[76:79], a[156:159], v[84:87], v[76:79]
    ds_read_b128 v[172:175], v200 offset:3072
    v_mfma_f32_16x16x32_bf16 v[56:59], a[144:147], v[84:87], v[56:59]
    ds_read_b128 v[176:179], v200 offset:4096
    v_mfma_f32_16x16x32_bf16 v[56:59], a[128:131], v[80:83], v[56:59]
    buffer_load_dwordx4 v[124:127], v204, s[28:31], s12 offen offset:2048 sc1
    v_mfma_f32_16x16x32_bf16 v[60:63], a[132:135], v[80:83], v[60:63]
    ds_read_b128 v[180:183], v200 offset:5120
    v_mfma_f32_16x16x32_bf16 v[60:63], a[148:151], v[84:87], v[60:63]
    s_waitcnt vmcnt(8)
    v_mfma_f32_16x16x32_bf16 v[72:75], a[184:187], v[92:95], v[72:75]
    s_mov_b32 s12, 139264
    v_mfma_f32_16x16x32_bf16 v[72:75], a[168:171], v[88:91], v[72:75]
    buffer_load_dwordx4 v[128:131], v204, s[28:31], s12 offen offset:0 sc1
    v_mfma_f32_16x16x32_bf16 v[76:79], a[172:175], v[88:91], v[76:79]
    s_waitcnt lgkmcnt(2)
    v_add_f32 v23, v23, v175
    v_add_f32 v22, v22, v174
    v_add_f32_e64 v21, v21, v173
    v_mfma_f32_16x16x32_bf16 v[76:79], a[188:191], v[92:95], v[76:79]
    v_add_f32 v20, v20, v172
    v_add_f32 v19, v19, v171
    v_mfma_f32_16x16x32_bf16 v[56:59], a[176:179], v[92:95], v[56:59]
    v_add_f32 v18, v18, v170
    v_add_f32 v17, v17, v169
    v_mfma_f32_16x16x32_bf16 v[56:59], a[160:163], v[88:91], v[56:59]
    buffer_load_dwordx4 v[132:135], v204, s[28:31], s12 offen offset:2048 sc1
    v_mfma_f32_16x16x32_bf16 v[60:63], a[164:167], v[88:91], v[60:63]
    v_add_f32 v16, v16, v168
    v_add_f32 v23, v23, v167
    v_mfma_f32_16x16x32_bf16 v[60:63], a[180:183], v[92:95], v[60:63]
    v_add_f32 v22, v22, v166
    v_add_f32 v21, v21, v165
    v_add_f32 v20, v20, v164
    s_waitcnt vmcnt(8)
    v_mfma_f32_16x16x32_bf16 v[72:75], a[216:219], v[100:103], v[72:75]
    s_mov_b32 s12, 143360
    v_add_f32 v19, v19, v163
    v_add_f32 v18, v18, v162
    v_mfma_f32_16x16x32_bf16 v[72:75], a[200:203], v[96:99], v[72:75]
    buffer_load_dwordx4 v[136:139], v204, s[28:31], s12 offen offset:0 sc1
    v_mfma_f32_16x16x32_bf16 v[76:79], a[204:207], v[96:99], v[76:79]
    v_add_f32 v17, v17, v161
    v_add_f32 v16, v16, v160
    v_mfma_f32_16x16x32_bf16 v[76:79], a[220:223], v[100:103], v[76:79]
    s_waitcnt lgkmcnt(0)
    v_add_f32 v23, v23, v183
    v_add_f32 v22, v22, v182
    v_mfma_f32_16x16x32_bf16 v[56:59], a[208:211], v[100:103], v[56:59]
    v_add_f32 v21, v21, v181
    v_add_f32 v20, v20, v180
    v_add_f32 v19, v19, v179
    v_mfma_f32_16x16x32_bf16 v[56:59], a[192:195], v[96:99], v[56:59]
    buffer_load_dwordx4 v[140:143], v204, s[28:31], s12 offen offset:2048 sc1
    v_mfma_f32_16x16x32_bf16 v[60:63], a[196:199], v[96:99], v[60:63]
    v_add_f32 v18, v18, v178
    v_add_f32 v17, v17, v177
    v_mfma_f32_16x16x32_bf16 v[60:63], a[212:215], v[100:103], v[60:63]
    v_add_f32 v16, v16, v176
    v_mul_f32 v184, v16, v16
    s_waitcnt vmcnt(8)
    v_mfma_f32_16x16x32_bf16 v[72:75], a[248:251], v[108:111], v[72:75]
    s_mov_b32 s12, 147456
    v_mul_f32 v185, v17, v17
    v_mul_f32 v186, v18, v18
    v_mfma_f32_16x16x32_bf16 v[72:75], a[232:235], v[104:107], v[72:75]
    buffer_load_dwordx4 v[144:147], v204, s[28:31], s12 offen offset:0 sc1
    v_mfma_f32_16x16x32_bf16 v[76:79], a[236:239], v[104:107], v[76:79]
    v_mul_f32 v187, v19, v19
    v_mul_f32 v188, v20, v20
    v_mul_f32 v189, v21, v21
    v_mfma_f32_16x16x32_bf16 v[76:79], a[252:255], v[108:111], v[76:79]
    v_mul_f32 v190, v22, v22
    v_mul_f32 v191, v23, v23
    v_mfma_f32_16x16x32_bf16 v[56:59], a[240:243], v[108:111], v[56:59]
    v_fma_f32 v184, v184, s9, v206
    v_fma_f32 v185, v185, s9, v206
    v_mfma_f32_16x16x32_bf16 v[56:59], a[224:227], v[104:107], v[56:59]
    buffer_load_dwordx4 v[148:151], v204, s[28:31], s12 offen offset:2048 sc1
    v_mfma_f32_16x16x32_bf16 v[60:63], a[228:231], v[104:107], v[60:63]
    v_fma_f32 v186, v186, s9, v206
    v_fma_f32 v187, v187, s9, v206
    v_mfma_f32_16x16x32_bf16 v[60:63], a[244:247], v[108:111], v[60:63]
    v_fma_f32 v188, v188, s9, v206
    v_fma_f32 v189, v189, s9, v206
    v_fma_f32 v190, v190, s9, v206
    s_waitcnt vmcnt(8)
    v_mfma_f32_16x16x32_bf16 v[64:67], a[24:27], v[116:119], 0
    s_mov_b32 s12, 151552
    v_fma_f32 v191, v191, s9, v206
    v_mul_f32 v184, v184, v16
    v_mfma_f32_16x16x32_bf16 v[64:67], a[8:11], v[112:115], v[64:67]
    buffer_load_dwordx4 v[152:155], v204, s[28:31], s12 offen offset:0 sc1
    v_mfma_f32_16x16x32_bf16 v[68:71], a[12:15], v[112:115], 0
    v_mul_f32 v185, v185, v17
    v_mul_f32 v186, v186, v18
    v_mfma_f32_16x16x32_bf16 v[68:71], a[28:31], v[116:119], v[68:71]
    v_mul_f32 v187, v187, v19
    v_mul_f32 v188, v188, v20
    v_mfma_f32_16x16x32_bf16 v[48:51], a[16:19], v[116:119], v[48:51]
    v_mul_f32 v189, v189, v21
    v_mul_f32 v190, v190, v22
    ds_write_b128 v201, v[56:59] offset:24576
    v_mfma_f32_16x16x32_bf16 v[48:51], a[0:3], v[112:115], v[48:51]
    buffer_load_dwordx4 v[156:159], v204, s[28:31], s12 offen offset:2048 sc1
    v_mfma_f32_16x16x32_bf16 v[52:55], a[4:7], v[112:115], v[52:55]
    v_mul_f32 v191, v191, v23
    v_exp_f32 v184, v184
    v_exp_f32 v185, v185
    v_mfma_f32_16x16x32_bf16 v[52:55], a[20:23], v[116:119], v[52:55]
    v_exp_f32 v186, v186
    v_exp_f32 v187, v187
    s_waitcnt vmcnt(8)
    v_mfma_f32_16x16x32_bf16 v[64:67], a[56:59], v[124:127], v[64:67]
    s_mov_b32 s12, 155648
    v_exp_f32 v188, v188
    v_exp_f32 v189, v189
    ds_write_b128 v201, v[60:63] offset:25600
    v_mfma_f32_16x16x32_bf16 v[64:67], a[40:43], v[120:123], v[64:67]
    buffer_load_dwordx4 v[80:83], v204, s[28:31], s12 offen offset:0 sc1
    v_mfma_f32_16x16x32_bf16 v[68:71], a[44:47], v[120:123], v[68:71]
    v_exp_f32 v190, v190
    v_exp_f32 v191, v191
    v_mfma_f32_16x16x32_bf16 v[68:71], a[60:63], v[124:127], v[68:71]
    v_add_f32 v184, 1.0, v184
    v_add_f32 v185, 1.0, v185
    v_add_f32 v186, 1.0, v186
    v_mfma_f32_16x16x32_bf16 v[48:51], a[48:51], v[124:127], v[48:51]
    v_add_f32 v187, 1.0, v187
    v_add_f32_e64 v188, 1.0, v188
    v_mfma_f32_16x16x32_bf16 v[48:51], a[32:35], v[120:123], v[48:51]
    buffer_load_dwordx4 v[84:87], v204, s[28:31], s12 offen offset:2048 sc1
    v_mfma_f32_16x16x32_bf16 v[52:55], a[36:39], v[120:123], v[52:55]
    v_add_f32 v189, 1.0, v189
    v_add_f32 v190, 1.0, v190
    ds_write_b128 v203, v[72:75] offset:24576
    v_mfma_f32_16x16x32_bf16 v[52:55], a[52:55], v[124:127], v[52:55]
    v_add_f32 v191, 1.0, v191
    v_rcp_f32_e64 v184, v184
    s_waitcnt vmcnt(8)
    v_mfma_f32_16x16x32_bf16 v[64:67], a[88:91], v[132:135], v[64:67]
    s_mov_b32 s12, 159744
    v_rcp_f32 v185, v185
    v_rcp_f32 v186, v186
    v_rcp_f32_e64 v187, v187
    v_mfma_f32_16x16x32_bf16 v[64:67], a[72:75], v[128:131], v[64:67]
    buffer_load_dwordx4 v[88:91], v204, s[28:31], s12 offen offset:0 sc1
    v_mfma_f32_16x16x32_bf16 v[68:71], a[76:79], v[128:131], v[68:71]
    v_rcp_f32 v188, v188
    v_rcp_f32 v189, v189
    v_mfma_f32_16x16x32_bf16 v[68:71], a[92:95], v[132:135], v[68:71]
    v_rcp_f32 v190, v190
    v_rcp_f32 v191, v191
    ds_write_b128 v203, v[76:79] offset:25600
    v_mfma_f32_16x16x32_bf16 v[48:51], a[80:83], v[132:135], v[48:51]
    v_mul_f32 v184, v184, v16
    v_mul_f32 v185, v185, v17
    v_mfma_f32_16x16x32_bf16 v[48:51], a[64:67], v[128:131], v[48:51]
    buffer_load_dwordx4 v[92:95], v204, s[28:31], s12 offen offset:2048 sc1
    v_mfma_f32_16x16x32_bf16 v[52:55], a[68:71], v[128:131], v[52:55]
    v_mul_f32 v186, v186, v18
    v_mul_f32 v187, v187, v19
    v_mul_f32 v188, v188, v20
    v_mfma_f32_16x16x32_bf16 v[52:55], a[84:87], v[132:135], v[52:55]
    v_mul_f32 v189, v189, v21
    v_mul_f32 v190, v190, v22
    s_waitcnt vmcnt(8)
    v_mfma_f32_16x16x32_bf16 v[64:67], a[120:123], v[140:143], v[64:67]
    s_add_u32 m0, s64, 4096
    s_mov_b32 s65, 393216
    v_mul_f32_e64 v191, v191, v23
    v_cvt_pk_bf16_f32 v192, v184, v185
    v_mfma_f32_16x16x32_bf16 v[64:67], a[104:107], v[136:139], v[64:67]
    buffer_load_dwordx4 v224, s[20:23], s65 offen offset:0 lds
    v_mfma_f32_16x16x32_bf16 v[68:71], a[108:111], v[136:139], v[68:71]
    v_cvt_pk_bf16_f32 v193, v186, v187
    v_cvt_pk_bf16_f32 v194, v188, v189
    v_mfma_f32_16x16x32_bf16 v[68:71], a[124:127], v[140:143], v[68:71]
    v_cvt_pk_bf16_f32 v195, v190, v191
    buffer_store_dwordx4 v[192:195], v7, s[28:31], s8 offen sc1
    v_mfma_f32_16x16x32_bf16 v[48:51], a[112:115], v[140:143], v[48:51]
    v_mfma_f32_16x16x32_bf16 v[48:51], a[96:99], v[136:139], v[48:51]
    buffer_load_dwordx4 v225, s[20:23], s65 offen offset:1024 lds
    v_mfma_f32_16x16x32_bf16 v[52:55], a[100:103], v[136:139], v[52:55]
    v_mfma_f32_16x16x32_bf16 v[52:55], a[116:119], v[140:143], v[52:55]
    s_waitcnt vmcnt(9)
    v_mfma_f32_16x16x32_bf16 v[64:67], a[152:155], v[148:151], v[64:67]
    s_nop 0
    v_mfma_f32_16x16x32_bf16 v[64:67], a[136:139], v[144:147], v[64:67]
    buffer_load_dwordx4 v226, s[20:23], s65 offen offset:2048 lds
    v_mfma_f32_16x16x32_bf16 v[68:71], a[140:143], v[144:147], v[68:71]
    ds_read_b64_tr_b16 a[0:1], v228 offset:16384
    v_mfma_f32_16x16x32_bf16 v[68:71], a[156:159], v[148:151], v[68:71]
    ds_read_b64_tr_b16 a[2:3], v228 offset:18432
    v_mfma_f32_16x16x32_bf16 v[48:51], a[144:147], v[148:151], v[48:51]
    ds_read_b64_tr_b16 a[4:5], v229 offset:16384
    v_mfma_f32_16x16x32_bf16 v[48:51], a[128:131], v[144:147], v[48:51]
    buffer_load_dwordx4 v227, s[20:23], s65 offen offset:3072 lds
    v_mfma_f32_16x16x32_bf16 v[52:55], a[132:135], v[144:147], v[52:55]
    ds_read_b64_tr_b16 a[6:7], v229 offset:18432
    v_mfma_f32_16x16x32_bf16 v[52:55], a[148:151], v[148:151], v[52:55]
    ds_read_b64_tr_b16 a[8:9], v230 offset:16384
    s_waitcnt vmcnt(9)
    v_mfma_f32_16x16x32_bf16 v[64:67], a[184:187], v[156:159], v[64:67]
    s_nop 0
    s_add_u32 m0, s64, 8192
    s_mov_b32 s65, 524288
    ds_read_b64_tr_b16 a[10:11], v230 offset:18432
    v_mfma_f32_16x16x32_bf16 v[64:67], a[168:171], v[152:155], v[64:67]
    buffer_load_dwordx4 v224, s[20:23], s65 offen offset:0 lds
    v_mfma_f32_16x16x32_bf16 v[68:71], a[172:175], v[152:155], v[68:71]
    ds_read_b64_tr_b16 a[12:13], v231 offset:16384
    v_mfma_f32_16x16x32_bf16 v[68:71], a[188:191], v[156:159], v[68:71]
    ds_read_b64_tr_b16 a[14:15], v231 offset:18432
    v_mfma_f32_16x16x32_bf16 v[48:51], a[176:179], v[156:159], v[48:51]
    ds_read_b64_tr_b16 a[16:17], v228 offset:20480
    v_mfma_f32_16x16x32_bf16 v[48:51], a[160:163], v[152:155], v[48:51]
    buffer_load_dwordx4 v225, s[20:23], s65 offen offset:1024 lds
    v_mfma_f32_16x16x32_bf16 v[52:55], a[164:167], v[152:155], v[52:55]
    ds_read_b64_tr_b16 a[18:19], v228 offset:22528
    v_mfma_f32_16x16x32_bf16 v[52:55], a[180:183], v[156:159], v[52:55]
    ds_read_b64_tr_b16 a[20:21], v229 offset:20480
    s_waitcnt vmcnt(9)
    v_mfma_f32_16x16x32_bf16 v[64:67], a[216:219], v[84:87], v[64:67]
    ds_read_b64_tr_b16 a[22:23], v229 offset:22528
    s_nop 0
    v_mfma_f32_16x16x32_bf16 v[64:67], a[200:203], v[80:83], v[64:67]
    buffer_load_dwordx4 v226, s[20:23], s65 offen offset:2048 lds
    v_mfma_f32_16x16x32_bf16 v[68:71], a[204:207], v[80:83], v[68:71]
    ds_read_b64_tr_b16 a[24:25], v230 offset:20480
    v_mfma_f32_16x16x32_bf16 v[68:71], a[220:223], v[84:87], v[68:71]
    ds_read_b64_tr_b16 a[26:27], v230 offset:22528
    v_mfma_f32_16x16x32_bf16 v[48:51], a[208:211], v[84:87], v[48:51]
    ds_read_b64_tr_b16 a[28:29], v231 offset:20480
    v_mfma_f32_16x16x32_bf16 v[48:51], a[192:195], v[80:83], v[48:51]
    buffer_load_dwordx4 v227, s[20:23], s65 offen offset:3072 lds
    v_mfma_f32_16x16x32_bf16 v[52:55], a[196:199], v[80:83], v[52:55]
    ds_read_b64_tr_b16 a[30:31], v231 offset:22528
    v_mfma_f32_16x16x32_bf16 v[52:55], a[212:215], v[84:87], v[52:55]
    ds_read_b64_tr_b16 a[32:33], v228 offset:0
    s_waitcnt vmcnt(9)
    v_mfma_f32_16x16x32_bf16 v[64:67], a[248:251], v[92:95], v[64:67]
    s_nop 0
    ds_read_b64_tr_b16 a[34:35], v228 offset:2048
    v_mfma_f32_16x16x32_bf16 v[64:67], a[232:235], v[88:91], v[64:67]
    ds_read_b64_tr_b16 a[36:37], v229 offset:0
    v_mfma_f32_16x16x32_bf16 v[68:71], a[236:239], v[88:91], v[68:71]
    ds_read_b64_tr_b16 a[38:39], v229 offset:2048
    v_mfma_f32_16x16x32_bf16 v[68:71], a[252:255], v[92:95], v[68:71]
    ds_read_b64_tr_b16 a[40:41], v230 offset:0
    v_mfma_f32_16x16x32_bf16 v[48:51], a[240:243], v[92:95], v[48:51]
    ds_read_b64_tr_b16 a[42:43], v230 offset:2048
    v_mfma_f32_16x16x32_bf16 v[48:51], a[224:227], v[88:91], v[48:51]
    ds_read_b64_tr_b16 a[44:45], v231 offset:0
    v_mfma_f32_16x16x32_bf16 v[52:55], a[228:231], v[88:91], v[52:55]
    ds_read_b64_tr_b16 a[46:47], v231 offset:2048
    v_mfma_f32_16x16x32_bf16 v[52:55], a[244:247], v[92:95], v[52:55]
    ds_write_b128 v202, v[64:67] offset:24576
    s_add_u32 m0, s64, 12288
    s_mov_b32 s65, 655360
    buffer_load_dwordx4 v224, s[20:23], s65 offen offset:0 lds
    ds_write_b128 v202, v[68:71] offset:25600
    buffer_load_dwordx4 v225, s[20:23], s65 offen offset:1024 lds
    s_waitcnt lgkmcnt(0)
    s_waitcnt vmcnt(9)
    s_barrier
    buffer_store_dword v253, v252, s[28:31], s10 offen sc1
    ds_read_b128 v[160:163], v200 offset:24576
    s_nop 0
    ds_read_b128 v[164:167], v200 offset:25600
    ds_read_b128 v[168:171], v200 offset:26624
    ds_read_b128 v[172:175], v200 offset:27648
    ds_read_b128 v[176:179], v200 offset:28672
    ds_read_b128 v[180:183], v200 offset:29696
    s_waitcnt lgkmcnt(5)
    v_pk_add_f32 v[48:49], v[48:49], v[160:161]
    v_pk_add_f32 v[50:51], v[50:51], v[162:163]
    s_waitcnt lgkmcnt(4)
    v_pk_add_f32 v[52:53], v[52:53], v[164:165]
    v_pk_add_f32 v[54:55], v[54:55], v[166:167]
    s_waitcnt lgkmcnt(3)
    v_pk_add_f32 v[48:49], v[48:49], v[168:169]
    v_pk_add_f32 v[50:51], v[50:51], v[170:171]
    s_waitcnt lgkmcnt(2)
    v_pk_add_f32 v[52:53], v[52:53], v[172:173]
    v_pk_add_f32 v[54:55], v[54:55], v[174:175]
    s_waitcnt lgkmcnt(1)
    v_pk_add_f32 v[48:49], v[48:49], v[176:177]
    v_pk_add_f32 v[50:51], v[50:51], v[178:179]
    s_waitcnt lgkmcnt(0)
    v_pk_add_f32 v[52:53], v[52:53], v[180:181]
    v_pk_add_f32 v[54:55], v[54:55], v[182:183]
    v_pk_mul_f32 v[184:185], v[48:49], v[48:49]
    buffer_load_dwordx4 v226, s[20:23], s65 offen offset:2048 lds
    v_pk_mul_f32 v[186:187], v[50:51], v[50:51]
    v_pk_mul_f32 v[188:189], v[52:53], v[52:53]
    v_pk_mul_f32 v[190:191], v[54:55], v[54:55]
    v_pk_fma_f32 v[184:185], v[184:185], s[8:9], v[206:207] op_sel:[0,1,0] op_sel_hi:[1,1,0]
    v_pk_fma_f32 v[186:187], v[186:187], s[8:9], v[206:207] op_sel:[0,1,0] op_sel_hi:[1,1,0]
    v_pk_fma_f32 v[188:189], v[188:189], s[8:9], v[206:207] op_sel:[0,1,0] op_sel_hi:[1,1,0]
    v_pk_fma_f32 v[190:191], v[190:191], s[8:9], v[206:207] op_sel:[0,1,0] op_sel_hi:[1,1,0]
    v_pk_mul_f32 v[184:185], v[184:185], v[48:49]
    v_pk_mul_f32 v[186:187], v[186:187], v[50:51]
    buffer_load_dwordx4 v227, s[20:23], s65 offen offset:3072 lds
    v_pk_mul_f32 v[188:189], v[188:189], v[52:53]
    v_pk_mul_f32 v[190:191], v[190:191], v[54:55]
    v_exp_f32 v184, v184
    v_exp_f32 v185, v185
    v_exp_f32 v186, v186
    v_exp_f32 v187, v187
    v_exp_f32 v188, v188
    v_exp_f32 v189, v189
    v_exp_f32_e64 v190, v190
    s_add_u32 m0, s64, 16384
    s_mov_b32 s65, 786432
    buffer_load_dwordx4 v224, s[20:23], s65 offen offset:0 lds
    v_exp_f32 v191, v191
    v_add_f32 v184, 1.0, v184
    v_add_f32 v185, 1.0, v185
    v_add_f32 v186, 1.0, v186
    v_add_f32 v187, 1.0, v187
    v_add_f32 v188, 1.0, v188
    v_add_f32 v189, 1.0, v189
    v_add_f32 v190, 1.0, v190
    v_add_f32 v191, 1.0, v191
    buffer_load_dwordx4 v225, s[20:23], s65 offen offset:1024 lds
    v_rcp_f32 v184, v184
    v_rcp_f32 v185, v185
    v_rcp_f32 v186, v186
    v_rcp_f32 v187, v187
    v_rcp_f32 v188, v188
    v_rcp_f32 v189, v189
    v_rcp_f32 v190, v190
    v_rcp_f32 v191, v191
    v_mul_f32 v184, v184, v48
    buffer_load_dwordx4 v226, s[20:23], s65 offen offset:2048 lds
    v_mul_f32 v185, v185, v49
    v_mul_f32 v186, v186, v50
    v_mul_f32 v187, v187, v51
    v_mul_f32 v188, v188, v52
    v_mul_f32 v189, v189, v53
    v_mul_f32 v190, v190, v54
    v_mul_f32_e64 v191, v191, v55
    v_cvt_pk_bf16_f32 v192, v184, v185
    v_cvt_pk_bf16_f32 v193, v186, v187
    v_cvt_pk_bf16_f32 v194, v188, v189
    v_cvt_pk_bf16_f32 v195, v190, v191
    buffer_store_dwordx4 v[192:195], v7, s[28:31], s14 offen sc1
    s_branch L_phaseD
L_cidle:
    s_mov_b32 s11, 1073741824
    s_mov_b32 s10, 1073741824
    s_waitcnt vmcnt(0) lgkmcnt(0)
    s_sub_u32 s3, s40, 30
    s_lshl_b32 s3, s3, 2
    s_add_u32 s3, s3, s38
    s_lshl_b32 s3, s3, 8
    s_lshr_b32 s9, s39, 1
    s_xor_b32 s9, s9, 3
    s_add_u32 s3, s3, s9
    s_lshl_b32 s3, s3, 10
    s_add_u32 s3, s3, 384
    v_lshlrev_b32_e64 v8, 12, v0
    buffer_load_dword v255, v8, s[20:23], s3 offen
    s_add_u32 s3, s3, 2097152
    buffer_load_dword v255, v8, s[20:23], s3 offen
    s_add_u32 s3, s3, 2097152
    buffer_load_dword v255, v8, s[20:23], s3 offen
    s_add_u32 s3, s3, 2097152
    s_add_u32 m0, s64, 16384
    s_mov_b32 s65, 0
    buffer_load_dwordx4 v224, s[20:23], s65 offen offset:0 lds
    buffer_load_dwordx4 v225, s[20:23], s65 offen offset:1024 lds
    buffer_load_dwordx4 v226, s[20:23], s65 offen offset:2048 lds
    s_nop 0
    buffer_load_dwordx4 v227, s[20:23], s65 offen offset:3072 lds
    s_add_u32 m0, s64, 20480
    s_mov_b32 s65, 131072
    buffer_load_dwordx4 v224, s[20:23], s65 offen offset:0 lds
    buffer_load_dwordx4 v225, s[20:23], s65 offen offset:1024 lds
    buffer_load_dwordx4 v226, s[20:23], s65 offen offset:2048 lds
    buffer_load_dwordx4 v227, s[20:23], s65 offen offset:3072 lds
    s_add_u32 m0, s64, 0
    s_nop 0
    s_mov_b32 s65, 262144
    buffer_load_dwordx4 v224, s[20:23], s65 offen offset:0 lds
    buffer_load_dwordx4 v225, s[20:23], s65 offen offset:1024 lds
    buffer_load_dwordx4 v226, s[20:23], s65 offen offset:2048 lds
    buffer_load_dwordx4 v227, s[20:23], s65 offen offset:3072 lds
    s_add_u32 m0, s64, 4096
    s_mov_b32 s65, 393216
    buffer_load_dwordx4 v224, s[20:23], s65 offen offset:0 lds
    buffer_load_dwordx4 v225, s[20:23], s65 offen offset:1024 lds
    buffer_load_dwordx4 v226, s[20:23], s65 offen offset:2048 lds
    buffer_load_dwordx4 v227, s[20:23], s65 offen offset:3072 lds
    s_add_u32 m0, s64, 8192
    s_mov_b32 s65, 524288
    buffer_load_dwordx4 v224, s[20:23], s65 offen offset:0 lds
    buffer_load_dwordx4 v225, s[20:23], s65 offen offset:1024 lds
    buffer_load_dwordx4 v226, s[20:23], s65 offen offset:2048 lds
    buffer_load_dwordx4 v227, s[20:23], s65 offen offset:3072 lds
    s_waitcnt vmcnt(16)
    ds_read_b64_tr_b16 a[0:1], v228 offset:16384
    ds_read_b64_tr_b16 a[2:3], v228 offset:18432
    s_nop 0
    ds_read_b64_tr_b16 a[4:5], v229 offset:16384
    ds_read_b64_tr_b16 a[6:7], v229 offset:18432
    ds_read_b64_tr_b16 a[8:9], v230 offset:16384
    ds_read_b64_tr_b16 a[10:11], v230 offset:18432
    ds_read_b64_tr_b16 a[12:13], v231 offset:16384
    ds_read_b64_tr_b16 a[14:15], v231 offset:18432
    s_add_u32 m0, s64, 12288
    s_mov_b32 s65, 655360
    buffer_load_dwordx4 v224, s[20:23], s65 offen offset:0 lds
    buffer_load_dwordx4 v225, s[20:23], s65 offen offset:1024 lds
    buffer_load_dwordx4 v226, s[20:23], s65 offen offset:2048 lds
    buffer_load_dwordx4 v227, s[20:23], s65 offen offset:3072 lds
    s_waitcnt vmcnt(16)
    ds_read_b64_tr_b16 a[16:17], v228 offset:20480
    ds_read_b64_tr_b16 a[18:19], v228 offset:22528
    ds_read_b64_tr_b16 a[20:21], v229 offset:20480
    s_nop 0
    ds_read_b64_tr_b16 a[22:23], v229 offset:22528
    ds_read_b64_tr_b16 a[24:25], v230 offset:20480
    ds_read_b64_tr_b16 a[26:27], v230 offset:22528
    ds_read_b64_tr_b16 a[28:29], v231 offset:20480
    ds_read_b64_tr_b16 a[30:31], v231 offset:22528
    s_waitcnt lgkmcnt(8)
    s_add_u32 m0, s64, 16384
    s_mov_b32 s65, 786432
    buffer_load_dwordx4 v224, s[20:23], s65 offen offset:0 lds
    buffer_load_dwordx4 v225, s[20:23], s65 offen offset:1024 lds
    buffer_load_dwordx4 v226, s[20:23], s65 offen offset:2048 lds
    s_waitcnt vmcnt(15)
    ds_read_b64_tr_b16 a[32:33], v228 offset:0
    ds_read_b64_tr_b16 a[34:35], v228 offset:2048
    ds_read_b64_tr_b16 a[36:37], v229 offset:0
    ds_read_b64_tr_b16 a[38:39], v229 offset:2048
    ds_read_b64_tr_b16 a[40:41], v230 offset:0
    ds_read_b64_tr_b16 a[42:43], v230 offset:2048
    ds_read_b64_tr_b16 a[44:45], v231 offset:0
    ds_read_b64_tr_b16 a[46:47], v231 offset:2048
    s_and_b32 s49, s68, 1
    s_mul_i32 s3, s68, 5
    s_add_u32 s46, s3, 4
    s_lshl_b32 s50, s49, 2
    s_sub_u32 s46, s46, s50
    s_add_u32 s3, s3, 1
    s_lshr_b32 s3, s3, 1
    s_add_u32 s44, s3, 1
    s_and_b32 s44, s44, 0xfe
    s_or_b32 s45, s3, 1
    s_mul_i32 s50, s38, 768
    s_mul_i32 s47, s44, 1536
    s_add_u32 s47, s47, s50
    s_add_u32 s47, s47, 65536
    v_min_u32 v8, 5, v0
    v_lshlrev_b32 v243, 7, v8
    s_lshr_b32 s3, s45, 1
    s_mul_i32 s48, s3, 3072
    s_add_u32 s48, s48, 98304
    s_lshr_b32 s3, s46, 2
    s_mul_i32 s3, s3, 3072
    s_and_b32 s62, s46, 2
    s_mul_i32 s62, s62, 16384
    s_add_u32 s3, s3, s62
    s_add_u32 s3, s3, 65536
    v_mov_b32 v9, s48
    v_mov_b32 v10, s3
    v_lshrrev_b32 v8, 1, v0
    v_min_u32 v8, 5, v8
    v_cndmask_b32 v9, v9, v10, s[56:57]
    v_lshl_add_u32 v239, v8, 7, v9
    s_lshl_b32 s51, s69, 2
    s_add_u32 s51, s51, s38
    v_lshl_add_u32 v10, v4, 3, v5
    v_lshlrev_b32 v10, 4, v10
    v_lshl_add_u32 v10, v2, 9, v10
    v_lshlrev_b32 v11, 4, v1
    v_cmp_gt_u32 vcc, 2, v2
    v_lshl_add_u32 v11, v2, 9, v11
    v_mov_b32_e64 v12, 1073741824
    v_cndmask_b32 v216, v12, v10, vcc
    v_cndmask_b32 v217, v12, v11, vcc
    s_lshl_b32 s48, s51, 10
    s_add_u32 s48, s48, 5242880
    s_lshl_b32 s3, s44, 17
    s_add_u32 s60, s3, s48
    s_lshl_b32 s3, s45, 17
    s_add_u32 s61, s3, s48
    s_lshr_b32 s3, s46, 1
    s_lshl_b32 s3, s3, 17
    s_add_u32 s3, s3, s48
    s_lshl_b32 s62, s49, 8
    s_add_u32 s67, s3, s62
    v_lshlrev_b32 v12, 2, v2
    v_sub_u32 v12, v1, v12
    v_cndmask_b32 v12, 64, v12, vcc
    v_and_b32 v13, 1, v12
    v_lshlrev_b32 v13, 4, v13
    v_lshlrev_b32 v13, v13, v253
    v_mul_u32_u24 v13, 0x3f80, v13
    v_lshrrev_b32 v12, 1, v12
    v_cmp_eq_u32 vcc, 0, v12
    v_cmp_eq_u32 s[62:63], 1, v12
    v_lshlrev_b32 v212, 16, v207
    v_lshlrev_b32 v213, 16, v207
    v_cndmask_b32 v208, 0, v13, vcc
    v_cndmask_b32 v209, 0, v13, s[62:63]
    v_cmp_eq_u32 vcc, 4, v12
    v_cmp_eq_u32 s[62:63], 5, v12
    v_lshlrev_b32 v214, 16, v207
    v_lshlrev_b32 v215, 16, v207
    v_cndmask_b32 v210, 0, v13, vcc
    v_cndmask_b32 v211, 0, v13, s[62:63]
    s_mul_i32 s48, s38, 12288
    s_add_u32 s48, s48, 13631488
    s_mul_i32 s52, s44, 98304
    s_add_u32 s52, s52, s48
    s_add_u32 s53, s52, 49152
    s_mul_i32 s54, s45, 98304
    s_add_u32 s54, s54, s48
    s_add_u32 s55, s54, 49152
    s_mul_i32 s66, s46, 49152
    s_add_u32 s66, s66, s48
    v_mov_b32 v236, v7
    v_add_u32 v237, 4096, v7
    v_add_u32 v238, 8192, v7
    s_xor_b32 s3, s38, 1
    s_mul_i32 s3, s3, 15360
    s_add_u32 s3, s3, 98304
    v_add_u32 v9, s3, v7
    s_xor_b32 s3, s38, 2
    s_mul_i32 s3, s3, 15360
    s_add_u32 s3, s3, 99328
    v_add_u32_e64 v10, s3, v7
    s_xor_b32 s3, s38, 3
    s_mul_i32 s3, s3, 15360
    s_add_u32 s3, s3, 100352
    v_add_u32_e64 v11, s3, v7
    s_mul_i32 s3, s38, 15360
    s_add_u32 s3, s3, 98304
    v_add_u32 v8, s3, v7
    s_lshl_b32 s3, s51, 4
    v_add_u32_e64 v12, s3, v1
    v_mul_u32_u24 v12, 1280, v12
    v_lshl_add_u32 v13, v2, 3, v12
    v_lshl_add_u32 v12, v2, 4, v12
    s_lshl_b32 s44, s44, 6
    s_lshl_b32 s45, s45, 6
    s_lshl_b32 s46, s46, 5
    s_waitcnt vmcnt(0) lgkmcnt(0)
L_phaseD:
L_pg12:
    s_cbranch_execz L_ret
    buffer_load_dwordx4 v227, s[20:23], s65 offen offset:3072 lds
    s_waitcnt vmcnt(14)
    ds_read_b64_tr_b16 a[48:49], v228 offset:4096
    ds_read_b64_tr_b16 a[50:51], v228 offset:6144
    ds_read_b64_tr_b16 a[52:53], v229 offset:4096
    ds_read_b64_tr_b16 a[54:55], v229 offset:6144
    ds_read_b64_tr_b16 a[56:57], v230 offset:4096
    ds_read_b64_tr_b16 a[58:59], v230 offset:6144
    ds_read_b64_tr_b16 a[60:61], v231 offset:4096
    ds_read_b64_tr_b16 a[62:63], v231 offset:6144
    s_add_u32 m0, s64, 20480
    s_mov_b32 s65, 917504
    buffer_load_dwordx4 v224, s[20:23], s65 offen offset:0 lds
    s_waitcnt vmcnt(11)
    ds_read_b64_tr_b16 a[64:65], v228 offset:8192
    ds_read_b64_tr_b16 a[66:67], v228 offset:10240
    s_nop 0
    ds_read_b64_tr_b16 a[68:69], v229 offset:8192
    ds_read_b64_tr_b16 a[70:71], v229 offset:10240
    ds_read_b64_tr_b16 a[72:73], v230 offset:8192
    ds_read_b64_tr_b16 a[74:75], v230 offset:10240
    ds_read_b64_tr_b16 a[76:77], v231 offset:8192
    ds_read_b64_tr_b16 a[78:79], v231 offset:10240
    buffer_load_dwordx4 v225, s[20:23], s65 offen offset:1024 lds
    s_waitcnt vmcnt(7)
    s_nop 0
    ds_read_b64_tr_b16 a[80:81], v228 offset:12288
    ds_read_b64_tr_b16 a[82:83], v228 offset:14336
    ds_read_b64_tr_b16 a[84:85], v229 offset:12288
    ds_read_b64_tr_b16 a[86:87], v229 offset:14336
    ds_read_b64_tr_b16 a[88:89], v230 offset:12288
    ds_read_b64_tr_b16 a[90:91], v230 offset:14336
    ds_read_b64_tr_b16 a[92:93], v231 offset:12288
    ds_read_b64_tr_b16 a[94:95], v231 offset:14336
L_pg13:
    s_cbranch_execz L_ret
    buffer_load_dwordx4 v226, s[20:23], s65 offen offset:2048 lds
    buffer_load_dwordx4 v227, s[20:23], s65 offen offset:3072 lds
    s_add_u32 m0, s64, 0
    s_mov_b32 s65, 1048576
    buffer_load_dwordx4 v224, s[20:23], s65 offen offset:0 lds
    buffer_load_dwordx4 v225, s[20:23], s65 offen offset:1024 lds
    buffer_load_dwordx4 v226, s[20:23], s65 offen offset:2048 lds
    s_waitcnt vmcnt(8)
    s_barrier
    buffer_store_dword v253, v252, s[28:31], s11 offen sc1
    buffer_load_dword v242, v243, s[28:31], s47 offen sc1
    buffer_load_dwordx4 v227, s[20:23], s65 offen offset:3072 lds
    s_waitcnt lgkmcnt(14)
    s_add_u32 m0, s64, 4096
    s_mov_b32 s65, 1179648
    buffer_load_dwordx4 v224, s[20:23], s65 offen offset:0 lds
    buffer_load_dwordx4 v225, s[20:23], s65 offen offset:1024 lds
    s_waitcnt vmcnt(12)
    ds_read_b64_tr_b16 a[96:97], v228 offset:16384
    ds_read_b64_tr_b16 a[98:99], v228 offset:18432
    ds_read_b64_tr_b16 a[100:101], v229 offset:16384
    ds_read_b64_tr_b16 a[102:103], v229 offset:18432
    ds_read_b64_tr_b16 a[104:105], v230 offset:16384
    ds_read_b64_tr_b16 a[106:107], v230 offset:18432
    ds_read_b64_tr_b16 a[108:109], v231 offset:16384
    ds_read_b64_tr_b16 a[110:111], v231 offset:18432
    buffer_load_dwordx4 v226, s[20:23], s65 offen offset:2048 lds
    buffer_load_dwordx4 v227, s[20:23], s65 offen offset:3072 lds
    s_waitcnt lgkmcnt(14)
    s_add_u32 m0, s64, 8192
    s_mov_b32 s65, 1310720
    buffer_load_dwordx4 v224, s[20:23], s65 offen offset:0 lds
    s_waitcnt vmcnt(6)
    v_cmp_gt_u32 vcc, 1, v242
    s_nop 0
    s_cbranch_vccz L_ok_45
    s_mov_b32 s43, 0
L_spin_46:
    s_sleep 4
    buffer_load_dword v242, v243, s[28:31], s47 offen sc1
    s_add_u32 s43, s43, 1
    s_cmp_ge_u32 s43, 20000
    s_waitcnt vmcnt(0)
    s_cbranch_scc1 L_ok_45
    v_cmp_gt_u32 vcc, 1, v242
    s_nop 1
    s_cbranch_vccnz L_spin_46
L_ok_45:
    buffer_load_dwordx4 v225, s[20:23], s65 offen offset:1024 lds
    ds_read_b64_tr_b16 a[112:113], v228 offset:20480
    s_nop 0
    ds_read_b64_tr_b16 a[114:115], v228 offset:22528
    ds_read_b64_tr_b16 a[116:117], v229 offset:20480
    ds_read_b64_tr_b16 a[118:119], v229 offset:22528
    ds_read_b64_tr_b16 a[120:121], v230 offset:20480
    ds_read_b64_tr_b16 a[122:123], v230 offset:22528
    ds_read_b64_tr_b16 a[124:125], v231 offset:20480
    ds_read_b64_tr_b16 a[126:127], v231 offset:22528
    buffer_load_dwordx4 v[96:99], v236, s[28:31], s52 offen offset:0 sc1
    buffer_load_dwordx4 v[100:103], v236, s[28:31], s52 offen offset:1024 sc1
    buffer_load_dwordx4 v[104:107], v236, s[28:31], s53 offen offset:0 sc1
    buffer_load_dwordx4 v226, s[20:23], s65 offen offset:2048 lds
    s_waitcnt vmcnt(10)
    s_nop 0
    ds_read_b64_tr_b16 a[128:129], v228 offset:0
    ds_read_b64_tr_b16 a[130:131], v228 offset:2048
    ds_read_b64_tr_b16 a[132:133], v229 offset:0
    ds_read_b64_tr_b16 a[134:135], v229 offset:2048
    ds_read_b64_tr_b16 a[136:137], v230 offset:0
    ds_read_b64_tr_b16 a[138:139], v230 offset:2048
    ds_read_b64_tr_b16 a[140:141], v231 offset:0
    ds_read_b64_tr_b16 a[142:143], v231 offset:2048
    buffer_load_dwordx4 v[108:111], v236, s[28:31], s53 offen offset:1024 sc1
    buffer_load_dwordx4 v[112:115], v236, s[28:31], s52 offen offset:2048 sc1
    buffer_load_dwordx4 v227, s[20:23], s65 offen offset:3072 lds
    buffer_load_dwordx4 v[116:119], v236, s[28:31], s52 offen offset:3072 sc1
    s_waitcnt vmcnt(10)
    ds_read_b64_tr_b16 a[144:145], v228 offset:4096
    ds_read_b64_tr_b16 a[146:147], v228 offset:6144
    ds_read_b64_tr_b16 a[148:149], v229 offset:4096
    s_nop 0
    ds_read_b64_tr_b16 a[150:151], v229 offset:6144
    ds_read_b64_tr_b16 a[152:153], v230 offset:4096
    ds_read_b64_tr_b16 a[154:155], v230 offset:6144
    ds_read_b64_tr_b16 a[156:157], v231 offset:4096
    ds_read_b64_tr_b16 a[158:159], v231 offset:6144
    buffer_load_dwordx4 v[120:123], v236, s[28:31], s53 offen offset:2048 sc1
    s_waitcnt lgkmcnt(14)
    s_add_u32 m0, s64, 12288
    s_mov_b32 s65, 1441792
    buffer_load_dwordx4 v224, s[20:23], s65 offen offset:0 lds
    buffer_load_dwordx4 v[124:127], v236, s[28:31], s53 offen offset:3072 sc1
    s_waitcnt vmcnt(9)
    v_mfma_f32_16x16x32_bf16 v[20:23], v[100:103], a[20:23], 0
    v_mfma_f32_16x16x32_bf16 v[20:23], v[96:99], a[4:7], v[20:23]
    v_mfma_f32_16x16x32_bf16 v[24:27], v[96:99], a[8:11], 0
    v_mfma_f32_16x16x32_bf16 v[24:27], v[100:103], a[24:27], v[24:27]
    v_mfma_f32_16x16x32_bf16 v[28:31], v[100:103], a[28:31], 0
    v_mfma_f32_16x16x32_bf16 v[28:31], v[96:99], a[12:15], v[28:31]
    v_mfma_f32_16x16x32_bf16 v[16:19], v[96:99], a[0:3], v[212:215]
    v_mfma_f32_16x16x32_bf16 v[16:19], v[100:103], a[16:19], v[16:19]
    buffer_load_dwordx4 v[128:131], v237, s[28:31], s52 offen offset:0 sc1
    buffer_load_dwordx4 v[132:135], v237, s[28:31], s52 offen offset:1024 sc1
    buffer_load_dwordx4 v225, s[20:23], s65 offen offset:1024 lds
    s_waitcnt vmcnt(9)
    v_mfma_f32_16x16x32_bf16 v[36:39], v[108:111], a[20:23], 0
    s_nop 0
    v_mfma_f32_16x16x32_bf16 v[36:39], v[104:107], a[4:7], v[36:39]
    v_mfma_f32_16x16x32_bf16 v[40:43], v[104:107], a[8:11], 0
    v_mfma_f32_16x16x32_bf16 v[40:43], v[108:111], a[24:27], v[40:43]
    v_mfma_f32_16x16x32_bf16 v[44:47], v[108:111], a[28:31], 0
    v_mfma_f32_16x16x32_bf16 v[44:47], v[104:107], a[12:15], v[44:47]
    v_mfma_f32_16x16x32_bf16 v[32:35], v[104:107], a[0:3], v[212:215]
    v_mfma_f32_16x16x32_bf16 v[32:35], v[108:111], a[16:19], v[32:35]
    buffer_load_dwordx4 v[136:139], v237, s[28:31], s53 offen offset:0 sc1
    buffer_load_dwordx4 v[140:143], v237, s[28:31], s53 offen offset:1024 sc1
    buffer_load_dwordx4 v226, s[20:23], s65 offen offset:2048 lds
    s_waitcnt vmcnt(10)
    ds_read_b64_tr_b16 a[160:161], v228 offset:8192
    s_nop 0
    ds_read_b64_tr_b16 a[162:163], v228 offset:10240
    ds_read_b64_tr_b16 a[164:165], v229 offset:8192
    ds_read_b64_tr_b16 a[166:167], v229 offset:10240
    ds_read_b64_tr_b16 a[168:169], v230 offset:8192
    ds_read_b64_tr_b16 a[170:171], v230 offset:10240
    ds_read_b64_tr_b16 a[172:173], v231 offset:8192
    ds_read_b64_tr_b16 a[174:175], v231 offset:10240
    buffer_load_dwordx4 v[144:147], v237, s[28:31], s52 offen offset:2048 sc1
    s_waitcnt vmcnt(10)
    v_mfma_f32_16x16x32_bf16 v[20:23], v[116:119], a[52:55], v[20:23]
    v_mfma_f32_16x16x32_bf16 v[20:23], v[112:115], a[36:39], v[20:23]
    v_mfma_f32_16x16x32_bf16 v[24:27], v[112:115], a[40:43], v[24:27]
    s_nop 0
    v_mfma_f32_16x16x32_bf16 v[24:27], v[116:119], a[56:59], v[24:27]
    v_mfma_f32_16x16x32_bf16 v[28:31], v[116:119], a[60:63], v[28:31]
    v_mfma_f32_16x16x32_bf16 v[28:31], v[112:115], a[44:47], v[28:31]
    v_mfma_f32_16x16x32_bf16 v[16:19], v[112:115], a[32:35], v[16:19]
    v_mfma_f32_16x16x32_bf16 v[16:19], v[116:119], a[48:51], v[16:19]
    buffer_load_dwordx4 v[148:151], v237, s[28:31], s52 offen offset:3072 sc1
    buffer_load_dwordx4 v227, s[20:23], s65 offen offset:3072 lds
    s_waitcnt vmcnt(9)
    s_nop 0
    v_mfma_f32_16x16x32_bf16 v[36:39], v[124:127], a[52:55], v[36:39]
    v_mfma_f32_16x16x32_bf16 v[36:39], v[120:123], a[36:39], v[36:39]
    v_mfma_f32_16x16x32_bf16 v[40:43], v[120:123], a[40:43], v[40:43]
    v_mfma_f32_16x16x32_bf16 v[40:43], v[124:127], a[56:59], v[40:43]
    v_mfma_f32_16x16x32_bf16 v[44:47], v[124:127], a[60:63], v[44:47]
    v_mfma_f32_16x16x32_bf16 v[44:47], v[120:123], a[44:47], v[44:47]
    v_mfma_f32_16x16x32_bf16 v[32:35], v[120:123], a[32:35], v[32:35]
    v_mfma_f32_16x16x32_bf16 v[32:35], v[124:127], a[48:51], v[32:35]
    buffer_load_dwordx4 v[152:155], v237, s[28:31], s53 offen offset:2048 sc1
    buffer_load_dwordx4 v[156:159], v237, s[28:31], s53 offen offset:3072 sc1
    s_waitcnt vmcnt(9)
    v_mfma_f32_16x16x32_bf16 v[20:23], v[132:135], a[84:87], v[20:23]
    s_nop 0
    v_mfma_f32_16x16x32_bf16 v[20:23], v[128:131], a[68:71], v[20:23]
    v_mfma_f32_16x16x32_bf16 v[24:27], v[128:131], a[72:75], v[24:27]
    v_mfma_f32_16x16x32_bf16 v[24:27], v[132:135], a[88:91], v[24:27]
    v_mfma_f32_16x16x32_bf16 v[28:31], v[132:135], a[92:95], v[28:31]
    v_mfma_f32_16x16x32_bf16 v[28:31], v[128:131], a[76:79], v[28:31]
    v_mfma_f32_16x16x32_bf16 v[16:19], v[128:131], a[64:67], v[16:19]
    v_mfma_f32_16x16x32_bf16 v[16:19], v[132:135], a[80:83], v[16:19]
    buffer_load_dword v240, v239, s[28:31], s50 offen sc1
    buffer_load_dwordx4 v[160:163], v238, s[28:31], s52 offen offset:0 sc1
    buffer_load_dwordx4 v[164:167], v238, s[28:31], s52 offen offset:1024 sc1
    buffer_load_dwordx4 v[168:171], v238, s[28:31], s53 offen offset:0 sc1
    s_waitcnt vmcnt(10)
    s_nop 0
    v_mfma_f32_16x16x32_bf16 v[36:39], v[140:143], a[84:87], v[36:39]
    v_mfma_f32_16x16x32_bf16 v[36:39], v[136:139], a[68:71], v[36:39]
    v_mfma_f32_16x16x32_bf16 v[40:43], v[136:139], a[72:75], v[40:43]
    v_mfma_f32_16x16x32_bf16 v[40:43], v[140:143], a[88:91], v[40:43]
    v_mfma_f32_16x16x32_bf16 v[44:47], v[140:143], a[92:95], v[44:47]
    v_mfma_f32_16x16x32_bf16 v[44:47], v[136:139], a[76:79], v[44:47]
    v_mfma_f32_16x16x32_bf16 v[32:35], v[136:139], a[64:67], v[32:35]
    v_mfma_f32_16x16x32_bf16 v[32:35], v[140:143], a[80:83], v[32:35]
    buffer_load_dwordx4 v[172:175], v238, s[28:31], s53 offen offset:1024 sc1
    buffer_load_dwordx4 v[96:99], v238, s[28:31], s52 offen offset:2048 sc1
    buffer_load_dwordx4 v[100:103], v238, s[28:31], s52 offen offset:3072 sc1
    s_waitcnt vmcnt(10) lgkmcnt(14)
    s_nop 0
    v_mfma_f32_16x16x32_bf16 v[20:23], v[148:151], a[116:119], v[20:23]
    v_mfma_f32_16x16x32_bf16 v[20:23], v[144:147], a[100:103], v[20:23]
    v_mfma_f32_16x16x32_bf16 v[24:27], v[144:147], a[104:107], v[24:27]
    v_mfma_f32_16x16x32_bf16 v[24:27], v[148:151], a[120:123], v[24:27]
    v_mfma_f32_16x16x32_bf16 v[28:31], v[148:151], a[124:127], v[28:31]
    v_mfma_f32_16x16x32_bf16 v[28:31], v[144:147], a[108:111], v[28:31]
    v_mfma_f32_16x16x32_bf16 v[16:19], v[144:147], a[96:99], v[16:19]
    v_mfma_f32_16x16x32_bf16 v[16:19], v[148:151], a[112:115], v[16:19]
    buffer_load_dwordx4 v[104:107], v238, s[28:31], s53 offen offset:2048 sc1
    buffer_load_dwordx4 v[108:111], v238, s[28:31], s53 offen offset:3072 sc1
    s_waitcnt vmcnt(11)
    ds_read_b64_tr_b16 a[176:177], v228 offset:12288
    s_nop 0
    ds_read_b64_tr_b16 a[178:179], v228 offset:14336
    ds_read_b64_tr_b16 a[180:181], v229 offset:12288
    ds_read_b64_tr_b16 a[182:183], v229 offset:14336
    ds_read_b64_tr_b16 a[184:185], v230 offset:12288
    ds_read_b64_tr_b16 a[186:187], v230 offset:14336
    ds_read_b64_tr_b16 a[188:189], v231 offset:12288
    ds_read_b64_tr_b16 a[190:191], v231 offset:14336
    s_waitcnt vmcnt(8)
    v_cmp_gt_u32 vcc, 1, v240
    s_nop 0
    s_cbranch_vccz L_ok_47
    s_mov_b32 s43, 0
L_spin_48:
    s_sleep 4
    buffer_load_dword v240, v239, s[28:31], s50 offen sc1
    s_add_u32 s43, s43, 1
    s_cmp_ge_u32 s43, 20000
    s_waitcnt vmcnt(0)
    s_cbranch_scc1 L_ok_47
    v_cmp_gt_u32 vcc, 1, v240
    s_nop 1
    s_cbranch_vccnz L_spin_48
L_ok_47:
    buffer_load_dwordx4 v[176:179], v216, s[28:31], s60 offen offset:0 sc1
    v_mfma_f32_16x16x32_bf16 v[36:39], v[156:159], a[116:119], v[36:39]
    v_mfma_f32_16x16x32_bf16 v[36:39], v[152:155], a[100:103], v[36:39]
    v_mfma_f32_16x16x32_bf16 v[40:43], v[152:155], a[104:107], v[40:43]
    v_mfma_f32_16x16x32_bf16 v[40:43], v[156:159], a[120:123], v[40:43]
    v_mfma_f32_16x16x32_bf16 v[44:47], v[156:159], a[124:127], v[44:47]
    v_mfma_f32_16x16x32_bf16 v[44:47], v[152:155], a[108:111], v[44:47]
    v_mfma_f32_16x16x32_bf16 v[32:35], v[152:155], a[96:99], v[32:35]
    v_mfma_f32_16x16x32_bf16 v[32:35], v[156:159], a[112:115], v[32:35]
    buffer_load_dwordx4 v[180:183], v216, s[28:31], s60 offen offset:64 sc1
    buffer_load_dwordx4 v[184:187], v216, s[28:31], s61 offen offset:0 sc1
    s_waitcnt vmcnt(9) lgkmcnt(14)
    v_mfma_f32_16x16x32_bf16 v[20:23], v[164:167], a[148:151], v[20:23]
    s_nop 0
    v_mfma_f32_16x16x32_bf16 v[20:23], v[160:163], a[132:135], v[20:23]
    v_mfma_f32_16x16x32_bf16 v[24:27], v[160:163], a[136:139], v[24:27]
    v_mfma_f32_16x16x32_bf16 v[24:27], v[164:167], a[152:155], v[24:27]
    v_mfma_f32_16x16x32_bf16 v[28:31], v[164:167], a[156:159], v[28:31]
    v_mfma_f32_16x16x32_bf16 v[28:31], v[160:163], a[140:143], v[28:31]
    v_mfma_f32_16x16x32_bf16 v[16:19], v[160:163], a[128:131], v[16:19]
    v_mfma_f32_16x16x32_bf16 v[16:19], v[164:167], a[144:147], v[16:19]
    buffer_load_dwordx4 v[188:191], v216, s[28:31], s61 offen offset:64 sc1
    buffer_load_dwordx4 v[192:195], v217, s[28:31], s67 offen sc1
    s_waitcnt vmcnt(9)
    v_mfma_f32_16x16x32_bf16 v[36:39], v[172:175], a[148:151], v[36:39]
    v_mfma_f32_16x16x32_bf16 v[36:39], v[168:171], a[132:135], v[36:39]
    s_nop 0
    v_mfma_f32_16x16x32_bf16 v[40:43], v[168:171], a[136:139], v[40:43]
    v_mfma_f32_16x16x32_bf16 v[40:43], v[172:175], a[152:155], v[40:43]
    v_mfma_f32_16x16x32_bf16 v[44:47], v[172:175], a[156:159], v[44:47]
    v_mfma_f32_16x16x32_bf16 v[44:47], v[168:171], a[140:143], v[44:47]
    v_mfma_f32_16x16x32_bf16 v[32:35], v[168:171], a[128:131], v[32:35]
    v_mfma_f32_16x16x32_bf16 v[32:35], v[172:175], a[144:147], v[32:35]
    buffer_load_dwordx4 v[112:115], v236, s[28:31], s54 offen offset:0 sc1
    buffer_load_dwordx4 v[116:119], v236, s[28:31], s54 offen offset:1024 sc1
    s_waitcnt vmcnt(9) lgkmcnt(4)
    v_mfma_f32_16x16x32_bf16 v[20:23], v[100:103], a[180:183], v[20:23]
    v_mfma_f32_16x16x32_bf16 v[20:23], v[96:99], a[164:167], v[20:23]
    v_mfma_f32_16x16x32_bf16 v[24:27], v[96:99], a[168:171], v[24:27]
    s_waitcnt lgkmcnt(2)
    v_mfma_f32_16x16x32_bf16 v[24:27], v[100:103], a[184:187], v[24:27]
    s_waitcnt lgkmcnt(0)
    v_mfma_f32_16x16x32_bf16 v[28:31], v[100:103], a[188:191], v[28:31]
    v_mfma_f32_16x16x32_bf16 v[28:31], v[96:99], a[172:175], v[28:31]
    v_mfma_f32_16x16x32_bf16 v[16:19], v[96:99], a[160:163], v[16:19]
    v_mfma_f32_16x16x32_bf16 v[16:19], v[100:103], a[176:179], v[16:19]
    buffer_load_dwordx4 v[120:123], v236, s[28:31], s54 offen offset:2048 sc1
    buffer_load_dwordx4 v[124:127], v236, s[28:31], s54 offen offset:3072 sc1
    s_waitcnt vmcnt(9)
    v_mfma_f32_16x16x32_bf16 v[36:39], v[108:111], a[180:183], v[36:39]
    v_mfma_f32_16x16x32_bf16 v[36:39], v[104:107], a[164:167], v[36:39]
    v_mfma_f32_16x16x32_bf16 v[40:43], v[104:107], a[168:171], v[40:43]
    v_mfma_f32_16x16x32_bf16 v[40:43], v[108:111], a[184:187], v[40:43]
    v_mfma_f32_16x16x32_bf16 v[44:47], v[108:111], a[188:191], v[44:47]
    v_mfma_f32_16x16x32_bf16 v[44:47], v[104:107], a[172:175], v[44:47]
    v_mfma_f32_16x16x32_bf16 v[32:35], v[104:107], a[160:163], v[32:35]
    v_mfma_f32_16x16x32_bf16 v[32:35], v[108:111], a[176:179], v[32:35]
    buffer_load_dwordx4 v[128:131], v237, s[28:31], s54 offen offset:0 sc1
    buffer_load_dwordx4 v[132:135], v237, s[28:31], s54 offen offset:1024 sc1
    buffer_load_dwordx4 v[136:139], v237, s[28:31], s54 offen offset:2048 sc1
    buffer_load_dwordx4 v[140:143], v237, s[28:31], s54 offen offset:3072 sc1
    buffer_load_dwordx4 v[144:147], v238, s[28:31], s54 offen offset:0 sc1
    buffer_load_dwordx4 v[148:151], v238, s[28:31], s54 offen offset:1024 sc1
    buffer_load_dwordx4 v[152:155], v238, s[28:31], s54 offen offset:2048 sc1
    s_waitcnt vmcnt(15)
    v_mfma_f32_16x16x32_bf16 v[16:19], v[176:179], v[208:211], v[16:19]
    s_waitcnt vmcnt(14)
    v_mfma_f32_16x16x32_bf16 v[32:35], v[180:183], v[208:211], v[32:35]
    s_waitcnt vmcnt(13)
    v_mfma_f32_16x16x32_bf16 v[48:51], v[184:187], v[208:211], v[212:215]
    s_waitcnt vmcnt(12)
    v_mfma_f32_16x16x32_bf16 v[64:67], v[188:191], v[208:211], v[212:215]
    s_waitcnt vmcnt(11)
    v_mfma_f32_16x16x32_bf16 v[80:83], v[192:195], v[208:211], v[212:215]
    s_waitcnt vmcnt(9)
    v_mfma_f32_16x16x32_bf16 v[52:55], v[116:119], a[20:23], 0
    v_mfma_f32_16x16x32_bf16 v[52:55], v[112:115], a[4:7], v[52:55]
    v_mfma_f32_16x16x32_bf16 v[56:59], v[112:115], a[8:11], 0
    v_mfma_f32_16x16x32_bf16 v[56:59], v[116:119], a[24:27], v[56:59]
    buffer_load_dwordx4 v[156:159], v238, s[28:31], s54 offen offset:3072 sc1
    v_mfma_f32_16x16x32_bf16 v[60:63], v[116:119], a[28:31], 0
    ds_write_b128 v9, v[20:23] offset:0
    v_mfma_f32_16x16x32_bf16 v[60:63], v[112:115], a[12:15], v[60:63]
    v_mfma_f32_16x16x32_bf16 v[48:51], v[112:115], a[0:3], v[48:51]
    v_mfma_f32_16x16x32_bf16 v[48:51], v[116:119], a[16:19], v[48:51]
    buffer_load_dwordx4 v[160:163], v236, s[28:31], s55 offen offset:0 sc1
    s_waitcnt vmcnt(9)
    v_mfma_f32_16x16x32_bf16 v[52:55], v[124:127], a[52:55], v[52:55]
    s_nop 0
    ds_write_b128 v10, v[24:27] offset:0
    v_mfma_f32_16x16x32_bf16 v[52:55], v[120:123], a[36:39], v[52:55]
    v_mfma_f32_16x16x32_bf16 v[56:59], v[120:123], a[40:43], v[56:59]
    v_mfma_f32_16x16x32_bf16 v[56:59], v[124:127], a[56:59], v[56:59]
    buffer_load_dwordx4 v[164:167], v236, s[28:31], s55 offen offset:1024 sc1
    v_mfma_f32_16x16x32_bf16 v[60:63], v[124:127], a[60:63], v[60:63]
    ds_write_b128 v11, v[28:31] offset:0
    v_mfma_f32_16x16x32_bf16 v[60:63], v[120:123], a[44:47], v[60:63]
    v_mfma_f32_16x16x32_bf16 v[48:51], v[120:123], a[32:35], v[48:51]
    v_mfma_f32_16x16x32_bf16 v[48:51], v[124:127], a[48:51], v[48:51]
    buffer_load_dwordx4 v[168:171], v236, s[28:31], s55 offen offset:2048 sc1
    s_waitcnt vmcnt(9)
    s_nop 0
    v_mfma_f32_16x16x32_bf16 v[52:55], v[132:135], a[84:87], v[52:55]
    ds_write_b128 v9, v[36:39] offset:3072
    v_mfma_f32_16x16x32_bf16 v[52:55], v[128:131], a[68:71], v[52:55]
    v_mfma_f32_16x16x32_bf16 v[56:59], v[128:131], a[72:75], v[56:59]
    v_mfma_f32_16x16x32_bf16 v[56:59], v[132:135], a[88:91], v[56:59]
    buffer_load_dwordx4 v[172:175], v236, s[28:31], s55 offen offset:3072 sc1
    v_mfma_f32_16x16x32_bf16 v[60:63], v[132:135], a[92:95], v[60:63]
    ds_write_b128 v10, v[40:43] offset:3072
    v_mfma_f32_16x16x32_bf16 v[60:63], v[128:131], a[76:79], v[60:63]
    v_mfma_f32_16x16x32_bf16 v[48:51], v[128:131], a[64:67], v[48:51]
    v_mfma_f32_16x16x32_bf16 v[48:51], v[132:135], a[80:83], v[48:51]
    buffer_load_dwordx4 v[96:99], v237, s[28:31], s55 offen offset:0 sc1
    s_waitcnt vmcnt(9)
    v_mfma_f32_16x16x32_bf16 v[52:55], v[140:143], a[116:119], v[52:55]
    ds_write_b128 v11, v[44:47] offset:3072
    v_mfma_f32_16x16x32_bf16 v[52:55], v[136:139], a[100:103], v[52:55]
    s_nop 0
    v_mfma_f32_16x16x32_bf16 v[56:59], v[136:139], a[104:107], v[56:59]
    v_mfma_f32_16x16x32_bf16 v[56:59], v[140:143], a[120:123], v[56:59]
    buffer_load_dwordx4 v[100:103], v237, s[28:31], s55 offen offset:1024 sc1
    v_mfma_f32_16x16x32_bf16 v[60:63], v[140:143], a[124:127], v[60:63]
    v_mfma_f32_16x16x32_bf16 v[60:63], v[136:139], a[108:111], v[60:63]
    v_mfma_f32_16x16x32_bf16 v[48:51], v[136:139], a[96:99], v[48:51]
    v_mfma_f32_16x16x32_bf16 v[48:51], v[140:143], a[112:115], v[48:51]
    buffer_load_dwordx4 v[104:107], v237, s[28:31], s55 offen offset:2048 sc1
    s_waitcnt vmcnt(9)
    v_mfma_f32_16x16x32_bf16 v[52:55], v[148:151], a[148:151], v[52:55]
    v_mfma_f32_16x16x32_bf16 v[52:55], v[144:147], a[132:135], v[52:55]
    v_mfma_f32_16x16x32_bf16 v[56:59], v[144:147], a[136:139], v[56:59]
    s_nop 0
    v_mfma_f32_16x16x32_bf16 v[56:59], v[148:151], a[152:155], v[56:59]
    buffer_load_dwordx4 v[108:111], v237, s[28:31], s55 offen offset:3072 sc1
    v_mfma_f32_16x16x32_bf16 v[60:63], v[148:151], a[156:159], v[60:63]
    v_mfma_f32_16x16x32_bf16 v[60:63], v[144:147], a[140:143], v[60:63]
    v_mfma_f32_16x16x32_bf16 v[48:51], v[144:147], a[128:131], v[48:51]
    v_mfma_f32_16x16x32_bf16 v[48:51], v[148:151], a[144:147], v[48:51]
    buffer_load_dwordx4 v[112:115], v238, s[28:31], s55 offen offset:0 sc1
    s_waitcnt vmcnt(9)
    s_nop 0
    v_mfma_f32_16x16x32_bf16 v[52:55], v[156:159], a[180:183], v[52:55]
    v_mfma_f32_16x16x32_bf16 v[52:55], v[152:155], a[164:167], v[52:55]
    v_mfma_f32_16x16x32_bf16 v[56:59], v[152:155], a[168:171], v[56:59]
    v_mfma_f32_16x16x32_bf16 v[56:59], v[156:159], a[184:187], v[56:59]
    buffer_load_dwordx4 v[116:119], v238, s[28:31], s55 offen offset:1024 sc1
    v_mfma_f32_16x16x32_bf16 v[60:63], v[156:159], a[188:191], v[60:63]
    v_mfma_f32_16x16x32_bf16 v[60:63], v[152:155], a[172:175], v[60:63]
    v_mfma_f32_16x16x32_bf16 v[48:51], v[152:155], a[160:163], v[48:51]
    v_mfma_f32_16x16x32_bf16 v[48:51], v[156:159], a[176:179], v[48:51]
    buffer_load_dwordx4 v[120:123], v238, s[28:31], s55 offen offset:2048 sc1
    s_waitcnt vmcnt(9)
    v_mfma_f32_16x16x32_bf16 v[68:71], v[164:167], a[20:23], 0
    s_nop 0
    v_mfma_f32_16x16x32_bf16 v[68:71], v[160:163], a[4:7], v[68:71]
    v_mfma_f32_16x16x32_bf16 v[72:75], v[160:163], a[8:11], 0
    v_mfma_f32_16x16x32_bf16 v[72:75], v[164:167], a[24:27], v[72:75]
    buffer_load_dwordx4 v[124:127], v238, s[28:31], s55 offen offset:3072 sc1
    v_mfma_f32_16x16x32_bf16 v[76:79], v[164:167], a[28:31], 0
    ds_write_b128 v9, v[52:55] offset:6144
    v_mfma_f32_16x16x32_bf16 v[76:79], v[160:163], a[12:15], v[76:79]
    v_mfma_f32_16x16x32_bf16 v[64:67], v[160:163], a[0:3], v[64:67]
    v_mfma_f32_16x16x32_bf16 v[64:67], v[164:167], a[16:19], v[64:67]
    buffer_load_dwordx4 v[128:131], v236, s[28:31], s66 offen offset:0 sc1
    s_waitcnt vmcnt(9)
    v_mfma_f32_16x16x32_bf16 v[68:71], v[172:175], a[52:55], v[68:71]
    s_nop 0
    ds_write_b128 v10, v[56:59] offset:6144
    v_mfma_f32_16x16x32_bf16 v[68:71], v[168:171], a[36:39], v[68:71]
    v_mfma_f32_16x16x32_bf16 v[72:75], v[168:171], a[40:43], v[72:75]
    v_mfma_f32_16x16x32_bf16 v[72:75], v[172:175], a[56:59], v[72:75]
    buffer_load_dwordx4 v[132:135], v236, s[28:31], s66 offen offset:1024 sc1
    v_mfma_f32_16x16x32_bf16 v[76:79], v[172:175], a[60:63], v[76:79]
    ds_write_b128 v11, v[60:63] offset:6144
    v_mfma_f32_16x16x32_bf16 v[76:79], v[168:171], a[44:47], v[76:79]
    v_mfma_f32_16x16x32_bf16 v[64:67], v[168:171], a[32:35], v[64:67]
    v_mfma_f32_16x16x32_bf16 v[64:67], v[172:175], a[48:51], v[64:67]
    buffer_load_dwordx4 v[136:139], v236, s[28:31], s66 offen offset:2048 sc1
    s_waitcnt vmcnt(9)
    s_nop 0
    v_mfma_f32_16x16x32_bf16 v[68:71], v[100:103], a[84:87], v[68:71]
    v_mfma_f32_16x16x32_bf16 v[68:71], v[96:99], a[68:71], v[68:71]
    v_mfma_f32_16x16x32_bf16 v[72:75], v[96:99], a[72:75], v[72:75]
    v_mfma_f32_16x16x32_bf16 v[72:75], v[100:103], a[88:91], v[72:75]
    buffer_load_dwordx4 v[140:143], v236, s[28:31], s66 offen offset:3072 sc1
    v_mfma_f32_16x16x32_bf16 v[76:79], v[100:103], a[92:95], v[76:79]
    v_mfma_f32_16x16x32_bf16 v[76:79], v[96:99], a[76:79], v[76:79]
    v_mfma_f32_16x16x32_bf16 v[64:67], v[96:99], a[64:67], v[64:67]
    v_mfma_f32_16x16x32_bf16 v[64:67], v[100:103], a[80:83], v[64:67]
    buffer_load_dwordx4 v[144:147], v237, s[28:31], s66 offen offset:0 sc1
    s_waitcnt vmcnt(9)
    v_mfma_f32_16x16x32_bf16 v[68:71], v[108:111], a[116:119], v[68:71]
    s_nop 0
    v_mfma_f32_16x16x32_bf16 v[68:71], v[104:107], a[100:103], v[68:71]
    v_mfma_f32_16x16x32_bf16 v[72:75], v[104:107], a[104:107], v[72:75]
    v_mfma_f32_16x16x32_bf16 v[72:75], v[108:111], a[120:123], v[72:75]
    buffer_load_dwordx4 v[148:151], v237, s[28:31], s66 offen offset:1024 sc1
    v_mfma_f32_16x16x32_bf16 v[76:79], v[108:111], a[124:127], v[76:79]
    v_mfma_f32_16x16x32_bf16 v[76:79], v[104:107], a[108:111], v[76:79]
    v_mfma_f32_16x16x32_bf16 v[64:67], v[104:107], a[96:99], v[64:67]
    v_mfma_f32_16x16x32_bf16 v[64:67], v[108:111], a[112:115], v[64:67]
    buffer_load_dwordx4 v[152:155], v237, s[28:31], s66 offen offset:2048 sc1
    s_waitcnt vmcnt(9)
    v_mfma_f32_16x16x32_bf16 v[68:71], v[116:119], a[148:151], v[68:71]
    v_mfma_f32_16x16x32_bf16 v[68:71], v[112:115], a[132:135], v[68:71]
    s_nop 0
    v_mfma_f32_16x16x32_bf16 v[72:75], v[112:115], a[136:139], v[72:75]
    v_mfma_f32_16x16x32_bf16 v[72:75], v[116:119], a[152:155], v[72:75]
    buffer_load_dwordx4 v[156:159], v237, s[28:31], s66 offen offset:3072 sc1
    v_mfma_f32_16x16x32_bf16 v[76:79], v[116:119], a[156:159], v[76:79]
    v_mfma_f32_16x16x32_bf16 v[76:79], v[112:115], a[140:143], v[76:79]
    v_mfma_f32_16x16x32_bf16 v[64:67], v[112:115], a[128:131], v[64:67]
    v_mfma_f32_16x16x32_bf16 v[64:67], v[116:119], a[144:147], v[64:67]
    buffer_load_dwordx4 v[160:163], v238, s[28:31], s66 offen offset:0 sc1
    s_waitcnt vmcnt(9)
    v_mfma_f32_16x16x32_bf16 v[68:71], v[124:127], a[180:183], v[68:71]
    v_mfma_f32_16x16x32_bf16 v[68:71], v[120:123], a[164:167], v[68:71]
    v_mfma_f32_16x16x32_bf16 v[72:75], v[120:123], a[168:171], v[72:75]
    s_nop 0
    v_mfma_f32_16x16x32_bf16 v[72:75], v[124:127], a[184:187], v[72:75]
    buffer_load_dwordx4 v[164:167], v238, s[28:31], s66 offen offset:1024 sc1
    v_mfma_f32_16x16x32_bf16 v[76:79], v[124:127], a[188:191], v[76:79]
    v_mfma_f32_16x16x32_bf16 v[76:79], v[120:123], a[172:175], v[76:79]
    v_mfma_f32_16x16x32_bf16 v[64:67], v[120:123], a[160:163], v[64:67]
    v_mfma_f32_16x16x32_bf16 v[64:67], v[124:127], a[176:179], v[64:67]
    buffer_load_dwordx4 v[168:171], v238, s[28:31], s66 offen offset:2048 sc1
    s_waitcnt vmcnt(9)
    s_nop 0
    v_mfma_f32_16x16x32_bf16 v[84:87], v[132:135], a[20:23], 0
    v_mfma_f32_16x16x32_bf16 v[84:87], v[128:131], a[4:7], v[84:87]
    v_mfma_f32_16x16x32_bf16 v[88:91], v[128:131], a[8:11], 0
    v_mfma_f32_16x16x32_bf16 v[88:91], v[132:135], a[24:27], v[88:91]
    ds_write_b128 v9, v[68:71] offset:9216
    buffer_load_dwordx4 v[172:175], v238, s[28:31], s66 offen offset:3072 sc1
    v_mfma_f32_16x16x32_bf16 v[92:95], v[132:135], a[28:31], 0
    v_mfma_f32_16x16x32_bf16 v[92:95], v[128:131], a[12:15], v[92:95]
    ds_write_b128 v10, v[72:75] offset:9216
    v_mfma_f32_16x16x32_bf16 v[80:83], v[128:131], a[0:3], v[80:83]
    v_mfma_f32_16x16x32_bf16 v[80:83], v[132:135], a[16:19], v[80:83]
    ds_write_b128 v11, v[76:79] offset:9216
    s_waitcnt vmcnt(8)
    v_mfma_f32_16x16x32_bf16 v[84:87], v[140:143], a[52:55], v[84:87]
    v_mfma_f32_16x16x32_bf16 v[84:87], v[136:139], a[36:39], v[84:87]
    v_mfma_f32_16x16x32_bf16 v[88:91], v[136:139], a[40:43], v[88:91]
    v_mfma_f32_16x16x32_bf16 v[88:91], v[140:143], a[56:59], v[88:91]
    s_waitcnt lgkmcnt(0)
    s_barrier
    v_mfma_f32_16x16x32_bf16 v[92:95], v[140:143], a[60:63], v[92:95]
    ds_read_b128 v[176:179], v8 offset:0
    s_nop 0
    ds_read_b128 v[180:183], v8 offset:1024
    v_mfma_f32_16x16x32_bf16 v[92:95], v[136:139], a[44:47], v[92:95]
    ds_read_b128 v[184:187], v8 offset:2048
    ds_read_b128 v[188:191], v8 offset:3072
    v_mfma_f32_16x16x32_bf16 v[80:83], v[136:139], a[32:35], v[80:83]
    ds_read_b128 v[192:195], v8 offset:4096
    ds_read_b128 v[196:199], v8 offset:5120
    v_mfma_f32_16x16x32_bf16 v[80:83], v[140:143], a[48:51], v[80:83]
    ds_read_b128 v[200:203], v8 offset:6144
    ds_read_b128 v[204:207], v8 offset:7168
    s_waitcnt vmcnt(6)
    v_mfma_f32_16x16x32_bf16 v[84:87], v[148:151], a[84:87], v[84:87]
    s_nop 0
    ds_read_b128 v[208:211], v8 offset:8192
    ds_read_b128 v[212:215], v8 offset:9216
    v_mfma_f32_16x16x32_bf16 v[84:87], v[144:147], a[68:71], v[84:87]
    ds_read_b128 v[216:219], v8 offset:10240
    ds_read_b128 v[220:223], v8 offset:11264
    v_mfma_f32_16x16x32_bf16 v[88:91], v[144:147], a[72:75], v[88:91]
    v_mfma_f32_16x16x32_bf16 v[88:91], v[148:151], a[88:91], v[88:91]
    s_waitcnt lgkmcnt(9)
    v_add_f32 v16, v16, v184
    v_add_f32 v17, v17, v185
    v_mfma_f32_16x16x32_bf16 v[92:95], v[148:151], a[92:95], v[92:95]
    v_add_f32 v18, v18, v186
    v_add_f32 v19, v19, v187
    v_mfma_f32_16x16x32_bf16 v[92:95], v[144:147], a[76:79], v[92:95]
    v_add_f32 v16, v16, v180
    v_add_f32 v17, v17, v181
    v_mfma_f32_16x16x32_bf16 v[80:83], v[144:147], a[64:67], v[80:83]
    v_add_f32 v18, v18, v182
    v_add_f32 v19, v19, v183
    v_mfma_f32_16x16x32_bf16 v[80:83], v[148:151], a[80:83], v[80:83]
    v_add_f32 v16, v16, v176
    v_add_f32 v17, v17, v177
    s_waitcnt vmcnt(4)
    v_mfma_f32_16x16x32_bf16 v[84:87], v[156:159], a[116:119], v[84:87]
    v_add_f32 v18, v18, v178
    v_add_f32 v19, v19, v179
    v_mfma_f32_16x16x32_bf16 v[84:87], v[152:155], a[100:103], v[84:87]
    v_cvt_pk_bf16_f32 v224, v16, v17
    v_cvt_pk_bf16_f32 v225, v18, v19
    v_mfma_f32_16x16x32_bf16 v[88:91], v[152:155], a[104:107], v[88:91]
    s_waitcnt lgkmcnt(6)
    v_add_f32 v32, v32, v196
    v_add_f32 v33, v33, v197
    v_mfma_f32_16x16x32_bf16 v[88:91], v[156:159], a[120:123], v[88:91]
    v_add_f32 v34, v34, v198
    v_add_f32 v35, v35, v199
    v_mfma_f32_16x16x32_bf16 v[92:95], v[156:159], a[124:127], v[92:95]
    v_add_f32 v32, v32, v192
    v_add_f32 v33, v33, v193
    v_mfma_f32_16x16x32_bf16 v[92:95], v[152:155], a[108:111], v[92:95]
    v_add_f32 v34, v34, v194
    v_add_f32 v35, v35, v195
    v_mfma_f32_16x16x32_bf16 v[80:83], v[152:155], a[96:99], v[80:83]
    v_add_f32 v32, v32, v188
    v_add_f32 v33, v33, v189
    v_mfma_f32_16x16x32_bf16 v[80:83], v[156:159], a[112:115], v[80:83]
    v_add_f32 v34, v34, v190
    v_add_f32 v35, v35, v191
    s_waitcnt vmcnt(2)
    v_mfma_f32_16x16x32_bf16 v[84:87], v[164:167], a[148:151], v[84:87]
    v_cvt_pk_bf16_f32 v226, v32, v33
    v_cvt_pk_bf16_f32 v227, v34, v35
    v_mfma_f32_16x16x32_bf16 v[84:87], v[160:163], a[132:135], v[84:87]
    buffer_store_dwordx4 v[224:227], v12, s[24:27], s44 offen sc1
    s_waitcnt lgkmcnt(3)
    v_add_f32 v48, v48, v208
    v_mfma_f32_16x16x32_bf16 v[88:91], v[160:163], a[136:139], v[88:91]
    v_add_f32 v49, v49, v209
    v_add_f32 v50, v50, v210
    v_mfma_f32_16x16x32_bf16 v[88:91], v[164:167], a[152:155], v[88:91]
    v_add_f32 v51, v51, v211
    v_add_f32 v48, v48, v204
    v_mfma_f32_16x16x32_bf16 v[92:95], v[164:167], a[156:159], v[92:95]
    v_add_f32 v49, v49, v205
    v_add_f32 v50, v50, v206
    v_mfma_f32_16x16x32_bf16 v[92:95], v[160:163], a[140:143], v[92:95]
    v_add_f32 v51, v51, v207
    v_add_f32 v48, v48, v200
    v_mfma_f32_16x16x32_bf16 v[80:83], v[160:163], a[128:131], v[80:83]
    v_add_f32 v49, v49, v201
    v_add_f32 v50, v50, v202
    v_mfma_f32_16x16x32_bf16 v[80:83], v[164:167], a[144:147], v[80:83]
    v_add_f32 v51, v51, v203
    v_cvt_pk_bf16_f32 v228, v48, v49
    s_waitcnt vmcnt(1)
    v_mfma_f32_16x16x32_bf16 v[84:87], v[172:175], a[180:183], v[84:87]
    v_cvt_pk_bf16_f32 v229, v50, v51
    s_waitcnt lgkmcnt(0)
    v_add_f32 v64, v64, v220
    v_mfma_f32_16x16x32_bf16 v[84:87], v[168:171], a[164:167], v[84:87]
    v_add_f32 v65, v65, v221
    v_add_f32 v66, v66, v222
    v_mfma_f32_16x16x32_bf16 v[88:91], v[168:171], a[168:171], v[88:91]
    v_add_f32 v67, v67, v223
    v_add_f32 v64, v64, v216
    v_mfma_f32_16x16x32_bf16 v[88:91], v[172:175], a[184:187], v[88:91]
    v_add_f32 v65, v65, v217
    v_add_f32 v66, v66, v218
    v_mfma_f32_16x16x32_bf16 v[92:95], v[172:175], a[188:191], v[92:95]
    v_add_f32 v67, v67, v219
    v_add_f32 v64, v64, v212
    v_mfma_f32_16x16x32_bf16 v[92:95], v[168:171], a[172:175], v[92:95]
    v_add_f32 v65, v65, v213
    v_add_f32 v66, v66, v214
    v_mfma_f32_16x16x32_bf16 v[80:83], v[168:171], a[160:163], v[80:83]
    v_add_f32_e64 v67, v67, v215
    v_cvt_pk_bf16_f32 v230, v64, v65
    v_mfma_f32_16x16x32_bf16 v[80:83], v[172:175], a[176:179], v[80:83]
    v_cvt_pk_bf16_f32 v231, v66, v67
    buffer_store_dwordx4 v[228:231], v12, s[24:27], s45 offen sc1
    ds_write_b128 v9, v[84:87] offset:12288
    ds_write_b128 v10, v[88:91] offset:12288
    ds_write_b128 v11, v[92:95] offset:12288
    s_waitcnt lgkmcnt(0)
    s_barrier
    ds_read_b128 v[96:99], v8 offset:12288
    ds_read_b128 v[100:103], v8 offset:13312
    ds_read_b128 v[104:107], v8 offset:14336
    s_waitcnt lgkmcnt(2)
    v_pk_add_f32 v[80:81], v[80:81], v[96:97]
    v_pk_add_f32 v[82:83], v[82:83], v[98:99]
    s_waitcnt lgkmcnt(1)
    v_pk_add_f32 v[80:81], v[80:81], v[100:101]
L_pg14:
    s_cbranch_execz L_ret
    v_pk_add_f32 v[82:83], v[82:83], v[102:103]
    s_waitcnt lgkmcnt(0)
    v_pk_add_f32 v[80:81], v[80:81], v[104:105]
    v_pk_add_f32 v[82:83], v[82:83], v[106:107]
    v_cvt_pk_bf16_f32 v232, v80, v81
    v_cvt_pk_bf16_f32 v233, v82, v83
    buffer_store_dwordx2 v[232:233], v13, s[24:27], s46 offen sc1
L_end:
    s_endpgm
.section .rodata,"a"
.p2align 6
.amdhsa_kernel sequential_preLN__linear_attn_block__mixer_token_mlp__prompt_kernel
  .amdhsa_next_free_vgpr 512
  .amdhsa_next_free_sgpr 102
  .amdhsa_accum_offset 256
  .amdhsa_group_segment_fixed_size 0
  .amdhsa_kernarg_size 88
  .amdhsa_user_sgpr_count 2
  .amdhsa_user_sgpr_kernarg_segment_ptr 1
  .amdhsa_system_sgpr_workgroup_id_x 1
  .amdhsa_float_denorm_mode_32 3
.end_amdhsa_kernel
```
